```python
import torch

def _softmax(x, axis=-1):
    return torch.softmax(x, dim=axis)
def _gelu(x):
    return torch.nn.functional.gelu(x, approximate="tanh")
def _silu(x):
    return torch.nn.functional.silu(x)
def _sigmoid(x):
    return torch.sigmoid(x)
def _layernorm(x, axis=-1, eps=1e-5):
    m = x.mean(dim=axis, keepdim=True)
    v = x.var(dim=axis, keepdim=True, unbiased=False)
    return (x - m) / torch.sqrt(v + eps)
def _scatter_add(tgt, idx, src, axis=0):
    return tgt.clone().index_add_(axis, idx, src)
def _segment_sum(src, seg, n):
    out = torch.zeros((n,) + src.shape[1:], dtype=src.dtype)
    return out.index_add_(0, seg, src)
def _pad(x, pw):
    flat = tuple(v for pair in reversed(pw) for v in pair)
    return torch.nn.functional.pad(x, flat)

kernel_name = 'interleave_layers__linear_attn_block__mixer_channel_mlp__prompt'

def setup_inputs():

    _w = (lambda a: (lambda t: t.to(torch.bfloat16) if t.is_floating_point() else t)(torch.as_tensor(a)))
    def _A_setup():
        B, S, D = 1, 2048, 448
        return {
            "x": _w((lambda *s: torch.randn(*s, dtype=torch.bfloat16) * 0.05)(B, S, D)),
            "wqkv": _w((lambda *s: torch.randn(*s, dtype=torch.bfloat16) * 0.1)(D, 3 * D)),
            "wo": _w((lambda *s: torch.randn(*s, dtype=torch.bfloat16) * 0.05)(D, D)),
        }
    _A_in = _A_setup()

    def _B_setup():
        B, S, D, F = 1, 2048, 448, 1792
        return {
            "x": _w((lambda *s: torch.randn(*s, dtype=torch.bfloat16) * 0.05)(B, S, D)),
            "w1": _w((lambda *s: torch.randn(*s, dtype=torch.bfloat16) * 3.2)(D, F) * (D ** -0.5)),
            "b1": _w((lambda *s: torch.randn(*s, dtype=torch.bfloat16) * 0.8)(F)),
            "w2": _w((lambda *s: torch.randn(*s, dtype=torch.bfloat16) * 0.8)(F, D) * (F ** -0.5)),
            "b2": _w((lambda *s: torch.randn(*s, dtype=torch.bfloat16) * 0.8)(D)),
        }
    _B_in = _B_setup()

    return {
        "A_x": _A_in["x"],
        "A_wqkv": _A_in["wqkv"],
        "A_wo": _A_in["wo"],
        "B_x": _B_in["x"],
        "B_w1": _B_in["w1"],
        "B_b1": _B_in["b1"],
        "B_w2": _B_in["w2"],
        "B_b2": _B_in["b2"],
    }

def reference(A_x, A_wqkv, A_wo, B_x, B_w1, B_b1, B_w2, B_b2):
    def _A_ref(x, wqkv, wo):
        B, S, D = x.shape
        H = 16; Dh = D // H
        qkv = (lambda x, *d: x.permute(*d))((x @ wqkv).reshape(B, S, 3, H, Dh), 2, 0, 3, 1, 4)
        q, k, v = qkv[0], qkv[1], qkv[2]
        phi = lambda t: torch.where(t > 0, t + 1, torch.exp(t)) + 1e-6
        pq, pk = phi(q), phi(k)
        kv = torch.einsum("bhsd,bhse->bhde", pk, v)
        z = torch.einsum("bhsd->bhd", pk)
        num = torch.einsum("bhqd,bhde->bhqe", pq, kv)
        den = torch.einsum("bhqd,bhd->bhq", pq, z)[..., None] + 1e-6
        o = num / den
        return (lambda x, *d: x.permute(*d))(o, 0, 2, 1, 3).reshape(B, S, D) @ wo

    def _B_ref(x, w1, b1, w2, b2):
        y = _layernorm(x, axis=-1)
        h = _gelu(torch.einsum("bsd,df->bsf", y, w1) + b1)
        return torch.einsum("bsf,fd->bsd", h, w2) + b2

    x = A_x
    x = x + _A_ref(_layernorm(x, axis=-1), A_wqkv, A_wo)
    x = x + _B_ref(_layernorm(x, axis=-1), B_w1, B_b1, B_w2, B_b2)
    x = x + _A_ref(_layernorm(x, axis=-1), A_wqkv, A_wo)
    x = x + _B_ref(_layernorm(x, axis=-1), B_w1, B_b1, B_w2, B_b2)
    return x
```

```asm
; @launch grid=(256,1,1) block=(256,1,1) lds=163840
.amdgcn_target "amdgcn-amd-amdhsa--gfx950"
.text
.globl interleave_layers__linear_attn_block__mixer_channel_mlp__prompt_kernel
.p2align 8
.type interleave_layers__linear_attn_block__mixer_channel_mlp__prompt_kernel,@function
interleave_layers__linear_attn_block__mixer_channel_mlp__prompt_kernel:
	s_cmp_ge_u32 s2, 256
	s_cbranch_scc1 L_end
	s_load_dwordx2 s[4:5], s[0:1], 0
	s_load_dwordx2 s[8:9], s[0:1], 8
	s_getpc_b64 s[88:89]
	v_lshrrev_b32 v96, 6, v0
	v_and_b32 v1, 63, v0
	s_lshr_b32 s3, s2, 3
	v_readfirstlane_b32 s64, v96
	s_lshr_b32 s52, s2, 3
	s_lshl_b32 s52, s52, 2
	s_add_u32 s52, s52, s64
	v_min_u32 v107, 3, v1
	v_lshl_add_u32 v107, s52, 2, v107
	v_lshlrev_b32 v107, 7, v107
	global_load_dword v17, v107, s[88:89]
	s_and_b32 s62, s3, 15
	s_lshr_b32 s3, s3, 4
	s_and_b32 s63, s2, 7
	s_lshl_b32 s63, s63, 1
	s_add_u32 s63, s63, s3
	s_lshl_b32 s3, s63, 2
	s_add_u32 s3, s3, s64
	s_mul_i32 s96, s3, 28672
	s_add_u32 s3, s62, s63
	s_mul_i32 s77, s3, 37
	s_lshr_b32 s77, s77, 8
	s_mul_i32 s77, s77, 7
	s_sub_u32 s3, s3, s77
	s_lshl_b32 s76, s3, 12
	v_lshrrev_b32 v96, 3, v1
	v_and_b32 v97, 7, v1
	v_lshrrev_b32 v102, 4, v1
	v_mul_u32_u24 v224, 896, v96
	v_xor_b32 v102, v102, v97
	v_xor_b32 v103, 4, v102
	v_lshl_add_u32 v225, v103, 4, v224
	v_lshl_add_u32 v224, v102, 4, v224
	s_lshl_b32 s66, s64, 12
	s_add_u32 s66, s66, 86016
	v_add_u32 v227, 21504, v225
	v_add_u32 v226, 14336, v224
	v_add_u32 v225, 7168, v225
	s_mov_b32 s6, 1835008
	s_mov_b32 s7, 0x20000
	s_waitcnt lgkmcnt(0)
	s_lshr_b32 s48, s76, 5
	s_add_u32 s48, s48, s96
	s_add_u32 m0, s66, 0
	s_nop 0
	buffer_load_dwordx4 v224, s[4:7], s48 offen nt lds
	s_add_u32 m0, s66, 1024
	s_nop 0
	buffer_load_dwordx4 v225, s[4:7], s48 offen nt lds
	s_add_u32 m0, s66, 2048
	s_nop 0
	buffer_load_dwordx4 v226, s[4:7], s48 offen nt lds
	s_add_u32 m0, s66, 3072
	s_nop 0
	buffer_load_dwordx4 v227, s[4:7], s48 offen nt lds
	s_load_dwordx2 s[28:29], s[0:1], 80
	s_load_dwordx2 s[16:17], s[0:1], 32
	s_load_dwordx2 s[20:21], s[0:1], 48
	s_load_dwordx2 s[12:13], s[0:1], 16
	s_load_dwordx2 s[32:33], s[0:1], 40
	s_load_dwordx2 s[36:37], s[0:1], 56
	s_load_dwordx2 s[24:25], s[0:1], 64
	v_lshrrev_b32 v98, 2, v1
	v_and_b32 v99, 3, v1
	v_mul_u32_u24 v228, 2688, v98
	v_lshl_add_u32 v228, v99, 4, v228
	s_lshl_b32 s90, s64, 10
	s_mov_b32 s10, 1204224
	s_mov_b32 s11, 0x20000
	s_mul_i32 s47, s62, 56
	s_mul_i32 s3, s64, 43008
	s_add_u32 s47, s47, s3
	s_mul_i32 s49, s76, 42
	s_add_u32 s49, s49, s47
	s_add_u32 m0, s90, 0
	s_add_u32 s50, s49, 896
	buffer_load_dwordx4 v228, s[8:11], s50 offen  lds
	s_add_u32 m0, s90, 28672
	s_add_u32 s50, s49, 1792
	buffer_load_dwordx4 v228, s[8:11], s50 offen  lds
	s_add_u32 s77, s76, 4096
	s_cmp_eq_u32 s77, 28672
	s_cselect_b32 s77, 0, s77
	s_lshr_b32 s48, s77, 5
	s_add_u32 s48, s48, s96
	s_add_u32 m0, s66, 16384
	s_nop 0
	buffer_load_dwordx4 v224, s[4:7], s48 offen nt lds
	s_add_u32 m0, s66, 17408
	s_nop 0
	buffer_load_dwordx4 v225, s[4:7], s48 offen nt lds
	s_add_u32 m0, s66, 18432
	s_nop 0
	buffer_load_dwordx4 v226, s[4:7], s48 offen nt lds
	s_add_u32 m0, s66, 19456
	s_nop 0
	buffer_load_dwordx4 v227, s[4:7], s48 offen nt lds
	v_lshrrev_b32 v100, 5, v1
	v_and_b32 v101, 31, v1
	v_lshlrev_b32 v103, 7, v101
	v_add_u32 v103, s66, v103
	v_bfe_u32 v102, v101, 1, 3
	v_lshl_add_u32 v232, v102, 4, v103
	v_lshl_add_u32 v232, v100, 3, v232
	v_xor_b32 v233, 16, v232
	v_xor_b32 v234, 32, v232
	v_xor_b32 v235, 48, v232
	v_xor_b32 v236, 64, v232
	v_xor_b32 v237, 80, v232
	v_xor_b32 v238, 96, v232
	v_xor_b32 v239, 112, v232
	v_mov_b32 v240, 0x3f803f80
	v_mov_b32 v241, 0x3f803f80
	v_mov_b32 v242, 0x3f803f80
	v_mov_b32 v243, 0x3f803f80
	v_bfe_u32 v102, v1, 2, 2
	v_lshl_add_u32 v102, v100, 2, v102
	v_lshlrev_b32 v102, 6, v102
	v_bfe_u32 v103, v1, 4, 1
	v_lshl_add_u32 v102, v103, 5, v102
	v_lshl_add_u32 v21, v99, 3, v102
	v_add_u32 v246, s90, v21
	v_lshlrev_b32 v4, 4, v1
	v_add_u32 v106, s90, v4
	s_mov_b32 s95, 0
	v_mov_b32 v13, 0
	s_add_u32 s78, s77, 4096
	s_cmp_eq_u32 s78, 28672
	s_cselect_b32 s78, 0, s78
	s_add_u32 s79, s78, 4096
	s_cmp_eq_u32 s79, 28672
	s_cselect_b32 s79, 0, s79
	s_add_u32 s80, s79, 4096
	s_cmp_eq_u32 s80, 28672
	s_cselect_b32 s80, 0, s80
	s_add_u32 s81, s80, 4096
	s_cmp_eq_u32 s81, 28672
	s_cselect_b32 s81, 0, s81
	s_add_u32 s82, s81, 4096
	s_cmp_eq_u32 s82, 28672
	s_cselect_b32 s82, 0, s82
	s_waitcnt lgkmcnt(0)
	v_lshlrev_b32 v3, 3, v1
	v_mov_b32 v244, -1
	v_mov_b32 v245, -1
	s_lshl_b32 s3, s62, 2
	s_add_u32 s3, s3, s64
	s_lshl_b32 s69, s3, 13
	s_add_u32 s69, s69, 262144
	s_lshl_b32 s70, s3, 11
	s_add_u32 s70, s70, 65536
	s_mov_b32 s30, 268435456
	s_mov_b32 s31, 0x20000
	s_lshl_b32 s3, s63, 9
	s_add_u32 s3, s3, s69
	buffer_load_dword v231, off, s[28:31], 0 sc1
	buffer_store_dwordx2 v[244:245], v3, s[28:31], s3 offen sc1
	s_add_u32 s3, s3, 524288
	buffer_store_dwordx2 v[244:245], v3, s[28:31], s3 offen sc1
	s_mov_b32 s18, 1605632
	s_mov_b32 s19, 0x20000
	s_mov_b32 s22, 1605632
	s_mov_b32 s23, 0x20000
	s_mov_b32 s14, 401408
	s_mov_b32 s15, 0x20000
	s_mov_b32 s34, 3584
	s_mov_b32 s35, 0x20000
	s_mov_b32 s38, 896
	s_mov_b32 s39, 0x20000
	s_mov_b32 s26, 1835008
	s_mov_b32 s27, 0x20000
	s_mov_b32 s84, 0
	s_mov_b32 s85, -1
	s_mov_b32 s86, 0xf0000000
	s_mov_b32 s87, 0xf0000000
	s_mov_b32 s92, 0x358637bd
	s_mov_b32 s93, 0x3fb8aa3b
	s_mov_b32 s94, 0xffff0000
	s_lshl_b32 s68, s63, 20
	s_add_u32 s68, s68, 2097152
	s_lshl_b32 s3, s64, 18
	s_add_u32 s68, s68, s3
	s_add_u32 s73, s68, 73728
	s_lshl_b32 s3, s62, 2
	s_add_u32 s74, s73, s3
	s_and_b32 s71, s62, 1
	s_lshr_b32 s72, s62, 1
	s_mul_i32 s56, s62, 114688
	s_add_u32 s57, s56, 229376
	s_cmp_ge_u32 s57, 1605632
	s_cselect_b32 s3, 1605632, 0
	s_sub_u32 s57, s57, s3
	s_add_u32 s58, s57, 229376
	s_cmp_ge_u32 s58, 1605632
	s_cselect_b32 s3, 1605632, 0
	s_sub_u32 s58, s58, s3
	s_add_u32 s59, s58, 229376
	s_cmp_ge_u32 s59, 1605632
	s_cselect_b32 s3, 1605632, 0
	s_sub_u32 s59, s59, s3
	s_add_u32 s60, s59, 229376
	s_cmp_ge_u32 s60, 1605632
	s_cselect_b32 s3, 1605632, 0
	s_sub_u32 s60, s60, s3
	s_add_u32 s61, s60, 229376
	s_cmp_ge_u32 s61, 1605632
	s_cselect_b32 s3, 1605632, 0
	s_sub_u32 s61, s61, s3
	s_add_u32 s75, s61, 229376
	s_cmp_ge_u32 s75, 1605632
	s_cselect_b32 s3, 1605632, 0
	s_sub_u32 s75, s75, s3
	v_lshlrev_b32 v2, 2, v1
	v_and_b32 v5, 60, v2
	v_min_u32 v6, 52, v5
	v_lshl_add_u32 v15, v97, 1, s71
	s_xor_b32 s3, s62, 1
	v_mov_b32 v103, s3
	v_cmp_eq_u32 vcc, 7, v97
	s_nop 1
	v_cndmask_b32 v15, v15, v103, vcc
	v_lshlrev_b32 v15, 2, v15
	v_add_u32 v22, 0x10000, v21
	v_add_u32 v23, 0x20000, v21
	v_bfe_u32 v102, v1, 2, 3
	v_mul_u32_u24 v7, 3584, v102
	v_lshl_add_u32 v7, v100, 6, v7
	v_lshl_add_u32 v7, v99, 4, v7
	s_lshl_b32 s51, s62, 8
	s_mul_i32 s3, s64, 28672
	s_add_u32 s3, s3, s51
	v_add_u32 v7, s3, v7
	s_xor_b32 s3, s71, 1
	v_xor_b32 v103, s3, v100
	v_mul_u32_u24 v8, 896, v102
	v_lshl_add_u32 v8, v103, 6, v8
	v_lshl_add_u32 v8, v99, 4, v8
	s_lshl_b32 s51, s72, 7
	s_mul_i32 s3, s64, 7168
	s_add_u32 s3, s3, s51
	v_add_u32 v8, s3, v8
	s_lshl_b32 s3, s64, 12
	s_add_u32 s3, s3, 143360
	v_add_u32 v9, s3, v4
	s_add_u32 s51, s90, 143360
	v_add_u32 v10, s51, v4
	s_lshr_b32 s3, s90, 1
	s_add_u32 s3, s3, 143360
	v_add_u32 v107, s3, v2
	v_add_u32 v108, 143360, v2
	v_and_b32 v102, 15, v1
	v_lshlrev_b32 v102, 7, v102
	s_lshl_b32 s3, s62, 11
	v_add_u32 v16, s3, v102
	v_add_u32 v103, 32768, v16
	s_mov_b32 s88, 0xffff0000
	s_mov_b32 s89, 0
	v_cndmask_b32 v16, v16, v103, s[88:89]
	v_add_u32 v103, 73472, v102
	s_mov_b32 s88, 0
	s_mov_b32 s89, 0xfffc
	v_cndmask_b32 v16, v16, v103, s[88:89]
	s_lshl_b32 s3, s62, 8
	s_add_u32 s3, s3, 61440
	v_add_u32 v103, s3, v102
	s_mov_b32 s89, 3
	v_cndmask_b32 v16, v16, v103, s[88:89]
	s_lshl_b32 s3, s64, 11
	s_lshl_b32 s51, s63, 7
	s_add_u32 s3, s3, s51
	s_add_u32 s3, s3, 65536
	v_add_u32 v230, s70, v102
	v_lshl_add_u32 v103, v102, 6, s3
	s_mov_b32 s88, 0xffff0000
	s_mov_b32 s89, 0xffff0000
	v_cndmask_b32 v230, v230, v103, s[88:89]
	s_lshr_b32 s48, s78, 5
	s_add_u32 s48, s48, s96
	s_add_u32 m0, s66, 32768
	s_nop 0
	buffer_load_dwordx4 v224, s[4:7], s48 offen nt lds
	s_add_u32 m0, s66, 33792
	s_nop 0
	buffer_load_dwordx4 v225, s[4:7], s48 offen nt lds
	s_add_u32 m0, s66, 34816
	s_nop 0
	buffer_load_dwordx4 v226, s[4:7], s48 offen nt lds
	s_add_u32 m0, s66, 35840
	s_nop 0
	buffer_load_dwordx4 v227, s[4:7], s48 offen nt lds
	s_mul_i32 s49, s77, 42
	s_add_u32 s49, s49, s47
	s_add_u32 m0, s90, 4096
	s_add_u32 s50, s49, 896
	buffer_load_dwordx4 v228, s[8:11], s50 offen  lds
	s_add_u32 m0, s90, 32768
	s_add_u32 s50, s49, 1792
	buffer_load_dwordx4 v228, s[8:11], s50 offen  lds
	s_waitcnt vmcnt(15)
	ds_read_b64 a[0:1], v232 offset:0
	ds_read_b64 a[2:3], v233 offset:0
	ds_read_b64 a[4:5], v234 offset:0
	ds_read_b64 a[6:7], v235 offset:0
	ds_read_b64 a[8:9], v236 offset:0
	ds_read_b64 a[10:11], v237 offset:0
	ds_read_b64 a[12:13], v238 offset:0
	ds_read_b64 a[14:15], v239 offset:0
	s_waitcnt vmcnt(9)
	s_barrier
	ds_read_b64_tr_b16 v[72:73], v21 offset:0
	ds_read_b64_tr_b16 v[74:75], v21 offset:512
	ds_read_b64_tr_b16 v[76:77], v21 offset:28672
	ds_read_b64_tr_b16 v[78:79], v21 offset:29184
	ds_read_b64_tr_b16 v[80:81], v21 offset:1024
	ds_read_b64_tr_b16 v[82:83], v21 offset:1536
	ds_read_b64_tr_b16 v[84:85], v21 offset:29696
	ds_read_b64_tr_b16 v[86:87], v21 offset:30208
	s_waitcnt lgkmcnt(14)
	v_mfma_f32_32x32x16_bf16 v[144:159], v[240:243], a[0:3], 0
	v_mfma_f32_32x32x16_bf16 v[160:175], a[0:3], a[0:3], 0
	s_waitcnt lgkmcnt(12)
	v_mfma_f32_32x32x16_bf16 v[144:159], v[240:243], a[4:7], v[144:159]
	v_mfma_f32_32x32x16_bf16 v[160:175], a[4:7], a[4:7], v[160:175]
	s_waitcnt lgkmcnt(10)
	v_mfma_f32_32x32x16_bf16 v[144:159], v[240:243], a[8:11], v[144:159]
	v_mfma_f32_32x32x16_bf16 v[160:175], a[8:11], a[8:11], v[160:175]
	s_waitcnt lgkmcnt(8)
	v_mfma_f32_32x32x16_bf16 v[144:159], v[240:243], a[12:15], v[144:159]
	v_mfma_f32_32x32x16_bf16 v[160:175], a[12:15], a[12:15], v[160:175]
	s_waitcnt lgkmcnt(4)
	v_mfma_f32_32x32x16_bf16 v[112:127], a[0:3], v[72:75], 0
	ds_read_b64_tr_b16 v[88:89], v21 offset:2048
	ds_read_b64_tr_b16 v[90:91], v21 offset:2560
	ds_read_b64 a[16:17], v232 offset:16384
	ds_read_b64 a[18:19], v233 offset:16384
	v_mfma_f32_32x32x16_bf16 v[128:143], a[0:3], v[76:79], 0
	ds_read_b64_tr_b16 v[92:93], v21 offset:30720
	ds_read_b64_tr_b16 v[94:95], v21 offset:31232
	ds_read_b64 a[20:21], v234 offset:16384
	ds_read_b64 a[22:23], v235 offset:16384
	s_waitcnt lgkmcnt(8)
	v_mfma_f32_32x32x16_bf16 v[112:127], a[4:7], v[80:83], v[112:127]
	ds_read_b64_tr_b16 v[72:73], v21 offset:3072
	ds_read_b64_tr_b16 v[74:75], v21 offset:3584
	ds_read_b64 a[24:25], v236 offset:16384
	ds_read_b64 a[26:27], v237 offset:16384
	v_mfma_f32_32x32x16_bf16 v[128:143], a[4:7], v[84:87], v[128:143]
	ds_read_b64_tr_b16 v[76:77], v21 offset:31744
	ds_read_b64_tr_b16 v[78:79], v21 offset:32256
	ds_read_b64 a[28:29], v238 offset:16384
	ds_read_b64 a[30:31], v239 offset:16384
	ds_read_b64_tr_b16 v[176:177], v246 offset:0
	s_waitcnt lgkmcnt(11)
	v_mfma_f32_32x32x16_bf16 v[112:127], a[8:11], v[88:91], v[112:127]
	ds_read_b64_tr_b16 v[178:179], v246 offset:512
	ds_read_b64_tr_b16 v[180:181], v246 offset:28672
	v_mfma_f32_32x32x16_bf16 v[128:143], a[8:11], v[92:95], v[128:143]
	ds_read_b64_tr_b16 v[182:183], v246 offset:29184
	ds_read_b128 a[128:131], v106 offset:0
	s_waitcnt lgkmcnt(7)
	v_mfma_f32_32x32x16_bf16 v[112:127], a[12:15], v[72:75], v[112:127]
	ds_read_b128 a[156:159], v106 offset:28672
	s_lshr_b32 s48, s79, 5
	s_add_u32 s48, s48, s96
	v_mfma_f32_32x32x16_bf16 v[128:143], a[12:15], v[76:79], v[128:143]
	s_add_u32 m0, s66, 0
	s_nop 0
	buffer_load_dwordx4 v224, s[4:7], s48 offen nt lds
	s_waitcnt lgkmcnt(4)
	v_mfma_f32_32x32x16_bf16 v[192:207], v[240:243], v[176:179], 0
	s_add_u32 m0, s66, 1024
	s_nop 0
	buffer_load_dwordx4 v225, s[4:7], s48 offen nt lds
	s_waitcnt lgkmcnt(2)
	v_mfma_f32_32x32x16_bf16 v[208:223], v[240:243], v[180:183], 0
	s_add_u32 m0, s66, 2048
	s_nop 0
	buffer_load_dwordx4 v226, s[4:7], s48 offen nt lds
	v_mfma_f32_32x32x16_bf16 v[144:159], v[240:243], a[16:19], v[144:159]
	s_add_u32 m0, s66, 3072
	s_nop 0
	buffer_load_dwordx4 v227, s[4:7], s48 offen nt lds
	s_mul_i32 s49, s78, 42
	v_mfma_f32_32x32x16_bf16 v[160:175], a[16:19], a[16:19], v[160:175]
	s_add_u32 s49, s49, s47
	s_add_u32 m0, s90, 8192
	v_mfma_f32_32x32x16_bf16 v[144:159], v[240:243], a[20:23], v[144:159]
	s_add_u32 s50, s49, 896
	buffer_load_dwordx4 v228, s[8:11], s50 offen  lds
	v_mfma_f32_32x32x16_bf16 v[160:175], a[20:23], a[20:23], v[160:175]
	s_add_u32 m0, s90, 36864
	s_add_u32 s50, s49, 1792
	buffer_load_dwordx4 v228, s[8:11], s50 offen  lds
	s_waitcnt vmcnt(6)
	s_barrier
	ds_read_b64_tr_b16 v[72:73], v21 offset:4096
	ds_read_b64_tr_b16 v[74:75], v21 offset:4608
	ds_read_b64_tr_b16 v[76:77], v21 offset:32768
	ds_read_b64_tr_b16 v[78:79], v21 offset:33280
	ds_read_b64_tr_b16 v[80:81], v21 offset:5120
	ds_read_b64_tr_b16 v[82:83], v21 offset:5632
	ds_read_b64_tr_b16 v[84:85], v21 offset:33792
	ds_read_b64_tr_b16 v[86:87], v21 offset:34304
	v_mfma_f32_32x32x16_bf16 v[144:159], v[240:243], a[24:27], v[144:159]
	v_mfma_f32_32x32x16_bf16 v[160:175], a[24:27], a[24:27], v[160:175]
	v_mfma_f32_32x32x16_bf16 v[144:159], v[240:243], a[28:31], v[144:159]
	v_mfma_f32_32x32x16_bf16 v[160:175], a[28:31], a[28:31], v[160:175]
	s_waitcnt lgkmcnt(4)
	v_mfma_f32_32x32x16_bf16 v[112:127], a[16:19], v[72:75], v[112:127]
	ds_read_b64_tr_b16 v[88:89], v21 offset:6144
	ds_read_b64_tr_b16 v[90:91], v21 offset:6656
	ds_read_b64 a[32:33], v232 offset:32768
	ds_read_b64 a[34:35], v233 offset:32768
	ds_read_b64 a[36:37], v234 offset:32768
	v_mfma_f32_32x32x16_bf16 v[128:143], a[16:19], v[76:79], v[128:143]
	ds_read_b64_tr_b16 v[92:93], v21 offset:34816
	ds_read_b64_tr_b16 v[94:95], v21 offset:35328
	ds_read_b64 a[38:39], v235 offset:32768
	ds_read_b64 a[40:41], v236 offset:32768
	ds_read_b64 a[42:43], v237 offset:32768
	s_waitcnt lgkmcnt(10)
	v_mfma_f32_32x32x16_bf16 v[112:127], a[20:23], v[80:83], v[112:127]
	ds_read_b64_tr_b16 v[72:73], v21 offset:7168
	ds_read_b64_tr_b16 v[74:75], v21 offset:7680
	ds_read_b64 a[44:45], v238 offset:32768
	ds_read_b64 a[46:47], v239 offset:32768
	ds_read_b64_tr_b16 v[176:177], v246 offset:4096
	v_mfma_f32_32x32x16_bf16 v[128:143], a[20:23], v[84:87], v[128:143]
	ds_read_b64_tr_b16 v[76:77], v21 offset:35840
	ds_read_b64_tr_b16 v[78:79], v21 offset:36352
	ds_read_b64_tr_b16 v[178:179], v246 offset:4608
	ds_read_b64_tr_b16 v[180:181], v246 offset:32768
	ds_read_b64_tr_b16 v[182:183], v246 offset:33280
	s_waitcnt lgkmcnt(13)
	v_mfma_f32_32x32x16_bf16 v[112:127], a[24:27], v[88:91], v[112:127]
	ds_read_b128 a[132:135], v106 offset:4096
	ds_read_b128 a[160:163], v106 offset:32768
	s_lshr_b32 s48, s80, 5
	s_add_u32 s48, s48, s96
	v_mfma_f32_32x32x16_bf16 v[128:143], a[24:27], v[92:95], v[128:143]
	s_add_u32 m0, s66, 16384
	s_nop 0
	buffer_load_dwordx4 v224, s[4:7], s48 offen nt lds
	s_add_u32 m0, s66, 17408
	s_waitcnt lgkmcnt(5)
	v_mfma_f32_32x32x16_bf16 v[112:127], a[28:31], v[72:75], v[112:127]
	buffer_load_dwordx4 v225, s[4:7], s48 offen nt lds
	s_add_u32 m0, s66, 18432
	s_nop 0
	buffer_load_dwordx4 v226, s[4:7], s48 offen nt lds
	v_mfma_f32_32x32x16_bf16 v[128:143], a[28:31], v[76:79], v[128:143]
	s_add_u32 m0, s66, 19456
	s_nop 0
	buffer_load_dwordx4 v227, s[4:7], s48 offen nt lds
	s_mul_i32 s49, s79, 42
	s_waitcnt lgkmcnt(4)
	v_mfma_f32_32x32x16_bf16 v[192:207], v[240:243], v[176:179], v[192:207]
	s_add_u32 s49, s49, s47
	s_add_u32 m0, s90, 12288
	s_add_u32 s50, s49, 896
	buffer_load_dwordx4 v228, s[8:11], s50 offen  lds
	s_waitcnt lgkmcnt(2)
	v_mfma_f32_32x32x16_bf16 v[208:223], v[240:243], v[180:183], v[208:223]
	s_add_u32 m0, s90, 40960
	s_add_u32 s50, s49, 1792
	buffer_load_dwordx4 v228, s[8:11], s50 offen  lds
	v_mfma_f32_32x32x16_bf16 v[144:159], v[240:243], a[32:35], v[144:159]
	v_readfirstlane_b32 s3, v231
	s_getreg_b32 s97, hwreg(HW_REG_XCC_ID, 0, 4)
	s_mul_i32 s65, s3, 1664525
	v_mfma_f32_32x32x16_bf16 v[160:175], a[32:35], a[32:35], v[160:175]
	s_add_u32 s65, s65, 1013904223
	v_mov_b32 v11, s65
	s_add_u32 s51, s97, s65
	v_mfma_f32_32x32x16_bf16 v[144:159], v[240:243], a[36:39], v[144:159]
	v_mov_b32 v229, s51
	s_lshl_b32 s51, s63, 7
	s_add_u32 s51, s51, s70
	v_mfma_f32_32x32x16_bf16 v[160:175], a[36:39], a[36:39], v[160:175]
	s_mov_b64 exec, 1
	buffer_store_dword v229, off, s[28:31], s51 sc1
	s_mov_b64 exec, -1
	s_waitcnt vmcnt(7)
	s_barrier
	ds_read_b64_tr_b16 v[72:73], v21 offset:8192
	ds_read_b64_tr_b16 v[74:75], v21 offset:8704
	ds_read_b64_tr_b16 v[76:77], v21 offset:36864
	ds_read_b64_tr_b16 v[78:79], v21 offset:37376
	ds_read_b64_tr_b16 v[80:81], v21 offset:9216
	ds_read_b64_tr_b16 v[82:83], v21 offset:9728
	ds_read_b64_tr_b16 v[84:85], v21 offset:37888
	ds_read_b64_tr_b16 v[86:87], v21 offset:38400
	v_mfma_f32_32x32x16_bf16 v[144:159], v[240:243], a[40:43], v[144:159]
	v_mfma_f32_32x32x16_bf16 v[160:175], a[40:43], a[40:43], v[160:175]
	v_mfma_f32_32x32x16_bf16 v[144:159], v[240:243], a[44:47], v[144:159]
	v_mfma_f32_32x32x16_bf16 v[160:175], a[44:47], a[44:47], v[160:175]
	s_waitcnt lgkmcnt(4)
	v_mfma_f32_32x32x16_bf16 v[112:127], a[32:35], v[72:75], v[112:127]
	ds_read_b64_tr_b16 v[88:89], v21 offset:10240
	ds_read_b64_tr_b16 v[90:91], v21 offset:10752
	ds_read_b64 a[48:49], v232 offset:0
	ds_read_b64 a[50:51], v233 offset:0
	v_mfma_f32_32x32x16_bf16 v[128:143], a[32:35], v[76:79], v[128:143]
	ds_read_b64_tr_b16 v[92:93], v21 offset:38912
	ds_read_b64_tr_b16 v[94:95], v21 offset:39424
	ds_read_b64 a[52:53], v234 offset:0
	ds_read_b64 a[54:55], v235 offset:0
	s_waitcnt lgkmcnt(8)
	v_mfma_f32_32x32x16_bf16 v[112:127], a[36:39], v[80:83], v[112:127]
	ds_read_b64_tr_b16 v[72:73], v21 offset:11264
	ds_read_b64_tr_b16 v[74:75], v21 offset:11776
	ds_read_b64 a[56:57], v236 offset:0
	ds_read_b64 a[58:59], v237 offset:0
	v_mfma_f32_32x32x16_bf16 v[128:143], a[36:39], v[84:87], v[128:143]
	ds_read_b64_tr_b16 v[76:77], v21 offset:39936
	ds_read_b64_tr_b16 v[78:79], v21 offset:40448
	ds_read_b64 a[60:61], v238 offset:0
	ds_read_b64 a[62:63], v239 offset:0
	ds_read_b64_tr_b16 v[176:177], v246 offset:8192
	s_waitcnt lgkmcnt(11)
	v_mfma_f32_32x32x16_bf16 v[112:127], a[40:43], v[88:91], v[112:127]
	ds_read_b64_tr_b16 v[178:179], v246 offset:8704
	ds_read_b64_tr_b16 v[180:181], v246 offset:36864
	v_mfma_f32_32x32x16_bf16 v[128:143], a[40:43], v[92:95], v[128:143]
	ds_read_b64_tr_b16 v[182:183], v246 offset:37376
	ds_read_b128 a[136:139], v106 offset:8192
	s_waitcnt lgkmcnt(7)
	v_mfma_f32_32x32x16_bf16 v[112:127], a[44:47], v[72:75], v[112:127]
	ds_read_b128 a[164:167], v106 offset:36864
	s_lshr_b32 s48, s81, 5
	s_add_u32 s48, s48, s96
	v_mfma_f32_32x32x16_bf16 v[128:143], a[44:47], v[76:79], v[128:143]
	s_add_u32 m0, s66, 32768
	s_nop 0
	buffer_load_dwordx4 v224, s[4:7], s48 offen nt lds
	s_waitcnt lgkmcnt(4)
	v_mfma_f32_32x32x16_bf16 v[192:207], v[240:243], v[176:179], v[192:207]
	s_add_u32 m0, s66, 33792
	s_nop 0
	buffer_load_dwordx4 v225, s[4:7], s48 offen nt lds
	s_waitcnt lgkmcnt(2)
	v_mfma_f32_32x32x16_bf16 v[208:223], v[240:243], v[180:183], v[208:223]
	s_add_u32 m0, s66, 34816
	s_nop 0
	buffer_load_dwordx4 v226, s[4:7], s48 offen nt lds
	v_mfma_f32_32x32x16_bf16 v[144:159], v[240:243], a[48:51], v[144:159]
	s_add_u32 m0, s66, 35840
	s_nop 0
	buffer_load_dwordx4 v227, s[4:7], s48 offen nt lds
	s_mul_i32 s49, s80, 42
	v_mfma_f32_32x32x16_bf16 v[160:175], a[48:51], a[48:51], v[160:175]
	s_add_u32 s49, s49, s47
	s_add_u32 m0, s90, 16384
	v_mfma_f32_32x32x16_bf16 v[144:159], v[240:243], a[52:55], v[144:159]
	s_add_u32 s50, s49, 896
	buffer_load_dwordx4 v228, s[8:11], s50 offen  lds
	v_mfma_f32_32x32x16_bf16 v[160:175], a[52:55], a[52:55], v[160:175]
	s_add_u32 m0, s90, 45056
	s_add_u32 s50, s49, 1792
	buffer_load_dwordx4 v228, s[8:11], s50 offen  lds
	s_waitcnt vmcnt(7)
	s_barrier
	ds_read_b64_tr_b16 v[72:73], v21 offset:12288
	ds_read_b64_tr_b16 v[74:75], v21 offset:12800
	ds_read_b64_tr_b16 v[76:77], v21 offset:40960
	ds_read_b64_tr_b16 v[78:79], v21 offset:41472
	ds_read_b64_tr_b16 v[80:81], v21 offset:13312
	ds_read_b64_tr_b16 v[82:83], v21 offset:13824
	ds_read_b64_tr_b16 v[84:85], v21 offset:41984
	ds_read_b64_tr_b16 v[86:87], v21 offset:42496
	v_mfma_f32_32x32x16_bf16 v[144:159], v[240:243], a[56:59], v[144:159]
	v_mfma_f32_32x32x16_bf16 v[160:175], a[56:59], a[56:59], v[160:175]
	v_mfma_f32_32x32x16_bf16 v[144:159], v[240:243], a[60:63], v[144:159]
	v_mfma_f32_32x32x16_bf16 v[160:175], a[60:63], a[60:63], v[160:175]
	s_waitcnt lgkmcnt(4)
	v_mfma_f32_32x32x16_bf16 v[112:127], a[48:51], v[72:75], v[112:127]
	ds_read_b64_tr_b16 v[88:89], v21 offset:14336
	ds_read_b64_tr_b16 v[90:91], v21 offset:14848
	ds_read_b64 a[64:65], v232 offset:16384
	ds_read_b64 a[66:67], v233 offset:16384
	ds_read_b64 a[68:69], v234 offset:16384
	v_mfma_f32_32x32x16_bf16 v[128:143], a[48:51], v[76:79], v[128:143]
	ds_read_b64_tr_b16 v[92:93], v21 offset:43008
	ds_read_b64_tr_b16 v[94:95], v21 offset:43520
	ds_read_b64 a[70:71], v235 offset:16384
	ds_read_b64 a[72:73], v236 offset:16384
	ds_read_b64 a[74:75], v237 offset:16384
	s_waitcnt lgkmcnt(10)
	v_mfma_f32_32x32x16_bf16 v[112:127], a[52:55], v[80:83], v[112:127]
	ds_read_b64_tr_b16 v[72:73], v21 offset:15360
	ds_read_b64_tr_b16 v[74:75], v21 offset:15872
	ds_read_b64 a[76:77], v238 offset:16384
	ds_read_b64 a[78:79], v239 offset:16384
	ds_read_b64_tr_b16 v[176:177], v246 offset:12288
	v_mfma_f32_32x32x16_bf16 v[128:143], a[52:55], v[84:87], v[128:143]
	ds_read_b64_tr_b16 v[76:77], v21 offset:44032
	ds_read_b64_tr_b16 v[78:79], v21 offset:44544
	ds_read_b64_tr_b16 v[178:179], v246 offset:12800
	ds_read_b64_tr_b16 v[180:181], v246 offset:40960
	ds_read_b64_tr_b16 v[182:183], v246 offset:41472
	s_waitcnt lgkmcnt(13)
	v_mfma_f32_32x32x16_bf16 v[112:127], a[56:59], v[88:91], v[112:127]
	ds_read_b128 a[140:143], v106 offset:12288
	ds_read_b128 a[168:171], v106 offset:40960
	s_lshr_b32 s48, s82, 5
	v_mfma_f32_32x32x16_bf16 v[128:143], a[56:59], v[92:95], v[128:143]
	s_add_u32 s48, s48, s96
	s_add_u32 m0, s66, 0
	s_nop 0
	buffer_load_dwordx4 v224, s[4:7], s48 offen nt lds
	s_waitcnt lgkmcnt(5)
	v_mfma_f32_32x32x16_bf16 v[112:127], a[60:63], v[72:75], v[112:127]
	s_add_u32 m0, s66, 1024
	s_nop 0
	buffer_load_dwordx4 v225, s[4:7], s48 offen nt lds
	s_add_u32 m0, s66, 2048
	v_mfma_f32_32x32x16_bf16 v[128:143], a[60:63], v[76:79], v[128:143]
	buffer_load_dwordx4 v226, s[4:7], s48 offen nt lds
	s_add_u32 m0, s66, 3072
	s_nop 0
	buffer_load_dwordx4 v227, s[4:7], s48 offen nt lds
	s_waitcnt lgkmcnt(4)
	v_mfma_f32_32x32x16_bf16 v[192:207], v[240:243], v[176:179], v[192:207]
	s_mul_i32 s49, s81, 42
	s_add_u32 s49, s49, s47
	s_add_u32 m0, s90, 20480
	s_waitcnt lgkmcnt(2)
	v_mfma_f32_32x32x16_bf16 v[208:223], v[240:243], v[180:183], v[208:223]
	s_add_u32 s50, s49, 896
	buffer_load_dwordx4 v228, s[8:11], s50 offen  lds
	s_add_u32 m0, s90, 49152
	v_mfma_f32_32x32x16_bf16 v[144:159], v[240:243], a[64:67], v[144:159]
	s_add_u32 s50, s49, 1792
	buffer_load_dwordx4 v228, s[8:11], s50 offen  lds
	s_lshl_b32 s3, s2, 2
	v_mfma_f32_32x32x16_bf16 v[160:175], a[64:67], a[64:67], v[160:175]
	s_add_u32 s3, s3, s64
	s_mul_i32 s51, s3, 1664
	v_min_u32 v254, 12, v1
	v_mfma_f32_32x32x16_bf16 v[144:159], v[240:243], a[68:71], v[144:159]
	v_lshlrev_b32 v254, 7, v254
	buffer_load_dword v17, v254, s[16:19], s51 offen
	buffer_load_dword v17, v254, s[20:23], s51 offen
	v_mfma_f32_32x32x16_bf16 v[160:175], a[68:71], a[68:71], v[160:175]
	v_and_b32 v254, 0x180, v254
	s_lshl_b32 s51, s3, 9
	buffer_load_dword v17, v254, s[12:15], s51 offen
	s_waitcnt vmcnt(9)
	s_barrier
	ds_read_b64_tr_b16 v[72:73], v21 offset:16384
	ds_read_b64_tr_b16 v[74:75], v21 offset:16896
	ds_read_b64_tr_b16 v[76:77], v21 offset:45056
	ds_read_b64_tr_b16 v[78:79], v21 offset:45568
	ds_read_b64_tr_b16 v[80:81], v21 offset:17408
	ds_read_b64_tr_b16 v[82:83], v21 offset:17920
	ds_read_b64_tr_b16 v[84:85], v21 offset:46080
	ds_read_b64_tr_b16 v[86:87], v21 offset:46592
	v_mfma_f32_32x32x16_bf16 v[144:159], v[240:243], a[72:75], v[144:159]
	v_mfma_f32_32x32x16_bf16 v[160:175], a[72:75], a[72:75], v[160:175]
	v_mfma_f32_32x32x16_bf16 v[144:159], v[240:243], a[76:79], v[144:159]
	v_mfma_f32_32x32x16_bf16 v[160:175], a[76:79], a[76:79], v[160:175]
	s_waitcnt lgkmcnt(4)
	v_mfma_f32_32x32x16_bf16 v[112:127], a[64:67], v[72:75], v[112:127]
	ds_read_b64_tr_b16 v[88:89], v21 offset:18432
	ds_read_b64_tr_b16 v[90:91], v21 offset:18944
	ds_read_b64 a[80:81], v232 offset:32768
	ds_read_b64 a[82:83], v233 offset:32768
	ds_read_b64 a[84:85], v234 offset:32768
	v_mfma_f32_32x32x16_bf16 v[128:143], a[64:67], v[76:79], v[128:143]
	ds_read_b64_tr_b16 v[92:93], v21 offset:47104
	ds_read_b64_tr_b16 v[94:95], v21 offset:47616
	ds_read_b64 a[86:87], v235 offset:32768
	ds_read_b64 a[88:89], v236 offset:32768
	ds_read_b64 a[90:91], v237 offset:32768
	ds_read_b64 a[92:93], v238 offset:32768
	s_waitcnt lgkmcnt(11)
	v_mfma_f32_32x32x16_bf16 v[112:127], a[68:71], v[80:83], v[112:127]
	ds_read_b64_tr_b16 v[72:73], v21 offset:19456
	ds_read_b64_tr_b16 v[74:75], v21 offset:19968
	ds_read_b64 a[94:95], v239 offset:32768
	ds_read_b64_tr_b16 v[176:177], v246 offset:16384
	ds_read_b64_tr_b16 v[178:179], v246 offset:16896
	v_mfma_f32_32x32x16_bf16 v[128:143], a[68:71], v[84:87], v[128:143]
	ds_read_b64_tr_b16 v[76:77], v21 offset:48128
	ds_read_b64_tr_b16 v[78:79], v21 offset:48640
	ds_read_b64_tr_b16 v[180:181], v246 offset:45056
	ds_read_b64_tr_b16 v[182:183], v246 offset:45568
	ds_read_b128 a[144:147], v106 offset:16384
	ds_read_b128 a[172:175], v106 offset:45056
	s_waitcnt lgkmcnt(15)
	v_mfma_f32_32x32x16_bf16 v[112:127], a[72:75], v[88:91], v[112:127]
	s_mul_i32 s49, s82, 42
	s_add_u32 s49, s49, s47
	s_add_u32 m0, s90, 24576
	v_mfma_f32_32x32x16_bf16 v[128:143], a[72:75], v[92:95], v[128:143]
	s_add_u32 s50, s49, 896
	buffer_load_dwordx4 v228, s[8:11], s50 offen  lds
	s_add_u32 m0, s90, 53248
	s_add_u32 s50, s49, 1792
	s_waitcnt lgkmcnt(4)
	v_mfma_f32_32x32x16_bf16 v[112:127], a[76:79], v[72:75], v[112:127]
	buffer_load_dwordx4 v228, s[8:11], s50 offen  lds
	v_lshlrev_b32 v102, 2, v100
	v_sub_u32 v102, v101, v102
	v_mfma_f32_32x32x16_bf16 v[128:143], a[76:79], v[76:79], v[128:143]
	v_mov_b32 v105, 0x3f80
	v_subrev_u32 v103, 0, v102
	v_cmp_gt_u32 vcc, 2, v103
	v_lshlrev_b32 v104, 4, v103
	v_mfma_f32_32x32x16_bf16 v[192:207], v[240:243], v[176:179], v[192:207]
	v_lshlrev_b32 v104, v104, v105
	v_cndmask_b32 v104, 0, v104, vcc
	v_accvgpr_write_b32 a240, v104
	s_waitcnt lgkmcnt(2)
	v_mfma_f32_32x32x16_bf16 v[208:223], v[240:243], v[180:183], v[208:223]
	v_subrev_u32 v103, 2, v102
	v_cmp_gt_u32 vcc, 2, v103
	v_lshlrev_b32 v104, 4, v103
	v_lshlrev_b32 v104, v104, v105
	v_mfma_f32_32x32x16_bf16 v[144:159], v[240:243], a[80:83], v[144:159]
	v_cndmask_b32 v104, 0, v104, vcc
	v_accvgpr_write_b32 a241, v104
	v_subrev_u32 v103, 8, v102
	v_mfma_f32_32x32x16_bf16 v[160:175], a[80:83], a[80:83], v[160:175]
	v_cmp_gt_u32 vcc, 2, v103
	v_lshlrev_b32 v104, 4, v103
	v_lshlrev_b32 v104, v104, v105
	v_cndmask_b32 v104, 0, v104, vcc
	v_mfma_f32_32x32x16_bf16 v[144:159], v[240:243], a[84:87], v[144:159]
	v_accvgpr_write_b32 a242, v104
	v_subrev_u32 v103, 10, v102
	v_cmp_gt_u32 vcc, 2, v103
	v_mfma_f32_32x32x16_bf16 v[160:175], a[84:87], a[84:87], v[160:175]
	v_lshlrev_b32 v104, 4, v103
	v_lshlrev_b32 v104, v104, v105
	v_cndmask_b32 v104, 0, v104, vcc
	v_accvgpr_write_b32 a243, v104
	s_waitcnt vmcnt(5)
	s_barrier
	ds_read_b64_tr_b16 v[72:73], v21 offset:20480
	ds_read_b64_tr_b16 v[74:75], v21 offset:20992
	ds_read_b64_tr_b16 v[76:77], v21 offset:49152
	ds_read_b64_tr_b16 v[78:79], v21 offset:49664
	ds_read_b64_tr_b16 v[80:81], v21 offset:21504
	ds_read_b64_tr_b16 v[82:83], v21 offset:22016
	ds_read_b64_tr_b16 v[84:85], v21 offset:50176
	ds_read_b64_tr_b16 v[86:87], v21 offset:50688
	v_mfma_f32_32x32x16_bf16 v[144:159], v[240:243], a[88:91], v[144:159]
	v_mfma_f32_32x32x16_bf16 v[160:175], a[88:91], a[88:91], v[160:175]
	v_mfma_f32_32x32x16_bf16 v[144:159], v[240:243], a[92:95], v[144:159]
	v_mfma_f32_32x32x16_bf16 v[160:175], a[92:95], a[92:95], v[160:175]
	s_waitcnt lgkmcnt(4)
	v_mfma_f32_32x32x16_bf16 v[112:127], a[80:83], v[72:75], v[112:127]
	ds_read_b64_tr_b16 v[88:89], v21 offset:22528
	ds_read_b64_tr_b16 v[90:91], v21 offset:23040
	ds_read_b64 a[96:97], v232 offset:0
	ds_read_b64 a[98:99], v233 offset:0
	v_mfma_f32_32x32x16_bf16 v[128:143], a[80:83], v[76:79], v[128:143]
	ds_read_b64_tr_b16 v[92:93], v21 offset:51200
	ds_read_b64_tr_b16 v[94:95], v21 offset:51712
	ds_read_b64 a[100:101], v234 offset:0
	ds_read_b64 a[102:103], v235 offset:0
	ds_read_b64 a[104:105], v236 offset:0
	s_waitcnt lgkmcnt(9)
	v_mfma_f32_32x32x16_bf16 v[112:127], a[84:87], v[80:83], v[112:127]
	ds_read_b64_tr_b16 v[72:73], v21 offset:23552
	ds_read_b64_tr_b16 v[74:75], v21 offset:24064
	ds_read_b64 a[106:107], v237 offset:0
	ds_read_b64 a[108:109], v238 offset:0
	ds_read_b64 a[110:111], v239 offset:0
	v_mfma_f32_32x32x16_bf16 v[128:143], a[84:87], v[84:87], v[128:143]
	ds_read_b64_tr_b16 v[76:77], v21 offset:52224
	ds_read_b64_tr_b16 v[78:79], v21 offset:52736
	ds_read_b64_tr_b16 v[176:177], v246 offset:20480
	ds_read_b64_tr_b16 v[178:179], v246 offset:20992
	s_waitcnt lgkmcnt(12)
	v_mfma_f32_32x32x16_bf16 v[112:127], a[88:91], v[88:91], v[112:127]
	ds_read_b64_tr_b16 v[180:181], v246 offset:49152
	ds_read_b64_tr_b16 v[182:183], v246 offset:49664
	ds_read_b128 a[148:151], v106 offset:20480
	v_mfma_f32_32x32x16_bf16 v[128:143], a[88:91], v[92:95], v[128:143]
	ds_read_b128 a[176:179], v106 offset:49152
	v_subrev_u32 v103, 16, v102
	v_cmp_gt_u32 vcc, 2, v103
	s_waitcnt lgkmcnt(6)
	v_mfma_f32_32x32x16_bf16 v[112:127], a[92:95], v[72:75], v[112:127]
	v_lshlrev_b32 v104, 4, v103
	v_lshlrev_b32 v104, v104, v105
	v_cndmask_b32 v104, 0, v104, vcc
	v_mfma_f32_32x32x16_bf16 v[128:143], a[92:95], v[76:79], v[128:143]
	v_accvgpr_write_b32 a244, v104
	v_subrev_u32 v103, 18, v102
	s_waitcnt lgkmcnt(4)
	v_mfma_f32_32x32x16_bf16 v[192:207], v[240:243], v[176:179], v[192:207]
	v_cmp_gt_u32 vcc, 2, v103
	v_lshlrev_b32 v104, 4, v103
	v_lshlrev_b32 v104, v104, v105
	s_waitcnt lgkmcnt(2)
	v_mfma_f32_32x32x16_bf16 v[208:223], v[240:243], v[180:183], v[208:223]
	v_cndmask_b32 v104, 0, v104, vcc
	v_accvgpr_write_b32 a245, v104
	v_subrev_u32 v103, 24, v102
	v_mfma_f32_32x32x16_bf16 v[144:159], v[240:243], a[96:99], v[144:159]
	v_cmp_gt_u32 vcc, 2, v103
	v_lshlrev_b32 v104, 4, v103
	v_mfma_f32_32x32x16_bf16 v[160:175], a[96:99], a[96:99], v[160:175]
	v_lshlrev_b32 v104, v104, v105
	v_cndmask_b32 v104, 0, v104, vcc
	v_accvgpr_write_b32 a246, v104
	v_mfma_f32_32x32x16_bf16 v[144:159], v[240:243], a[100:103], v[144:159]
	v_subrev_u32 v103, 26, v102
	v_cmp_gt_u32 vcc, 2, v103
	v_lshlrev_b32 v104, 4, v103
	v_mfma_f32_32x32x16_bf16 v[160:175], a[100:103], a[100:103], v[160:175]
	v_lshlrev_b32 v104, v104, v105
	v_cndmask_b32 v104, 0, v104, vcc
	v_accvgpr_write_b32 a247, v104
	ds_write_b32 v107, v192
	ds_write_b32 v107, v208 offset:256
	s_waitcnt lgkmcnt(0) vmcnt(0)
	s_barrier
	ds_read_b64_tr_b16 v[72:73], v21 offset:24576
	ds_read_b64_tr_b16 v[74:75], v21 offset:25088
	ds_read_b64_tr_b16 v[76:77], v21 offset:53248
	ds_read_b64_tr_b16 v[78:79], v21 offset:53760
	ds_read_b64_tr_b16 v[80:81], v21 offset:25600
	ds_read_b64_tr_b16 v[82:83], v21 offset:26112
	ds_read_b64_tr_b16 v[84:85], v21 offset:54272
	ds_read_b64_tr_b16 v[86:87], v21 offset:54784
	buffer_load_dword v229, v230, s[28:31], 0 offen sc1
	v_mfma_f32_32x32x16_bf16 v[144:159], v[240:243], a[104:107], v[144:159]
	v_mfma_f32_32x32x16_bf16 v[160:175], a[104:107], a[104:107], v[160:175]
	v_mfma_f32_32x32x16_bf16 v[144:159], v[240:243], a[108:111], v[144:159]
	v_mfma_f32_32x32x16_bf16 v[160:175], a[108:111], a[108:111], v[160:175]
	s_waitcnt lgkmcnt(4)
	v_mfma_f32_32x32x16_bf16 v[112:127], a[96:99], v[72:75], v[112:127]
	ds_read_b64_tr_b16 v[88:89], v21 offset:26624
	ds_read_b64_tr_b16 v[90:91], v21 offset:27136
	v_mfma_f32_32x32x16_bf16 v[192:207], v[240:243], v[72:75], 0
	s_mul_i32 s52, s76, 42
	s_add_u32 s52, s52, s47
	s_add_u32 m0, s90, 57344
	s_nop 0
	buffer_load_dwordx4 v228, s[8:11], s52 offen  lds
	ds_read_b32 v248, v108 offset:0
	ds_read_b32 v249, v108 offset:512
	ds_read_b32 v250, v108 offset:1024
	ds_read_b32 v251, v108 offset:1536
	v_mfma_f32_32x32x16_bf16 v[128:143], a[96:99], v[76:79], v[128:143]
	ds_read_b64_tr_b16 v[92:93], v21 offset:55296
	ds_read_b64_tr_b16 v[94:95], v21 offset:55808
	ds_read_b32 v252, v108 offset:256
	ds_read_b32 v253, v108 offset:768
	ds_read_b32 v254, v108 offset:1280
	ds_read_b32 v255, v108 offset:1792
	s_mov_b32 s88, 0xaaaaaaaa
	v_mfma_f32_32x32x16_bf16 v[208:223], v[240:243], v[76:79], 0
	s_mov_b32 s89, 0xaaaaaaaa
	v_cndmask_b32 v160, v160, v161, s[88:89]
	v_cndmask_b32 v162, v162, v163, s[88:89]
	v_cndmask_b32 v164, v164, v165, s[88:89]
	s_waitcnt lgkmcnt(12)
	v_mfma_f32_32x32x16_bf16 v[112:127], a[100:103], v[80:83], v[112:127]
	ds_read_b64_tr_b16 v[72:73], v21 offset:27648
	ds_read_b64_tr_b16 v[74:75], v21 offset:28160
	v_cndmask_b32 v166, v166, v167, s[88:89]
	v_cndmask_b32 v168, v168, v169, s[88:89]
	v_cndmask_b32 v170, v170, v171, s[88:89]
	v_cndmask_b32 v172, v172, v173, s[88:89]
	v_cndmask_b32 v174, v174, v175, s[88:89]
	v_mfma_f32_32x32x16_bf16 v[192:207], v[240:243], v[80:83], v[192:207]
	s_mul_i32 s52, s77, 42
	s_add_u32 s52, s52, s47
	s_add_u32 m0, s90, 61440
	s_nop 0
	buffer_load_dwordx4 v228, s[8:11], s52 offen  lds
	s_mov_b32 s88, 0xcccccccc
	s_mov_b32 s89, 0xcccccccc
	v_cndmask_b32 v160, v160, v162, s[88:89]
	v_cndmask_b32 v164, v164, v166, s[88:89]
	v_mfma_f32_32x32x16_bf16 v[128:143], a[100:103], v[84:87], v[128:143]
	ds_read_b64_tr_b16 v[76:77], v21 offset:56320
	ds_read_b64_tr_b16 v[78:79], v21 offset:56832
	v_cndmask_b32 v168, v168, v170, s[88:89]
	v_cndmask_b32 v172, v172, v174, s[88:89]
	s_mov_b32 s88, 0xff00ff00
	s_mov_b32 s89, 0xff00ff00
	v_cndmask_b32 v160, v160, v164, s[88:89]
	v_mfma_f32_32x32x16_bf16 v[208:223], v[240:243], v[84:87], v[208:223]
	v_cndmask_b32 v168, v168, v172, s[88:89]
	s_mov_b32 s88, 0xffff0000
	s_mov_b32 s89, 0xffff0000
	v_cndmask_b32 v160, v160, v168, s[88:89]
	s_waitcnt lgkmcnt(8)
	v_mfma_f32_32x32x16_bf16 v[112:127], a[104:107], v[88:91], v[112:127]
	v_mov_b32 v161, v160
	s_mov_b32 s88, 0xf0f0f0f0
	s_mov_b32 s89, 0xf0f0f0f0
	v_permlane32_swap_b32 v160, v161
	v_cndmask_b32 v160, v160, v161, s[88:89]
	v_mfma_f32_32x32x16_bf16 v[192:207], v[240:243], v[88:91], v[192:207]
	s_mul_i32 s52, s78, 42
	s_add_u32 s52, s52, s47
	s_add_u32 m0, s90, 65536
	s_nop 0
	buffer_load_dwordx4 v228, s[8:11], s52 offen  lds
	ds_read_b128 a[152:155], v106 offset:24576
	ds_read_b128 a[180:183], v106 offset:53248
	v_mul_f32 v96, 0x3b124925, v144
	v_mul_f32 v97, 0x3b124925, v160
	v_mfma_f32_32x32x16_bf16 v[128:143], a[104:107], v[92:95], v[128:143]
	v_cvt_pk_bf16_f32 v68, -v96, -v96
	v_fma_f32 v97, -v96, v96, v97
	v_and_b32 v98, s94, v68
	v_max_f32 v97, 0, v97
	v_sub_f32 v98, -v96, v98
	v_mfma_f32_32x32x16_bf16 v[208:223], v[240:243], v[92:95], v[208:223]
	v_add_f32 v99, 0x3727c5ac, v97
	v_mov_b32 v71, 0
	v_rsq_f32 v12, v99
	v_cvt_pk_bf16_f32 v69, v98, 0
	s_waitcnt lgkmcnt(2)
	v_mfma_f32_32x32x16_bf16 v[112:127], a[108:111], v[72:75], v[112:127]
	v_mov_b32 v70, 0
	s_lshr_b32 s48, s90, 3
	s_add_u32 s48, s48, 161792
	v_and_b32 v100, 0x7c, v2
	v_add_u32 v100, s48, v100
	v_mfma_f32_32x32x16_bf16 v[192:207], v[240:243], v[72:75], v[192:207]
	s_mul_i32 s52, s79, 42
	s_add_u32 s52, s52, s47
	s_add_u32 m0, s90, 69632
	s_nop 0
	buffer_load_dwordx4 v228, s[8:11], s52 offen  lds
	ds_write_b32 v100, v12
	v_lshrrev_b32 v101, 5, v1
	v_lshlrev_b32 v101, 4, v101
	v_add_u32 v101, s48, v101
	ds_read_b128 v[176:179], v101 offset:0
	v_mfma_f32_32x32x16_bf16 v[128:143], a[108:111], v[76:79], v[128:143]
	ds_read_b128 v[180:183], v101 offset:32
	ds_read_b128 v[184:187], v101 offset:64
	ds_read_b128 v[188:191], v101 offset:96
	v_add_f32 v248, v248, v249
	v_mfma_f32_32x32x16_bf16 v[208:223], v[240:243], v[76:79], v[208:223]
	v_add_f32 v252, v252, v253
	v_add_f32 v250, v250, v251
	v_add_f32 v254, v254, v255
	v_add_f32 v248, v248, v250
	v_add_f32 v252, v252, v254
	s_mul_i32 s52, s80, 42
	s_add_u32 s52, s52, s47
	s_add_u32 m0, s90, 73728
	s_nop 0
	buffer_load_dwordx4 v228, s[8:11], s52 offen  lds
	s_cmp_ge_u32 s62, 14
	s_cselect_b32 s14, 0, s14
	s_cselect_b32 s18, 0, s18
	s_cselect_b32 s34, 0, s34
	s_cselect_b32 s38, 0, s38
	s_mov_b32 s66, 0
	s_mov_b32 s67, 200000
	s_mul_i32 s52, s81, 42
	s_add_u32 s52, s52, s47
	s_add_u32 m0, s90, 77824
	s_nop 0
	buffer_load_dwordx4 v228, s[8:11], s52 offen  lds
	v_add_f32 v192, v192, v248
	v_add_f32 v208, v208, v252
	v_cndmask_b32 v192, v192, 0, s[84:85]
	v_cvt_pk_bf16_f32 v41, v192, 0
	v_mov_b32 v43, 0
	v_lshlrev_b32 v102, 16, v41
	v_mov_b32 v42, 0
	v_sub_f32 v102, v192, v102
	v_cvt_pk_bf16_f32 v40, v192, v102
	v_cndmask_b32 v208, v208, 0, s[84:85]
	v_cvt_pk_bf16_f32 v45, v208, 0
	v_mov_b32 v47, 0
	v_lshlrev_b32 v102, 16, v45
	v_mov_b32 v46, 0
	v_sub_f32 v102, v208, v102
	v_cvt_pk_bf16_f32 v44, v208, v102
	s_mul_i32 s52, s82, 42
	s_add_u32 s52, s52, s47
	s_add_u32 m0, s90, 81920
	s_nop 0
	buffer_load_dwordx4 v228, s[8:11], s52 offen  lds
	v_mfma_f32_32x32x16_bf16 v[112:127], v[68:71], v[40:43], v[112:127]
	v_mfma_f32_32x32x16_bf16 v[128:143], v[68:71], v[44:47], v[128:143]
Lhello_1:
	s_waitcnt vmcnt(7)
	v_subrev_u32 v109, s65, v229
	v_cmp_lt_u32 vcc, 15, v109
	s_nop 0
	s_cbranch_vccz Lhok_2
	buffer_load_dword v229, v230, s[28:31], 0 offen sc1
	s_waitcnt vmcnt(0)
	s_sub_u32 s67, s67, 1
	s_cbranch_scc0 Lhello_1
	s_mov_b32 s67, 0
Lhok_2:
	v_cmp_ne_u32 vcc, s97, v109
	s_waitcnt lgkmcnt(0)
	s_and_b32 s3, vcc_lo, 0xffff0000
	s_cbranch_scc1 L_start_slow
L_start_fast:
	s_mov_b32 exec_lo, 65535
	s_mov_b32 exec_hi, 0xfffc
	buffer_load_dword v17, v16, s[28:31], s68 offen
	s_mov_b64 exec, -1
	v_mov_b32 v96, 0x3f803f80
	s_lshl_b32 s52, s63, 9
	s_add_u32 s52, s52, s69
	v_pk_fma_f32 v[112:113], v[112:113], v[176:177], s[92:93] op_sel_hi:[1,1,0]
	v_pk_fma_f32 v[114:115], v[114:115], v[178:179], s[92:93] op_sel_hi:[1,1,0]
	v_pk_fma_f32 v[116:117], v[116:117], v[180:181], s[92:93] op_sel_hi:[1,1,0]
	v_pk_fma_f32 v[118:119], v[118:119], v[182:183], s[92:93] op_sel_hi:[1,1,0]
	v_pk_mul_f32 v[104:105], v[112:113], s[92:93] op_sel:[0,1] op_sel_hi:[1,1]
	v_pk_mul_f32 v[106:107], v[114:115], s[92:93] op_sel:[0,1] op_sel_hi:[1,1]
	v_pk_mul_f32 v[108:109], v[116:117], s[92:93] op_sel:[0,1] op_sel_hi:[1,1]
	v_pk_mul_f32 v[110:111], v[118:119], s[92:93] op_sel:[0,1] op_sel_hi:[1,1]
	v_exp_f32 v104, v104 clamp
	v_exp_f32 v105, v105 clamp
	v_exp_f32 v106, v106 clamp
	v_exp_f32 v107, v107 clamp
	v_exp_f32 v108, v108 clamp
	v_exp_f32 v109, v109 clamp
	v_exp_f32 v110, v110 clamp
	v_exp_f32 v111, v111 clamp
	v_max_f32 v112, s92, v112
	v_max_f32 v113, s92, v113
	v_max_f32 v114, s92, v114
	v_max_f32 v115, s92, v115
	v_max_f32 v116, s92, v116
	v_max_f32 v117, s92, v117
	v_max_f32 v118, s92, v118
	v_max_f32 v119, s92, v119
	v_pk_add_f32 v[112:113], v[112:113], v[104:105]
	v_pk_add_f32 v[114:115], v[114:115], v[106:107]
	v_pk_add_f32 v[116:117], v[116:117], v[108:109]
	v_pk_add_f32 v[118:119], v[118:119], v[110:111]
	v_cvt_pk_bf16_f32 v224, v112, v113
	v_cvt_pk_bf16_f32 v225, v114, v115
	v_cvt_pk_bf16_f32 v226, v116, v117
	v_cvt_pk_bf16_f32 v227, v118, v119
	v_pk_fma_f32 v[120:121], v[120:121], v[184:185], s[92:93] op_sel_hi:[1,1,0]
	v_pk_fma_f32 v[122:123], v[122:123], v[186:187], s[92:93] op_sel_hi:[1,1,0]
	v_pk_fma_f32 v[124:125], v[124:125], v[188:189], s[92:93] op_sel_hi:[1,1,0]
	v_pk_fma_f32 v[126:127], v[126:127], v[190:191], s[92:93] op_sel_hi:[1,1,0]
	v_pk_mul_f32 v[104:105], v[120:121], s[92:93] op_sel:[0,1] op_sel_hi:[1,1]
	v_pk_mul_f32 v[106:107], v[122:123], s[92:93] op_sel:[0,1] op_sel_hi:[1,1]
	v_pk_mul_f32 v[108:109], v[124:125], s[92:93] op_sel:[0,1] op_sel_hi:[1,1]
	v_pk_mul_f32 v[110:111], v[126:127], s[92:93] op_sel:[0,1] op_sel_hi:[1,1]
	v_exp_f32 v104, v104 clamp
	v_exp_f32 v105, v105 clamp
	v_exp_f32 v106, v106 clamp
	v_exp_f32 v107, v107 clamp
	v_exp_f32 v108, v108 clamp
	v_exp_f32 v109, v109 clamp
	v_exp_f32 v110, v110 clamp
	v_exp_f32 v111, v111 clamp
	v_max_f32 v120, s92, v120
	v_max_f32 v121, s92, v121
	v_max_f32 v122, s92, v122
	v_max_f32 v123, s92, v123
	v_max_f32 v124, s92, v124
	v_max_f32 v125, s92, v125
	v_max_f32 v126, s92, v126
	v_max_f32 v127, s92, v127
	v_pk_add_f32 v[120:121], v[120:121], v[104:105]
	v_pk_add_f32 v[122:123], v[122:123], v[106:107]
	v_pk_add_f32 v[124:125], v[124:125], v[108:109]
	v_pk_add_f32 v[126:127], v[126:127], v[110:111]
	v_cvt_pk_bf16_f32 v228, v120, v121
	v_cvt_pk_bf16_f32 v229, v122, v123
	v_cvt_pk_bf16_f32 v230, v124, v125
	v_cvt_pk_bf16_f32 v231, v126, v127
	v_pk_mul_f32 v[128:129], v[128:129], v[176:177]
	v_pk_mul_f32 v[130:131], v[130:131], v[178:179]
	v_pk_mul_f32 v[132:133], v[132:133], v[180:181]
	v_pk_mul_f32 v[134:135], v[134:135], v[182:183]
	v_pk_mul_f32 v[136:137], v[136:137], v[184:185]
	v_pk_mul_f32 v[138:139], v[138:139], v[186:187]
	v_pk_mul_f32 v[140:141], v[140:141], v[188:189]
	v_pk_mul_f32 v[142:143], v[142:143], v[190:191]
	v_cvt_pk_bf16_f32 v232, v128, v129
	v_cvt_pk_bf16_f32 v233, v130, v131
	v_cvt_pk_bf16_f32 v234, v132, v133
	v_cvt_pk_bf16_f32 v235, v134, v135
	v_cvt_pk_bf16_f32 v236, v136, v137
	v_cvt_pk_bf16_f32 v237, v138, v139
	v_cvt_pk_bf16_f32 v238, v140, v141
	v_cvt_pk_bf16_f32 v239, v142, v143
	v_cndmask_b32 v224, v224, 0, s[86:87]
	v_cndmask_b32 v225, v225, 0, s[86:87]
	v_cndmask_b32 v226, v226, 0, s[86:87]
	v_cndmask_b32 v227, v227, 0, s[86:87]
	v_cndmask_b32 v228, v228, 0, s[86:87]
	v_cndmask_b32 v229, v229, 0, s[86:87]
	v_cndmask_b32 v230, v230, 0, s[86:87]
	v_cndmask_b32 v231, v231, 0, s[86:87]
	v_cndmask_b32 v232, v232, v96, s[86:87]
	v_cndmask_b32 v233, v233, v96, s[86:87]
	v_cndmask_b32 v234, v234, v96, s[86:87]
	v_cndmask_b32 v235, v235, v96, s[86:87]
	v_cndmask_b32 v236, v236, v96, s[86:87]
	v_cndmask_b32 v237, v237, v96, s[86:87]
	v_cndmask_b32 v238, v238, v96, s[86:87]
	v_cndmask_b32 v239, v239, v96, s[86:87]
	v_mfma_f32_32x32x16_bf16 v[160:175], v[224:227], v[232:235], 0
	s_nop 0
	v_mfma_f32_32x32x16_bf16 v[160:175], v[228:231], v[236:239], v[160:175]
	s_nop 11
	ds_write_b128 v9, v[160:163] offset:0
	ds_write_b128 v9, v[164:167] offset:1024
	ds_write_b128 v9, v[168:171] offset:2048
	ds_write_b128 v9, v[172:175] offset:3072
	s_waitcnt lgkmcnt(0)
	s_barrier
	ds_read_b128 v[112:115], v10 offset:0
	ds_read_b128 v[116:119], v10 offset:4096
	ds_read_b128 v[120:123], v10 offset:8192
	ds_read_b128 v[124:127], v10 offset:12288
	s_waitcnt lgkmcnt(2)
	v_pk_add_f32 v[112:113], v[112:113], v[116:117]
	v_pk_add_f32 v[114:115], v[114:115], v[118:119]
	s_waitcnt lgkmcnt(0)
	v_pk_add_f32 v[120:121], v[120:121], v[124:125]
	v_pk_add_f32 v[122:123], v[122:123], v[126:127]
	v_pk_add_f32 v[112:113], v[112:113], v[120:121]
	v_pk_add_f32 v[114:115], v[114:115], v[122:123]
	v_cvt_pk_bf16_f32 v96, v112, v113
	v_cvt_pk_bf16_f32 v97, v114, v115
	buffer_store_dwordx2 v[96:97], v3, s[28:31], s52 offen sc1
	s_lshl_b32 s52, s62, 6
	v_lshrrev_b32 v240, 2, v1
	v_mul_u32_u24 v240, 896, v240
	v_and_b32 v101, 48, v4
	v_add_u32 v240, v240, v101
	s_mul_i32 s55, s64, 14336
	s_add_u32 s55, s55, s52
	v_mov_b32 v224, 0x3f803f80
	v_mov_b32 v225, 0x3f803f80
	v_mov_b32 v226, 0x3f803f80
	v_mov_b32 v227, 0x3f803f80
	s_waitcnt vmcnt(2)
	s_barrier
	ds_read_b64_tr_b16 v[72:73], v21 offset:57344
	ds_read_b64_tr_b16 v[74:75], v21 offset:57856
	ds_read_b64_tr_b16 v[76:77], v21 offset:58368
	ds_read_b64_tr_b16 v[78:79], v21 offset:58880
	ds_read_b64_tr_b16 v[80:81], v21 offset:59392
	ds_read_b64_tr_b16 v[82:83], v21 offset:59904
	ds_read_b64_tr_b16 v[84:85], v21 offset:60416
	ds_read_b64_tr_b16 v[86:87], v21 offset:60928
	v_and_b32 v246, 31, v1
	v_lshlrev_b32 v246, 1, v246
	v_lshrrev_b32 v247, 5, v1
	v_lshlrev_b32 v247, 3, v247
	s_lshl_b32 s3, s62, 6
	s_lshl_b32 s53, s62, 8
	buffer_load_dwordx2 a[248:249], v247, s[36:39], s3 offen offset:0
	buffer_load_dwordx2 a[250:251], v247, s[36:39], s3 offen offset:16
	buffer_load_dwordx2 a[252:253], v247, s[36:39], s3 offen offset:32
	buffer_load_dwordx2 a[254:255], v247, s[36:39], s3 offen offset:48
	buffer_load_ushort v55, v246, s[32:35], s53 offen offset:0
	buffer_load_ushort v59, v246, s[32:35], s53 offen offset:64
	buffer_load_ushort v63, v246, s[32:35], s53 offen offset:128
	buffer_load_ushort v67, v246, s[32:35], s53 offen offset:192
	s_waitcnt lgkmcnt(4)
	v_mfma_f32_32x32x16_bf16 v[144:159], v[72:75], a[0:3], 0
	ds_read_b64_tr_b16 v[88:89], v21 offset:61440
	ds_read_b64_tr_b16 v[90:91], v21 offset:61952
	v_and_b32 v180, 31, v1
	v_mov_b32 v181, 0x3f80
	s_add_u32 m0, s90, 86016
	s_mov_b32 s54, 128
	buffer_load_dwordx4 v7, s[16:19], s54 offen lds
	v_mfma_f32_32x32x16_bf16 v[144:159], v[76:79], a[4:7], v[144:159]
	ds_read_b64_tr_b16 v[92:93], v21 offset:62464
	ds_read_b64_tr_b16 v[94:95], v21 offset:62976
	v_subrev_u32 v182, 0, v180
	v_cmp_gt_u32 vcc, 2, v182
	s_waitcnt lgkmcnt(4)
	v_mfma_f32_32x32x16_bf16 v[144:159], v[80:83], a[8:11], v[144:159]
	ds_read_b64_tr_b16 v[72:73], v21 offset:63488
	ds_read_b64_tr_b16 v[74:75], v21 offset:64000
	v_lshlrev_b32 v183, 4, v182
	v_lshlrev_b32 v183, v183, v181
	s_add_u32 m0, s90, 90112
	s_mov_b32 s54, 114816
	buffer_load_dwordx4 v7, s[16:19], s54 offen lds
	v_mfma_f32_32x32x16_bf16 v[144:159], v[84:87], a[12:15], v[144:159]
	ds_read_b64_tr_b16 v[76:77], v21 offset:64512
	ds_read_b64_tr_b16 v[78:79], v21 offset:65024
	v_cndmask_b32 v176, 0, v183, vcc
	v_subrev_u32 v182, 2, v180
	s_waitcnt lgkmcnt(4)
	v_mfma_f32_32x32x16_bf16 v[144:159], v[88:91], a[16:19], v[144:159]
	ds_read_b64_tr_b16 v[80:81], v22 offset:0
	ds_read_b64_tr_b16 v[82:83], v22 offset:512
	v_cmp_gt_u32 vcc, 2, v182
	v_lshlrev_b32 v183, 4, v182
	s_add_u32 m0, s90, 94208
	s_mov_b32 s54, 229504
	buffer_load_dwordx4 v7, s[16:19], s54 offen lds
	v_mfma_f32_32x32x16_bf16 v[144:159], v[92:95], a[20:23], v[144:159]
	ds_read_b64_tr_b16 v[84:85], v22 offset:1024
	ds_read_b64_tr_b16 v[86:87], v22 offset:1536
	v_lshlrev_b32 v183, v183, v181
	v_cndmask_b32 v177, 0, v183, vcc
	s_waitcnt lgkmcnt(4)
	v_mfma_f32_32x32x16_bf16 v[144:159], v[72:75], a[24:27], v[144:159]
	ds_read_b64_tr_b16 v[88:89], v22 offset:2048
	ds_read_b64_tr_b16 v[90:91], v22 offset:2560
	v_subrev_u32 v182, 4, v180
	v_cmp_gt_u32 vcc, 2, v182
	s_add_u32 m0, s90, 98304
	s_mov_b32 s54, 344192
	buffer_load_dwordx4 v7, s[16:19], s54 offen lds
	v_mfma_f32_32x32x16_bf16 v[144:159], v[76:79], a[28:31], v[144:159]
	ds_read_b64_tr_b16 v[92:93], v22 offset:3072
	ds_read_b64_tr_b16 v[94:95], v22 offset:3584
	v_lshlrev_b32 v183, 4, v182
	v_lshlrev_b32 v183, v183, v181
	s_waitcnt lgkmcnt(4)
	v_mfma_f32_32x32x16_bf16 v[144:159], v[80:83], a[32:35], v[144:159]
	ds_read_b64_tr_b16 v[72:73], v22 offset:4096
	ds_read_b64_tr_b16 v[74:75], v22 offset:4608
	v_cndmask_b32 v178, 0, v183, vcc
	v_subrev_u32 v182, 6, v180
	s_add_u32 m0, s90, 102400
	s_mov_b32 s54, 458880
	buffer_load_dwordx4 v7, s[16:19], s54 offen lds
	v_mfma_f32_32x32x16_bf16 v[144:159], v[84:87], a[36:39], v[144:159]
	ds_read_b64_tr_b16 v[76:77], v22 offset:5120
	ds_read_b64_tr_b16 v[78:79], v22 offset:5632
	v_cmp_gt_u32 vcc, 2, v182
	v_lshlrev_b32 v183, 4, v182
	s_waitcnt lgkmcnt(4)
	v_mfma_f32_32x32x16_bf16 v[144:159], v[88:91], a[40:43], v[144:159]
	ds_read_b64_tr_b16 v[80:81], v22 offset:6144
	ds_read_b64_tr_b16 v[82:83], v22 offset:6656
	v_lshlrev_b32 v183, v183, v181
	v_cndmask_b32 v179, 0, v183, vcc
	s_add_u32 m0, s90, 106496
	s_mov_b32 s54, 573568
	buffer_load_dwordx4 v7, s[16:19], s54 offen lds
	v_mfma_f32_32x32x16_bf16 v[144:159], v[92:95], a[44:47], v[144:159]
	ds_read_b64_tr_b16 v[84:85], v22 offset:7168
	ds_read_b64_tr_b16 v[86:87], v22 offset:7680
	s_waitcnt lgkmcnt(4)
	v_mfma_f32_32x32x16_bf16 v[144:159], v[72:75], a[48:51], v[144:159]
	ds_read_b64_tr_b16 v[88:89], v22 offset:8192
	ds_read_b64_tr_b16 v[90:91], v22 offset:8704
	s_add_u32 m0, s90, 110592
	s_mov_b32 s54, 688256
	buffer_load_dwordx4 v7, s[16:19], s54 offen lds
	v_mfma_f32_32x32x16_bf16 v[144:159], v[76:79], a[52:55], v[144:159]
	ds_read_b64_tr_b16 v[92:93], v22 offset:9216
	ds_read_b64_tr_b16 v[94:95], v22 offset:9728
	s_waitcnt lgkmcnt(4)
	v_mfma_f32_32x32x16_bf16 v[144:159], v[80:83], a[56:59], v[144:159]
	ds_read_b64_tr_b16 v[72:73], v22 offset:10240
	ds_read_b64_tr_b16 v[74:75], v22 offset:10752
	s_add_u32 m0, s90, 114688
	s_mov_b32 s54, 802944
	buffer_load_dwordx4 v7, s[16:19], s54 offen lds
	v_mfma_f32_32x32x16_bf16 v[144:159], v[84:87], a[60:63], v[144:159]
	ds_read_b64_tr_b16 v[76:77], v22 offset:11264
	ds_read_b64_tr_b16 v[78:79], v22 offset:11776
	s_waitcnt lgkmcnt(4)
	v_mfma_f32_32x32x16_bf16 v[144:159], v[88:91], a[64:67], v[144:159]
	ds_read_b64_tr_b16 v[80:81], v22 offset:12288
	ds_read_b64_tr_b16 v[82:83], v22 offset:12800
	s_add_u32 m0, s90, 118784
	s_mov_b32 s54, 917632
	buffer_load_dwordx4 v7, s[16:19], s54 offen lds
	v_mfma_f32_32x32x16_bf16 v[144:159], v[92:95], a[68:71], v[144:159]
	ds_read_b64_tr_b16 v[84:85], v22 offset:13312
	ds_read_b64_tr_b16 v[86:87], v22 offset:13824
	s_waitcnt lgkmcnt(4)
	v_mfma_f32_32x32x16_bf16 v[144:159], v[72:75], a[72:75], v[144:159]
	ds_read_b64_tr_b16 v[88:89], v22 offset:14336
	ds_read_b64_tr_b16 v[90:91], v22 offset:14848
	s_add_u32 m0, s90, 122880
	s_mov_b32 s54, 1032320
	buffer_load_dwordx4 v7, s[16:19], s54 offen lds
	v_mfma_f32_32x32x16_bf16 v[144:159], v[76:79], a[76:79], v[144:159]
	ds_read_b64_tr_b16 v[92:93], v22 offset:15360
	ds_read_b64_tr_b16 v[94:95], v22 offset:15872
	s_waitcnt lgkmcnt(4)
	v_mfma_f32_32x32x16_bf16 v[144:159], v[80:83], a[80:83], v[144:159]
	ds_read_b64_tr_b16 v[72:73], v22 offset:16384
	ds_read_b64_tr_b16 v[74:75], v22 offset:16896
	s_add_u32 m0, s90, 126976
	s_mov_b32 s54, 1147008
	buffer_load_dwordx4 v7, s[16:19], s54 offen lds
	v_mfma_f32_32x32x16_bf16 v[144:159], v[84:87], a[84:87], v[144:159]
	ds_read_b64_tr_b16 v[76:77], v22 offset:17408
	ds_read_b64_tr_b16 v[78:79], v22 offset:17920
	s_waitcnt lgkmcnt(4)
	v_mfma_f32_32x32x16_bf16 v[144:159], v[88:91], a[88:91], v[144:159]
	ds_read_b64_tr_b16 v[80:81], v22 offset:18432
	ds_read_b64_tr_b16 v[82:83], v22 offset:18944
	s_add_u32 m0, s90, 131072
	s_mov_b32 s54, 1261696
	buffer_load_dwordx4 v7, s[16:19], s54 offen lds
	v_mfma_f32_32x32x16_bf16 v[144:159], v[92:95], a[92:95], v[144:159]
	ds_read_b64_tr_b16 v[84:85], v22 offset:19456
	ds_read_b64_tr_b16 v[86:87], v22 offset:19968
	s_waitcnt lgkmcnt(4)
	v_mfma_f32_32x32x16_bf16 v[144:159], v[72:75], a[96:99], v[144:159]
	s_add_u32 m0, s90, 135168
	s_mov_b32 s54, 1376384
	buffer_load_dwordx4 v7, s[16:19], s54 offen lds
	v_mfma_f32_32x32x16_bf16 v[144:159], v[76:79], a[100:103], v[144:159]
	s_waitcnt lgkmcnt(0)
	v_mfma_f32_32x32x16_bf16 v[144:159], v[80:83], a[104:107], v[144:159]
	s_add_u32 m0, s90, 139264
	s_mov_b32 s54, 1491072
	buffer_load_dwordx4 v7, s[16:19], s54 offen lds
	v_mfma_f32_32x32x16_bf16 v[144:159], v[84:87], a[108:111], v[144:159]
	s_add_u32 s48, s69, 4096
	buffer_load_dwordx4 v[192:195], v4, s[28:31], s69 offen offset:0 sc1
	buffer_load_dwordx4 v[196:199], v4, s[28:31], s69 offen offset:1024 sc1
	buffer_load_dwordx4 v[200:203], v4, s[28:31], s69 offen offset:2048 sc1
	buffer_load_dwordx4 v[204:207], v4, s[28:31], s69 offen offset:3072 sc1
	buffer_load_dwordx4 v[208:211], v4, s[28:31], s48 offen offset:0 sc1
	buffer_load_dwordx4 v[212:215], v4, s[28:31], s48 offen offset:1024 sc1
	buffer_load_dwordx4 v[216:219], v4, s[28:31], s48 offen offset:2048 sc1
	buffer_load_dwordx4 v[220:223], v4, s[28:31], s48 offen offset:3072 sc1
	s_mul_i32 s48, s64, 7168
	s_add_u32 s48, s48, 57344
	v_add_u32 v96, s48, v21
	ds_read_b64_tr_b16 v[112:113], v96 offset:0
	ds_read_b64_tr_b16 v[114:115], v96 offset:512
	ds_read_b64_tr_b16 v[116:117], v96 offset:1024
	ds_read_b64_tr_b16 v[118:119], v96 offset:1536
	ds_read_b64_tr_b16 v[120:121], v96 offset:2048
	ds_read_b64_tr_b16 v[122:123], v96 offset:2560
	ds_read_b64_tr_b16 v[124:125], v96 offset:3072
	ds_read_b64_tr_b16 v[126:127], v96 offset:3584
	ds_read_b64_tr_b16 v[128:129], v96 offset:4096
	ds_read_b64_tr_b16 v[130:131], v96 offset:4608
	ds_read_b64_tr_b16 v[132:133], v96 offset:5120
	ds_read_b64_tr_b16 v[134:135], v96 offset:5632
	ds_read_b64_tr_b16 v[136:137], v96 offset:6144
	ds_read_b64_tr_b16 v[138:139], v96 offset:6656
	v_add_u32 v106, s90, v4
	v_add_u32 v106, 57344, v106
	ds_read_b128 a[184:187], v106 offset:0
	ds_read_b128 a[188:191], v106 offset:4096
	ds_read_b128 a[192:195], v106 offset:8192
	ds_read_b128 a[196:199], v106 offset:12288
	ds_read_b128 a[200:203], v106 offset:16384
	ds_read_b128 a[204:207], v106 offset:20480
	ds_read_b128 a[208:211], v106 offset:24576
	s_waitcnt lgkmcnt(15)
	v_mfma_f32_32x32x16_bf16 v[160:175], v[224:227], v[112:115], 0
	v_mfma_f32_32x32x16_bf16 v[160:175], v[224:227], v[116:119], v[160:175]
	v_mfma_f32_32x32x16_bf16 v[160:175], v[224:227], v[120:123], v[160:175]
	s_waitcnt lgkmcnt(13)
	v_mfma_f32_32x32x16_bf16 v[160:175], v[224:227], v[124:127], v[160:175]
	s_waitcnt lgkmcnt(11)
	v_mfma_f32_32x32x16_bf16 v[160:175], v[224:227], v[128:131], v[160:175]
	s_waitcnt lgkmcnt(9)
	v_mfma_f32_32x32x16_bf16 v[160:175], v[224:227], v[132:135], v[160:175]
	s_waitcnt lgkmcnt(7)
	v_mfma_f32_32x32x16_bf16 v[160:175], v[224:227], v[136:139], v[160:175]
	s_lshl_b32 s48, s72, 12
	s_lshl_b32 s49, s71, 11
	s_add_u32 s48, s48, s49
	s_add_u32 s49, s76, 0
	s_cmp_eq_u32 s49, s48
	s_cbranch_scc0 Lres_4
	v_mfma_f32_32x32x16_bf16 v[24:39], a[240:243], a[0:3], 0
	v_mfma_f32_32x32x16_bf16 v[24:39], a[244:247], a[4:7], v[24:39]
	s_branch Lres_3
Lres_4:
	s_add_u32 s49, s76, 2048
	s_cmp_eq_u32 s49, s48
	s_cbranch_scc0 Lres_5
	v_mfma_f32_32x32x16_bf16 v[24:39], a[240:243], a[8:11], 0
	v_mfma_f32_32x32x16_bf16 v[24:39], a[244:247], a[12:15], v[24:39]
	s_branch Lres_3
Lres_5:
	s_add_u32 s49, s77, 0
	s_cmp_eq_u32 s49, s48
	s_cbranch_scc0 Lres_6
	v_mfma_f32_32x32x16_bf16 v[24:39], a[240:243], a[16:19], 0
	v_mfma_f32_32x32x16_bf16 v[24:39], a[244:247], a[20:23], v[24:39]
	s_branch Lres_3
Lres_6:
	s_add_u32 s49, s77, 2048
	s_cmp_eq_u32 s49, s48
	s_cbranch_scc0 Lres_7
	v_mfma_f32_32x32x16_bf16 v[24:39], a[240:243], a[24:27], 0
	v_mfma_f32_32x32x16_bf16 v[24:39], a[244:247], a[28:31], v[24:39]
	s_branch Lres_3
Lres_7:
	s_add_u32 s49, s78, 0
	s_cmp_eq_u32 s49, s48
	s_cbranch_scc0 Lres_8
	v_mfma_f32_32x32x16_bf16 v[24:39], a[240:243], a[32:35], 0
	v_mfma_f32_32x32x16_bf16 v[24:39], a[244:247], a[36:39], v[24:39]
	s_branch Lres_3
Lres_8:
	s_add_u32 s49, s78, 2048
	s_cmp_eq_u32 s49, s48
	s_cbranch_scc0 Lres_9
	v_mfma_f32_32x32x16_bf16 v[24:39], a[240:243], a[40:43], 0
	v_mfma_f32_32x32x16_bf16 v[24:39], a[244:247], a[44:47], v[24:39]
	s_branch Lres_3
Lres_9:
	s_add_u32 s49, s79, 0
	s_cmp_eq_u32 s49, s48
	s_cbranch_scc0 Lres_10
	v_mfma_f32_32x32x16_bf16 v[24:39], a[240:243], a[48:51], 0
	v_mfma_f32_32x32x16_bf16 v[24:39], a[244:247], a[52:55], v[24:39]
	s_branch Lres_3
Lres_10:
	s_add_u32 s49, s79, 2048
	s_cmp_eq_u32 s49, s48
	s_cbranch_scc0 Lres_11
	v_mfma_f32_32x32x16_bf16 v[24:39], a[240:243], a[56:59], 0
	v_mfma_f32_32x32x16_bf16 v[24:39], a[244:247], a[60:63], v[24:39]
	s_branch Lres_3
Lres_11:
	s_add_u32 s49, s80, 0
	s_cmp_eq_u32 s49, s48
	s_cbranch_scc0 Lres_12
	v_mfma_f32_32x32x16_bf16 v[24:39], a[240:243], a[64:67], 0
	v_mfma_f32_32x32x16_bf16 v[24:39], a[244:247], a[68:71], v[24:39]
	s_branch Lres_3
Lres_12:
	s_add_u32 s49, s80, 2048
	s_cmp_eq_u32 s49, s48
	s_cbranch_scc0 Lres_13
	v_mfma_f32_32x32x16_bf16 v[24:39], a[240:243], a[72:75], 0
	v_mfma_f32_32x32x16_bf16 v[24:39], a[244:247], a[76:79], v[24:39]
	s_branch Lres_3
Lres_13:
	s_add_u32 s49, s81, 0
	s_cmp_eq_u32 s49, s48
	s_cbranch_scc0 Lres_14
	v_mfma_f32_32x32x16_bf16 v[24:39], a[240:243], a[80:83], 0
	v_mfma_f32_32x32x16_bf16 v[24:39], a[244:247], a[84:87], v[24:39]
	s_branch Lres_3
Lres_14:
	s_add_u32 s49, s81, 2048
	s_cmp_eq_u32 s49, s48
	s_cbranch_scc0 Lres_15
	v_mfma_f32_32x32x16_bf16 v[24:39], a[240:243], a[88:91], 0
	v_mfma_f32_32x32x16_bf16 v[24:39], a[244:247], a[92:95], v[24:39]
	s_branch Lres_3
Lres_15:
	s_add_u32 s49, s82, 0
	s_cmp_eq_u32 s49, s48
	s_cbranch_scc0 Lres_16
	v_mfma_f32_32x32x16_bf16 v[24:39], a[240:243], a[96:99], 0
	v_mfma_f32_32x32x16_bf16 v[24:39], a[244:247], a[100:103], v[24:39]
	s_branch Lres_3
Lres_16:
	s_add_u32 s49, s82, 2048
	s_cmp_eq_u32 s49, s48
	s_cbranch_scc0 Lres_17
	v_mfma_f32_32x32x16_bf16 v[24:39], a[240:243], a[104:107], 0
	v_mfma_f32_32x32x16_bf16 v[24:39], a[244:247], a[108:111], v[24:39]
	s_branch Lres_3
Lres_17:
Lres_3:
	s_lshr_b32 s48, s90, 2
	s_add_u32 s48, s48, 162304
	v_add_u32 v96, s48, v2
	ds_write_b32 v96, v160
	s_waitcnt lgkmcnt(0)
	s_barrier
	v_add_u32 v96, 162304, v2
	ds_read_b32 v224, v96 offset:0
	ds_read_b32 v225, v96 offset:256
	ds_read_b32 v226, v96 offset:512
	ds_read_b32 v227, v96 offset:768
	s_waitcnt lgkmcnt(2)
	v_add_f32 v224, v224, v225
	s_waitcnt lgkmcnt(0)
	v_add_f32 v226, v226, v227
	v_add_f32 v224, v224, v226
	v_cndmask_b32 v224, v224, 0, s[84:85]
	v_cvt_pk_bf16_f32 v49, v224, 0
	v_mov_b32 v51, 0
	v_lshlrev_b32 v102, 16, v49
	v_mov_b32 v50, 0
	v_sub_f32 v102, v224, v102
	v_cvt_pk_bf16_f32 v48, v224, v102
	s_nop 1
	v_mfma_f32_32x32x16_bf16 v[144:159], v[48:51], v[68:71], v[144:159]
	s_lshr_b32 s48, s64, 1
	s_lshl_b32 s48, s48, 10
	s_and_b32 s49, s64, 1
	s_lshl_b32 s49, s49, 3
	s_add_u32 s48, s48, s49
	s_add_u32 s48, s48, 159744
	v_and_b32 v242, 31, v1
	v_lshrrev_b32 v243, 5, v1
	v_lshlrev_b32 v242, 5, v242
	v_lshl_add_u32 v242, v243, 4, v242
	v_add_u32 v242, s48, v242
	v_add_u32 v243, 159744, v4
	s_lshl_b32 s49, s63, 7
	s_add_u32 s49, s49, s70
	s_lshl_b32 s50, s62, 11
	s_add_u32 s50, s50, s68
	s_add_u32 m0, s90, 57344
	s_nop 0
	buffer_load_dwordx4 v240, s[12:15], s55 offen  lds
	v_pk_fma_f32 v[144:145], v[144:145], v[12:13], s[92:93] op_sel_hi:[1,0,0]
	v_pk_fma_f32 v[146:147], v[146:147], v[12:13], s[92:93] op_sel_hi:[1,0,0]
	v_pk_fma_f32 v[148:149], v[148:149], v[12:13], s[92:93] op_sel_hi:[1,0,0]
	v_pk_fma_f32 v[150:151], v[150:151], v[12:13], s[92:93] op_sel_hi:[1,0,0]
	v_pk_mul_f32 v[104:105], v[144:145], s[92:93] op_sel:[0,1] op_sel_hi:[1,1]
	v_pk_mul_f32 v[106:107], v[146:147], s[92:93] op_sel:[0,1] op_sel_hi:[1,1]
	v_pk_mul_f32 v[108:109], v[148:149], s[92:93] op_sel:[0,1] op_sel_hi:[1,1]
	v_pk_mul_f32 v[110:111], v[150:151], s[92:93] op_sel:[0,1] op_sel_hi:[1,1]
	v_exp_f32 v104, v104 clamp
	s_add_u32 m0, s90, 61440
	s_add_u32 s54, s55, 57344
	buffer_load_dwordx4 v240, s[12:15], s54 offen  lds
	v_exp_f32 v105, v105 clamp
	v_exp_f32 v106, v106 clamp
	v_exp_f32 v107, v107 clamp
	v_exp_f32 v108, v108 clamp
	v_exp_f32 v109, v109 clamp
	v_exp_f32 v110, v110 clamp
	v_exp_f32 v111, v111 clamp
	v_max_f32 v144, s92, v144
	v_max_f32 v145, s92, v145
	s_add_u32 m0, s90, 65536
	s_add_u32 s54, s55, 114688
	buffer_load_dwordx4 v240, s[12:15], s54 offen  lds
	v_max_f32 v146, s92, v146
	v_max_f32 v147, s92, v147
	v_max_f32 v148, s92, v148
	v_max_f32 v149, s92, v149
	v_max_f32 v150, s92, v150
	v_max_f32 v151, s92, v151
	v_pk_add_f32 v[144:145], v[144:145], v[104:105]
	v_pk_add_f32 v[146:147], v[146:147], v[106:107]
	v_pk_add_f32 v[148:149], v[148:149], v[108:109]
	s_add_u32 m0, s90, 69632
	s_add_u32 s54, s55, 172032
	buffer_load_dwordx4 v240, s[12:15], s54 offen  lds
	v_pk_add_f32 v[150:151], v[150:151], v[110:111]
	v_cvt_pk_bf16_f32 v248, v144, v145
	v_cvt_pk_bf16_f32 v249, v146, v147
	v_cvt_pk_bf16_f32 v250, v148, v149
	v_cvt_pk_bf16_f32 v251, v150, v151
	v_pk_fma_f32 v[152:153], v[152:153], v[12:13], s[92:93] op_sel_hi:[1,0,0]
	v_pk_fma_f32 v[154:155], v[154:155], v[12:13], s[92:93] op_sel_hi:[1,0,0]
	v_pk_fma_f32 v[156:157], v[156:157], v[12:13], s[92:93] op_sel_hi:[1,0,0]
	v_pk_fma_f32 v[158:159], v[158:159], v[12:13], s[92:93] op_sel_hi:[1,0,0]
	s_add_u32 m0, s90, 73728
	s_add_u32 s54, s55, 229376
	buffer_load_dwordx4 v240, s[12:15], s54 offen  lds
	v_pk_mul_f32 v[104:105], v[152:153], s[92:93] op_sel:[0,1] op_sel_hi:[1,1]
	v_pk_mul_f32 v[106:107], v[154:155], s[92:93] op_sel:[0,1] op_sel_hi:[1,1]
	v_pk_mul_f32 v[108:109], v[156:157], s[92:93] op_sel:[0,1] op_sel_hi:[1,1]
	v_pk_mul_f32 v[110:111], v[158:159], s[92:93] op_sel:[0,1] op_sel_hi:[1,1]
	v_exp_f32 v104, v104 clamp
	v_exp_f32 v105, v105 clamp
	v_exp_f32 v106, v106 clamp
	v_exp_f32 v107, v107 clamp
	v_exp_f32 v108, v108 clamp
	s_add_u32 m0, s90, 77824
	s_add_u32 s54, s55, 286720
	buffer_load_dwordx4 v240, s[12:15], s54 offen  lds
	v_exp_f32 v109, v109 clamp
	v_exp_f32 v110, v110 clamp
	v_exp_f32 v111, v111 clamp
	v_max_f32 v152, s92, v152
	v_max_f32 v153, s92, v153
	v_max_f32 v154, s92, v154
	v_max_f32 v155, s92, v155
	v_max_f32 v156, s92, v156
	v_max_f32 v157, s92, v157
	s_add_u32 m0, s90, 81920
	s_add_u32 s54, s55, 344064
	buffer_load_dwordx4 v240, s[12:15], s54 offen  lds
	v_max_f32 v158, s92, v158
	v_max_f32 v159, s92, v159
	v_pk_add_f32 v[152:153], v[152:153], v[104:105]
	v_pk_add_f32 v[154:155], v[154:155], v[106:107]
	v_pk_add_f32 v[156:157], v[156:157], v[108:109]
	v_pk_add_f32 v[158:159], v[158:159], v[110:111]
	v_cvt_pk_bf16_f32 v252, v152, v153
	v_cvt_pk_bf16_f32 v253, v154, v155
	v_cvt_pk_bf16_f32 v254, v156, v157
	v_cvt_pk_bf16_f32 v255, v158, v159
	s_waitcnt vmcnt(14)
	v_mfma_f32_32x32x16_bf16 v[112:127], v[176:179], v[192:195], 0
	s_waitcnt vmcnt(13)
	v_mfma_f32_32x32x16_bf16 v[112:127], v[176:179], v[196:199], v[112:127]
	s_waitcnt vmcnt(12)
	v_mfma_f32_32x32x16_bf16 v[112:127], v[176:179], v[200:203], v[112:127]
	s_waitcnt vmcnt(11)
	v_mfma_f32_32x32x16_bf16 v[112:127], v[176:179], v[204:207], v[112:127]
	s_waitcnt vmcnt(10)
	v_mfma_f32_32x32x16_bf16 v[112:127], v[176:179], v[208:211], v[112:127]
	s_waitcnt vmcnt(9)
	v_mfma_f32_32x32x16_bf16 v[112:127], v[176:179], v[212:215], v[112:127]
	s_waitcnt vmcnt(8)
	v_mfma_f32_32x32x16_bf16 v[112:127], v[176:179], v[216:219], v[112:127]
	s_waitcnt vmcnt(7)
	v_mfma_f32_32x32x16_bf16 v[112:127], v[176:179], v[220:223], v[112:127]
	s_nop 11
	v_cmp_u_f32 vcc, v112, v112
	s_nop 0
	s_cbranch_vccnz Lkvretry_18
Lkvok_19:
	s_nop 9
	v_cvt_pk_bf16_f32 v96, v112, v113
	v_cvt_pk_bf16_f32 v97, v114, v115
	ds_write_b64 v242, v[96:97]
	s_waitcnt lgkmcnt(0)
	s_barrier
	ds_read_b128 v[72:75], v243
	ds_read_b128 v[76:79], v243 offset:1024
	s_waitcnt lgkmcnt(1)
	v_mfma_f32_32x32x16_bf16 v[128:143], v[72:75], v[248:251], 0
	s_waitcnt lgkmcnt(0)
	v_mfma_f32_32x32x16_bf16 v[128:143], v[76:79], v[252:255], v[128:143]
	s_mov_b32 s40, s68
	s_add_u32 s41, s68, 4096
	s_add_u32 s42, s68, 8192
	s_add_u32 s43, s68, 12288
	s_add_u32 s44, s68, 16384
	s_add_u32 s45, s68, 20480
	s_add_u32 s46, s68, 24576
	s_add_u32 s47, s68, 28672
	s_nop 3
	v_add_f32 v96, s92, v140
	v_mov_b32 v97, v96
	s_nop 1
	v_permlane32_swap_b32 v96, v97
	v_rcp_f32 v97, v97
	s_nop 0
	v_cndmask_b32 v96, v97, 0, s[84:85]
	v_pk_mul_f32 v[128:129], v[128:129], v[96:97] op_sel:[0,1] op_sel_hi:[1,1]
	v_pk_mul_f32 v[130:131], v[130:131], v[96:97] op_sel:[0,1] op_sel_hi:[1,1]
	v_pk_mul_f32 v[132:133], v[132:133], v[96:97] op_sel:[0,1] op_sel_hi:[1,1]
	v_pk_mul_f32 v[134:135], v[134:135], v[96:97] op_sel:[0,1] op_sel_hi:[1,1]
	v_cvt_pk_bf16_f32 v224, v128, v129
	v_cvt_pk_bf16_f32 v225, v130, v131
	v_cvt_pk_bf16_f32 v226, v132, v133
	v_cvt_pk_bf16_f32 v227, v134, v135
	buffer_store_dwordx4 v[224:227], v4, s[28:31], s50 offen offset:0
	v_pk_mul_f32 v[136:137], v[136:137], v[96:97] op_sel:[0,1] op_sel_hi:[1,1]
	v_pk_mul_f32 v[138:139], v[138:139], v[96:97] op_sel:[0,1] op_sel_hi:[1,1]
	v_pk_mul_f32 v[140:141], v[140:141], v[96:97] op_sel_hi:[1,0]
	v_pk_mul_f32 v[142:143], v[142:143], v[96:97] op_sel_hi:[1,0]
	v_cvt_pk_bf16_f32 v228, v136, v137
	v_cvt_pk_bf16_f32 v229, v138, v139
	v_cvt_pk_bf16_f32 v230, v140, v141
	v_cvt_pk_bf16_f32 v231, v142, v143
	buffer_store_dwordx4 v[228:231], v4, s[28:31], s50 offen offset:1024
	s_add_u32 m0, s90, 0
	s_mov_b32 s54, 0
	buffer_load_dwordx4 v7, s[16:19], s54 offen lds
	s_add_u32 m0, s90, 4096
	s_mov_b32 s54, 114688
	buffer_load_dwordx4 v7, s[16:19], s54 offen lds
	s_add_u32 m0, s90, 8192
	s_mov_b32 s54, 229376
	buffer_load_dwordx4 v7, s[16:19], s54 offen lds
	s_add_u32 m0, s90, 12288
	s_mov_b32 s54, 344064
	buffer_load_dwordx4 v7, s[16:19], s54 offen lds
	s_add_u32 m0, s90, 16384
	s_mov_b32 s54, 458752
	buffer_load_dwordx4 v7, s[16:19], s54 offen lds
	s_add_u32 m0, s90, 20480
	s_mov_b32 s54, 573440
	buffer_load_dwordx4 v7, s[16:19], s54 offen lds
	s_add_u32 m0, s90, 24576
	s_mov_b32 s54, 688128
	buffer_load_dwordx4 v7, s[16:19], s54 offen lds
	s_waitcnt vmcnt(7)
	s_mov_b64 exec, 1
	buffer_store_dword v11, off, s[28:31], s74 offset:0
	s_mov_b64 exec, -1
	s_cmp_ge_u32 s62, 14
	s_cbranch_scc1 L_idle_fast0
	s_add_u32 m0, s90, 28672
	s_mov_b32 s54, 802816
	buffer_load_dwordx4 v7, s[16:19], s54 offen lds
	s_add_u32 m0, s90, 32768
	s_mov_b32 s54, 917504
	buffer_load_dwordx4 v7, s[16:19], s54 offen lds
	s_add_u32 m0, s90, 36864
	s_mov_b32 s54, 1032192
	buffer_load_dwordx4 v7, s[16:19], s54 offen lds
	s_add_u32 m0, s90, 40960
	s_mov_b32 s54, 1146880
	buffer_load_dwordx4 v7, s[16:19], s54 offen lds
	s_add_u32 m0, s90, 45056
	s_mov_b32 s54, 1261568
	buffer_load_dwordx4 v7, s[16:19], s54 offen lds
	s_add_u32 m0, s90, 49152
	s_mov_b32 s54, 1376256
	buffer_load_dwordx4 v7, s[16:19], s54 offen lds
	s_add_u32 m0, s90, 53248
	s_mov_b32 s54, 1490944
	buffer_load_dwordx4 v7, s[16:19], s54 offen lds
	s_lshr_b32 s48, s64, 1
	s_lshl_b32 s48, s48, 9
	s_and_b32 s49, s64, 1
	s_mul_i32 s49, s49, 28672
	s_add_u32 s48, s48, s49
	s_add_u32 s48, s48, 86016
	v_add_u32 v100, s48, v21
	v_mov_b32 v232, 0x3f803f80
	v_mov_b32 v233, 0x3f803f80
	v_mov_b32 v234, 0x3f803f80
	v_mov_b32 v235, 0x3f803f80
	ds_read_b64_tr_b16 v[72:73], v100 offset:0
	ds_read_b64_tr_b16 v[74:75], v100 offset:1024
	ds_read_b64_tr_b16 v[76:77], v100 offset:2048
	ds_read_b64_tr_b16 v[78:79], v100 offset:3072
	ds_read_b64_tr_b16 v[80:81], v100 offset:4096
	ds_read_b64_tr_b16 v[82:83], v100 offset:5120
	ds_read_b64_tr_b16 v[84:85], v100 offset:6144
	ds_read_b64_tr_b16 v[86:87], v100 offset:7168
	ds_read_b64_tr_b16 v[88:89], v100 offset:8192
	ds_read_b64_tr_b16 v[90:91], v100 offset:9216
	s_waitcnt lgkmcnt(8)
	v_mfma_f32_32x32x16_bf16 v[112:127], v[232:235], v[72:75], 0
	ds_read_b64_tr_b16 v[92:93], v100 offset:10240
	ds_read_b64_tr_b16 v[94:95], v100 offset:11264
	s_waitcnt lgkmcnt(8)
	v_mfma_f32_32x32x16_bf16 v[112:127], v[232:235], v[76:79], v[112:127]
	ds_read_b64_tr_b16 v[72:73], v100 offset:12288
	ds_read_b64_tr_b16 v[74:75], v100 offset:13312
	s_waitcnt lgkmcnt(8)
	v_mfma_f32_32x32x16_bf16 v[112:127], v[232:235], v[80:83], v[112:127]
	ds_read_b64_tr_b16 v[76:77], v100 offset:14336
	ds_read_b64_tr_b16 v[78:79], v100 offset:15360
	s_waitcnt lgkmcnt(8)
	v_mfma_f32_32x32x16_bf16 v[112:127], v[232:235], v[84:87], v[112:127]
	ds_read_b64_tr_b16 v[80:81], v100 offset:16384
	ds_read_b64_tr_b16 v[82:83], v100 offset:17408
	s_waitcnt lgkmcnt(8)
	v_mfma_f32_32x32x16_bf16 v[112:127], v[232:235], v[88:91], v[112:127]
	ds_read_b64_tr_b16 v[84:85], v100 offset:18432
	ds_read_b64_tr_b16 v[86:87], v100 offset:19456
	s_waitcnt lgkmcnt(8)
	v_mfma_f32_32x32x16_bf16 v[112:127], v[232:235], v[92:95], v[112:127]
	ds_read_b64_tr_b16 v[88:89], v100 offset:20480
	ds_read_b64_tr_b16 v[90:91], v100 offset:21504
	s_waitcnt lgkmcnt(8)
	v_mfma_f32_32x32x16_bf16 v[112:127], v[232:235], v[72:75], v[112:127]
	ds_read_b64_tr_b16 v[92:93], v100 offset:22528
	ds_read_b64_tr_b16 v[94:95], v100 offset:23552
	s_waitcnt lgkmcnt(8)
	v_mfma_f32_32x32x16_bf16 v[112:127], v[232:235], v[76:79], v[112:127]
	ds_read_b64_tr_b16 v[72:73], v100 offset:24576
	ds_read_b64_tr_b16 v[74:75], v100 offset:25600
	s_waitcnt lgkmcnt(8)
	v_mfma_f32_32x32x16_bf16 v[112:127], v[232:235], v[80:83], v[112:127]
	ds_read_b64_tr_b16 v[76:77], v100 offset:26624
	ds_read_b64_tr_b16 v[78:79], v100 offset:27648
	s_waitcnt lgkmcnt(8)
	v_mfma_f32_32x32x16_bf16 v[112:127], v[232:235], v[84:87], v[112:127]
	s_waitcnt lgkmcnt(6)
	v_mfma_f32_32x32x16_bf16 v[112:127], v[232:235], v[88:91], v[112:127]
	s_waitcnt lgkmcnt(4)
	v_mfma_f32_32x32x16_bf16 v[112:127], v[232:235], v[92:95], v[112:127]
	s_waitcnt lgkmcnt(2)
	v_mfma_f32_32x32x16_bf16 v[112:127], v[232:235], v[72:75], v[112:127]
	s_waitcnt lgkmcnt(0)
	v_mfma_f32_32x32x16_bf16 v[112:127], v[232:235], v[76:79], v[112:127]
	s_lshr_b32 s48, s90, 3
	s_add_u32 s48, s48, 162816
	v_and_b32 v100, 0x7c, v2
	v_add_u32 v100, s48, v100
	s_nop 7
	ds_write_b32 v100, v112
Lpoll_23:
	buffer_load_dword v14, v5, s[28:31], s73 offen offset:0 sc1
	s_waitcnt vmcnt(0)
	v_cmp_ne_u32 vcc, s65, v14
	s_nop 0
	s_cbranch_vccz Lpdone_24
	s_sub_u32 s67, s67, 1
	s_cbranch_scc0 Lpoll_23
	s_mov_b32 s67, 0
Lpdone_24:
	buffer_load_dwordx4 a[0:3], v4, s[28:31], s40 offen offset:0 sc1
	buffer_load_dwordx4 a[4:7], v4, s[28:31], s40 offen offset:1024 sc1
	buffer_load_dwordx4 a[8:11], v4, s[28:31], s40 offen offset:2048 sc1
	buffer_load_dwordx4 a[12:15], v4, s[28:31], s40 offen offset:3072 sc1
	buffer_load_dwordx4 a[16:19], v4, s[28:31], s41 offen offset:0 sc1
	buffer_load_dwordx4 a[20:23], v4, s[28:31], s41 offen offset:1024 sc1
	buffer_load_dwordx4 a[24:27], v4, s[28:31], s41 offen offset:2048 sc1
	buffer_load_dwordx4 a[28:31], v4, s[28:31], s41 offen offset:3072 sc1
	buffer_load_dwordx4 a[32:35], v4, s[28:31], s42 offen offset:0 sc1
	buffer_load_dwordx4 a[36:39], v4, s[28:31], s42 offen offset:1024 sc1
	s_waitcnt lgkmcnt(0)
	s_barrier
	ds_read_b64_tr_b16 v[72:73], v21 offset:57344
	ds_read_b64_tr_b16 v[74:75], v21 offset:57856
	ds_read_b64_tr_b16 v[76:77], v21 offset:58368
	ds_read_b64_tr_b16 v[78:79], v21 offset:58880
	ds_read_b64_tr_b16 v[80:81], v21 offset:59136
	ds_read_b64_tr_b16 v[82:83], v21 offset:59648
	ds_read_b64_tr_b16 v[84:85], v21 offset:60160
	ds_read_b64_tr_b16 v[86:87], v21 offset:60672
	buffer_load_dwordx4 a[40:43], v4, s[28:31], s42 offen offset:2048 sc1
	s_waitcnt lgkmcnt(4) vmcnt(10)
	v_mfma_f32_32x32x16_bf16 v[24:39], v[72:75], a[0:3], v[24:39]
	ds_read_b64_tr_b16 v[88:89], v21 offset:60928
	ds_read_b64_tr_b16 v[90:91], v21 offset:61440
	buffer_load_dwordx4 a[44:47], v4, s[28:31], s42 offen offset:3072 sc1
	s_waitcnt vmcnt(10)
	v_mfma_f32_32x32x16_bf16 v[24:39], v[76:79], a[4:7], v[24:39]
	ds_read_b64_tr_b16 v[92:93], v21 offset:61952
	ds_read_b64_tr_b16 v[94:95], v21 offset:62464
	buffer_load_dwordx4 a[48:51], v4, s[28:31], s43 offen offset:0 sc1
	s_waitcnt lgkmcnt(4) vmcnt(10)
	v_mfma_f32_32x32x16_bf16 v[24:39], v[80:83], a[8:11], v[24:39]
	ds_read_b64_tr_b16 v[72:73], v21 offset:62720
	ds_read_b64_tr_b16 v[74:75], v21 offset:63232
	buffer_load_dwordx4 a[52:55], v4, s[28:31], s43 offen offset:1024 sc1
	s_waitcnt vmcnt(10)
	v_mfma_f32_32x32x16_bf16 v[24:39], v[84:87], a[12:15], v[24:39]
	ds_read_b64_tr_b16 v[76:77], v21 offset:63744
	ds_read_b64_tr_b16 v[78:79], v21 offset:64256
	buffer_load_dwordx4 a[56:59], v4, s[28:31], s43 offen offset:2048 sc1
	s_waitcnt lgkmcnt(4) vmcnt(10)
	v_mfma_f32_32x32x16_bf16 v[24:39], v[88:91], a[16:19], v[24:39]
	ds_read_b64_tr_b16 v[80:81], v21 offset:64512
	ds_read_b64_tr_b16 v[82:83], v21 offset:65024
	buffer_load_dwordx4 a[60:63], v4, s[28:31], s43 offen offset:3072 sc1
	s_waitcnt vmcnt(10)
	v_mfma_f32_32x32x16_bf16 v[24:39], v[92:95], a[20:23], v[24:39]
	ds_read_b64_tr_b16 v[84:85], v22 offset:0
	ds_read_b64_tr_b16 v[86:87], v22 offset:512
	buffer_load_dwordx4 a[64:67], v4, s[28:31], s44 offen offset:0 sc1
	s_waitcnt lgkmcnt(4) vmcnt(10)
	v_mfma_f32_32x32x16_bf16 v[24:39], v[72:75], a[24:27], v[24:39]
	ds_read_b64_tr_b16 v[88:89], v22 offset:768
	ds_read_b64_tr_b16 v[90:91], v22 offset:1280
	buffer_load_dwordx4 a[68:71], v4, s[28:31], s44 offen offset:1024 sc1
	s_waitcnt vmcnt(10)
	v_mfma_f32_32x32x16_bf16 v[24:39], v[76:79], a[28:31], v[24:39]
	ds_read_b64_tr_b16 v[92:93], v22 offset:1792
	ds_read_b64_tr_b16 v[94:95], v22 offset:2304
	buffer_load_dwordx4 a[72:75], v4, s[28:31], s44 offen offset:2048 sc1
	s_waitcnt lgkmcnt(4) vmcnt(10)
	v_mfma_f32_32x32x16_bf16 v[24:39], v[80:83], a[32:35], v[24:39]
	ds_read_b64_tr_b16 v[72:73], v22 offset:2560
	ds_read_b64_tr_b16 v[74:75], v22 offset:3072
	buffer_load_dwordx4 a[76:79], v4, s[28:31], s44 offen offset:3072 sc1
	s_waitcnt vmcnt(10)
	v_mfma_f32_32x32x16_bf16 v[24:39], v[84:87], a[36:39], v[24:39]
	ds_read_b64_tr_b16 v[76:77], v22 offset:3584
	ds_read_b64_tr_b16 v[78:79], v22 offset:4096
	buffer_load_dwordx4 a[80:83], v4, s[28:31], s45 offen offset:0 sc1
	s_waitcnt lgkmcnt(4) vmcnt(10)
	v_mfma_f32_32x32x16_bf16 v[24:39], v[88:91], a[40:43], v[24:39]
	ds_read_b64_tr_b16 v[80:81], v22 offset:4352
	ds_read_b64_tr_b16 v[82:83], v22 offset:4864
	buffer_load_dwordx4 a[84:87], v4, s[28:31], s45 offen offset:1024 sc1
	s_waitcnt vmcnt(10)
	v_mfma_f32_32x32x16_bf16 v[24:39], v[92:95], a[44:47], v[24:39]
	ds_read_b64_tr_b16 v[84:85], v22 offset:5376
	ds_read_b64_tr_b16 v[86:87], v22 offset:5888
	buffer_load_dwordx4 a[88:91], v4, s[28:31], s45 offen offset:2048 sc1
	s_waitcnt lgkmcnt(4) vmcnt(10)
	v_mfma_f32_32x32x16_bf16 v[24:39], v[72:75], a[48:51], v[24:39]
	ds_read_b64_tr_b16 v[88:89], v22 offset:6144
	ds_read_b64_tr_b16 v[90:91], v22 offset:6656
	buffer_load_dwordx4 a[92:95], v4, s[28:31], s45 offen offset:3072 sc1
	s_waitcnt vmcnt(10)
	v_mfma_f32_32x32x16_bf16 v[24:39], v[76:79], a[52:55], v[24:39]
	ds_read_b64_tr_b16 v[92:93], v22 offset:7168
	ds_read_b64_tr_b16 v[94:95], v22 offset:7680
	buffer_load_dwordx4 a[96:99], v4, s[28:31], s46 offen offset:0 sc1
	s_waitcnt lgkmcnt(4) vmcnt(10)
	v_mfma_f32_32x32x16_bf16 v[24:39], v[80:83], a[56:59], v[24:39]
	ds_read_b64_tr_b16 v[72:73], v22 offset:7936
	ds_read_b64_tr_b16 v[74:75], v22 offset:8448
	buffer_load_dwordx4 a[100:103], v4, s[28:31], s46 offen offset:1024 sc1
	s_waitcnt vmcnt(10)
	v_mfma_f32_32x32x16_bf16 v[24:39], v[84:87], a[60:63], v[24:39]
	ds_read_b64_tr_b16 v[76:77], v22 offset:8960
	ds_read_b64_tr_b16 v[78:79], v22 offset:9472
	buffer_load_dwordx4 a[104:107], v4, s[28:31], s46 offen offset:2048 sc1
	s_waitcnt lgkmcnt(4) vmcnt(10)
	v_mfma_f32_32x32x16_bf16 v[24:39], v[88:91], a[64:67], v[24:39]
	ds_read_b64_tr_b16 v[80:81], v22 offset:9728
	ds_read_b64_tr_b16 v[82:83], v22 offset:10240
	buffer_load_dwordx4 a[108:111], v4, s[28:31], s46 offen offset:3072 sc1
	s_waitcnt vmcnt(10)
	v_mfma_f32_32x32x16_bf16 v[24:39], v[92:95], a[68:71], v[24:39]
	ds_read_b64_tr_b16 v[84:85], v22 offset:10752
	ds_read_b64_tr_b16 v[86:87], v22 offset:11264
	buffer_load_dwordx4 a[112:115], v4, s[28:31], s47 offen offset:0 sc1
	s_waitcnt lgkmcnt(4) vmcnt(10)
	v_mfma_f32_32x32x16_bf16 v[24:39], v[72:75], a[72:75], v[24:39]
	ds_read_b64_tr_b16 v[88:89], v22 offset:11520
	ds_read_b64_tr_b16 v[90:91], v22 offset:12032
	buffer_load_dwordx4 a[116:119], v4, s[28:31], s47 offen offset:1024 sc1
	s_waitcnt vmcnt(10)
	v_mfma_f32_32x32x16_bf16 v[24:39], v[76:79], a[76:79], v[24:39]
	ds_read_b64_tr_b16 v[92:93], v22 offset:12544
	ds_read_b64_tr_b16 v[94:95], v22 offset:13056
	buffer_load_dwordx4 a[120:123], v4, s[28:31], s47 offen offset:2048 sc1
	s_waitcnt lgkmcnt(4) vmcnt(10)
	v_mfma_f32_32x32x16_bf16 v[24:39], v[80:83], a[80:83], v[24:39]
	ds_read_b64_tr_b16 v[72:73], v22 offset:13312
	ds_read_b64_tr_b16 v[74:75], v22 offset:13824
	buffer_load_dwordx4 a[124:127], v4, s[28:31], s47 offen offset:3072 sc1
	s_waitcnt vmcnt(10)
	v_mfma_f32_32x32x16_bf16 v[24:39], v[84:87], a[84:87], v[24:39]
	ds_read_b64_tr_b16 v[76:77], v22 offset:14336
	ds_read_b64_tr_b16 v[78:79], v22 offset:14848
	s_waitcnt lgkmcnt(4) vmcnt(9)
	v_mfma_f32_32x32x16_bf16 v[24:39], v[88:91], a[88:91], v[24:39]
	ds_read_b64_tr_b16 v[80:81], v22 offset:15104
	ds_read_b64_tr_b16 v[82:83], v22 offset:15616
	s_waitcnt vmcnt(8)
	v_mfma_f32_32x32x16_bf16 v[24:39], v[92:95], a[92:95], v[24:39]
	ds_read_b64_tr_b16 v[84:85], v22 offset:16128
	ds_read_b64_tr_b16 v[86:87], v22 offset:16640
	s_waitcnt lgkmcnt(4) vmcnt(7)
	v_mfma_f32_32x32x16_bf16 v[24:39], v[72:75], a[96:99], v[24:39]
	ds_read_b64_tr_b16 v[88:89], v22 offset:16896
	ds_read_b64_tr_b16 v[90:91], v22 offset:17408
	s_waitcnt vmcnt(6)
	v_mfma_f32_32x32x16_bf16 v[24:39], v[76:79], a[100:103], v[24:39]
	ds_read_b64_tr_b16 v[92:93], v22 offset:17920
	ds_read_b64_tr_b16 v[94:95], v22 offset:18432
	s_waitcnt lgkmcnt(4) vmcnt(5)
	v_mfma_f32_32x32x16_bf16 v[24:39], v[80:83], a[104:107], v[24:39]
	ds_read_b64_tr_b16 v[72:73], v22 offset:18688
	ds_read_b64_tr_b16 v[74:75], v22 offset:19200
	s_waitcnt vmcnt(4)
	v_mfma_f32_32x32x16_bf16 v[24:39], v[84:87], a[108:111], v[24:39]
	ds_read_b64_tr_b16 v[76:77], v22 offset:19712
	ds_read_b64_tr_b16 v[78:79], v22 offset:20224
	s_waitcnt lgkmcnt(4) vmcnt(3)
	v_mfma_f32_32x32x16_bf16 v[24:39], v[88:91], a[112:115], v[24:39]
	s_waitcnt vmcnt(2)
	v_mfma_f32_32x32x16_bf16 v[24:39], v[92:95], a[116:119], v[24:39]
	s_waitcnt lgkmcnt(0) vmcnt(1)
	v_mfma_f32_32x32x16_bf16 v[24:39], v[72:75], a[120:123], v[24:39]
	s_waitcnt vmcnt(0)
	v_mfma_f32_32x32x16_bf16 v[24:39], v[76:79], a[124:127], v[24:39]
	s_lshl_b32 s53, s62, 11
	s_add_u32 s53, s53, s68
	s_add_u32 s53, s53, 32768
	s_lshl_b32 s49, s62, 8
	s_add_u32 s49, s49, s68
	s_add_u32 s49, s49, 61440
	s_add_u32 s48, s68, 32768
	s_add_u32 s40, s48, 0
	s_add_u32 s41, s48, 4096
	s_add_u32 s42, s48, 8192
	s_add_u32 s43, s48, 12288
	s_add_u32 s44, s48, 16384
	s_add_u32 s45, s48, 20480
	s_add_u32 s46, s48, 24576
	s_add_u32 s52, s68, 61440
	v_cvt_pk_bf16_f32 v224, v24, v25
	v_cvt_pk_bf16_f32 v225, v26, v27
	v_cvt_pk_bf16_f32 v226, v28, v29
	v_cvt_pk_bf16_f32 v227, v30, v31
	buffer_store_dwordx4 v[224:227], v4, s[28:31], s53 offen
	v_cvt_pk_bf16_f32 v228, v32, v33
	v_cvt_pk_bf16_f32 v229, v34, v35
	v_cvt_pk_bf16_f32 v230, v36, v37
	v_cvt_pk_bf16_f32 v231, v38, v39
	buffer_store_dwordx4 v[228:231], v4, s[28:31], s53 offen offset:1024
	v_pk_add_f32 v[96:97], v[24:25], v[26:27]
	v_pk_mul_f32 v[98:99], v[24:25], v[24:25]
	v_pk_fma_f32 v[98:99], v[26:27], v[26:27], v[98:99]
	v_pk_fma_f32 v[98:99], v[28:29], v[28:29], v[98:99]
	v_pk_add_f32 v[96:97], v[96:97], v[28:29]
	v_pk_fma_f32 v[98:99], v[30:31], v[30:31], v[98:99]
	v_pk_add_f32 v[96:97], v[96:97], v[30:31]
	v_pk_fma_f32 v[98:99], v[32:33], v[32:33], v[98:99]
	v_pk_add_f32 v[96:97], v[96:97], v[32:33]
	v_pk_fma_f32 v[98:99], v[34:35], v[34:35], v[98:99]
	v_pk_add_f32 v[96:97], v[96:97], v[34:35]
	v_pk_fma_f32 v[98:99], v[36:37], v[36:37], v[98:99]
	v_pk_add_f32 v[96:97], v[96:97], v[36:37]
	v_pk_fma_f32 v[98:99], v[38:39], v[38:39], v[98:99]
	v_pk_add_f32 v[96:97], v[96:97], v[38:39]
	v_add_f32 v96, v96, v97
	v_add_f32 v97, v98, v99
	s_nop 1
	v_permlane32_swap_b32 v96, v97
	v_add_f32 v96, v96, v97
	buffer_store_dword v96, v2, s[28:31], s49 offen
	s_lshr_b32 s50, s56, 3
	s_add_u32 s50, s50, s68
	s_add_u32 s50, s50, 65536
	s_add_u32 s51, s50, 4096
	v_add_u32 v106, s90, v4
	v_add_u32 v106, 57344, v106
	ds_read_b128 a[212:215], v106 offset:0
	ds_read_b128 a[216:219], v106 offset:4096
	ds_read_b128 a[220:223], v106 offset:8192
	ds_read_b128 a[224:227], v106 offset:12288
	ds_read_b128 a[228:231], v106 offset:16384
	ds_read_b128 a[232:235], v106 offset:20480
	ds_read_b128 a[236:239], v106 offset:24576
	s_lshr_b32 s48, s64, 1
	s_lshl_b32 s48, s48, 9
	s_and_b32 s49, s64, 1
	s_mul_i32 s49, s49, 28672
	s_add_u32 s48, s48, s49
	s_add_u32 s48, s48, 0
	v_add_u32 v100, s48, v21
	v_mov_b32 v232, 0x3f803f80
	v_mov_b32 v233, 0x3f803f80
	v_mov_b32 v234, 0x3f803f80
	v_mov_b32 v235, 0x3f803f80
	ds_read_b64_tr_b16 v[72:73], v100 offset:0
	ds_read_b64_tr_b16 v[74:75], v100 offset:1024
	ds_read_b64_tr_b16 v[76:77], v100 offset:2048
	ds_read_b64_tr_b16 v[78:79], v100 offset:3072
	ds_read_b64_tr_b16 v[80:81], v100 offset:4096
	ds_read_b64_tr_b16 v[82:83], v100 offset:5120
	ds_read_b64_tr_b16 v[84:85], v100 offset:6144
	ds_read_b64_tr_b16 v[86:87], v100 offset:7168
	ds_read_b64_tr_b16 v[88:89], v100 offset:8192
	ds_read_b64_tr_b16 v[90:91], v100 offset:9216
	s_waitcnt lgkmcnt(8)
	v_mfma_f32_32x32x16_bf16 v[112:127], v[232:235], v[72:75], 0
	ds_read_b64_tr_b16 v[92:93], v100 offset:10240
	ds_read_b64_tr_b16 v[94:95], v100 offset:11264
	s_waitcnt lgkmcnt(8)
	v_mfma_f32_32x32x16_bf16 v[112:127], v[232:235], v[76:79], v[112:127]
	s_waitcnt vmcnt(0)
	s_mov_b64 exec, 1
	buffer_store_dword v11, off, s[28:31], s74 offset:128
	s_mov_b64 exec, -1
	ds_read_b64_tr_b16 v[72:73], v100 offset:12288
	ds_read_b64_tr_b16 v[74:75], v100 offset:13312
	s_waitcnt lgkmcnt(8)
	v_mfma_f32_32x32x16_bf16 v[112:127], v[232:235], v[80:83], v[112:127]
	ds_read_b64_tr_b16 v[76:77], v100 offset:14336
	ds_read_b64_tr_b16 v[78:79], v100 offset:15360
	s_waitcnt lgkmcnt(8)
	v_mfma_f32_32x32x16_bf16 v[112:127], v[232:235], v[84:87], v[112:127]
	ds_read_b64_tr_b16 v[80:81], v100 offset:16384
	ds_read_b64_tr_b16 v[82:83], v100 offset:17408
	s_waitcnt lgkmcnt(8)
	v_mfma_f32_32x32x16_bf16 v[112:127], v[232:235], v[88:91], v[112:127]
	ds_read_b64_tr_b16 v[84:85], v100 offset:18432
	ds_read_b64_tr_b16 v[86:87], v100 offset:19456
	s_waitcnt lgkmcnt(8)
	v_mfma_f32_32x32x16_bf16 v[112:127], v[232:235], v[92:95], v[112:127]
	ds_read_b64_tr_b16 v[88:89], v100 offset:20480
	ds_read_b64_tr_b16 v[90:91], v100 offset:21504
	s_waitcnt lgkmcnt(8)
	v_mfma_f32_32x32x16_bf16 v[112:127], v[232:235], v[72:75], v[112:127]
	ds_read_b64_tr_b16 v[92:93], v100 offset:22528
	ds_read_b64_tr_b16 v[94:95], v100 offset:23552
	s_waitcnt lgkmcnt(8)
	v_mfma_f32_32x32x16_bf16 v[112:127], v[232:235], v[76:79], v[112:127]
	ds_read_b64_tr_b16 v[72:73], v100 offset:24576
	ds_read_b64_tr_b16 v[74:75], v100 offset:25600
	s_waitcnt lgkmcnt(8)
	v_mfma_f32_32x32x16_bf16 v[112:127], v[232:235], v[80:83], v[112:127]
	ds_read_b64_tr_b16 v[76:77], v100 offset:26624
	ds_read_b64_tr_b16 v[78:79], v100 offset:27648
	s_waitcnt lgkmcnt(8)
	v_mfma_f32_32x32x16_bf16 v[112:127], v[232:235], v[84:87], v[112:127]
	s_waitcnt lgkmcnt(6)
	v_mfma_f32_32x32x16_bf16 v[112:127], v[232:235], v[88:91], v[112:127]
	s_waitcnt lgkmcnt(4)
	v_mfma_f32_32x32x16_bf16 v[112:127], v[232:235], v[92:95], v[112:127]
	s_waitcnt lgkmcnt(2)
	v_mfma_f32_32x32x16_bf16 v[112:127], v[232:235], v[72:75], v[112:127]
	s_waitcnt lgkmcnt(0)
	v_mfma_f32_32x32x16_bf16 v[112:127], v[232:235], v[76:79], v[112:127]
	s_lshr_b32 s48, s90, 3
	s_add_u32 s48, s48, 162304
	v_and_b32 v100, 0x7c, v2
	v_add_u32 v100, s48, v100
	s_nop 7
	ds_write_b32 v100, v112
L_mlp_fast:
Lpoll_25:
	buffer_load_dword v14, v6, s[28:31], s73 offen offset:128 sc1
	s_waitcnt vmcnt(0)
	v_cmp_ne_u32 vcc, s65, v14
	s_nop 0
	s_cbranch_vccz Lpdone_26
	s_sub_u32 s67, s67, 1
	s_cbranch_scc0 Lpoll_25
	s_mov_b32 s67, 0
Lpdone_26:
	buffer_load_dwordx4 a[0:3], v4, s[28:31], s40 offen offset:0 sc1
	buffer_load_dwordx4 a[4:7], v4, s[28:31], s40 offen offset:1024 sc1
	buffer_load_dwordx4 a[8:11], v4, s[28:31], s40 offen offset:2048 sc1
	buffer_load_dwordx4 a[12:15], v4, s[28:31], s40 offen offset:3072 sc1
	buffer_load_dwordx4 v[224:227], v4, s[28:31], s52 offen offset:0 sc1
	buffer_load_dwordx4 v[228:231], v4, s[28:31], s52 offen offset:1024 sc1
	buffer_load_dwordx4 v[232:235], v4, s[28:31], s52 offen offset:2048 sc1
	buffer_load_dwordx4 v[236:239], v4, s[28:31], s52 offen offset:3072 sc1
	buffer_load_dwordx4 a[16:19], v4, s[28:31], s41 offen offset:0 sc1
	buffer_load_dwordx4 a[20:23], v4, s[28:31], s41 offen offset:1024 sc1
	buffer_load_dwordx4 a[24:27], v4, s[28:31], s41 offen offset:2048 sc1
	buffer_load_dwordx4 a[28:31], v4, s[28:31], s41 offen offset:3072 sc1
	buffer_load_dwordx4 a[32:35], v4, s[28:31], s42 offen offset:0 sc1
	s_waitcnt lgkmcnt(0)
	s_barrier
	s_cmp_lg_u32 s66, 0
	s_cbranch_scc1 Lskip_27
	v_and_b32 v96, 0x7c, v2
	v_add_u32 v96, 162304, v96
	ds_read_b32 v240, v96 offset:0
	ds_read_b32 v241, v96 offset:128
	ds_read_b32 v242, v96 offset:256
	ds_read_b32 v243, v96 offset:384
	ds_read_b32 v244, v96 offset:512
	ds_read_b32 v245, v96 offset:640
	ds_read_b32 v246, v96 offset:768
	ds_read_b32 v247, v96 offset:896
	v_lshlrev_b32 v248, 16, v55
	s_waitcnt lgkmcnt(6)
	v_add_f32 v240, v240, v241
	v_cndmask_b32 v240, v240, 0, s[84:85]
	v_cndmask_b32 v248, v248, 0, s[84:85]
	v_cvt_pk_bf16_f32 v53, v240, v248
	v_mov_b32 v55, 0
	v_lshlrev_b32 v102, 16, v53
	v_cvt_pk_bf16_f32 v54, v248, 0
	v_sub_f32 v102, v240, v102
	v_cvt_pk_bf16_f32 v52, v240, v102
	v_lshlrev_b32 v248, 16, v59
	s_waitcnt lgkmcnt(4)
	v_add_f32 v242, v242, v243
	v_cndmask_b32 v242, v242, 0, s[84:85]
	v_cndmask_b32 v248, v248, 0, s[84:85]
	v_cvt_pk_bf16_f32 v57, v242, v248
	v_mov_b32 v59, 0
	v_lshlrev_b32 v102, 16, v57
	v_cvt_pk_bf16_f32 v58, v248, 0
	v_sub_f32 v102, v242, v102
	v_cvt_pk_bf16_f32 v56, v242, v102
	v_lshlrev_b32 v248, 16, v63
	s_waitcnt lgkmcnt(2)
	v_add_f32 v244, v244, v245
	v_cndmask_b32 v244, v244, 0, s[84:85]
	v_cndmask_b32 v248, v248, 0, s[84:85]
	v_cvt_pk_bf16_f32 v61, v244, v248
	v_mov_b32 v63, 0
	v_lshlrev_b32 v102, 16, v61
	v_cvt_pk_bf16_f32 v62, v248, 0
	v_sub_f32 v102, v244, v102
	v_cvt_pk_bf16_f32 v60, v244, v102
	v_lshlrev_b32 v248, 16, v67
	s_waitcnt lgkmcnt(0)
	v_add_f32 v246, v246, v247
	v_cndmask_b32 v246, v246, 0, s[84:85]
	v_cndmask_b32 v248, v248, 0, s[84:85]
	v_cvt_pk_bf16_f32 v65, v246, v248
	v_mov_b32 v67, 0
	v_lshlrev_b32 v102, 16, v65
	v_cvt_pk_bf16_f32 v66, v248, 0
	v_sub_f32 v102, v246, v102
	v_cvt_pk_bf16_f32 v64, v246, v102
Lskip_27:
	ds_read_b64_tr_b16 v[72:73], v21 offset:0
	ds_read_b64_tr_b16 v[74:75], v21 offset:1024
	ds_read_b64_tr_b16 v[76:77], v21 offset:512
	ds_read_b64_tr_b16 v[78:79], v21 offset:1536
	ds_read_b64_tr_b16 v[80:81], v21 offset:2048
	ds_read_b64_tr_b16 v[82:83], v21 offset:3072
	ds_read_b64_tr_b16 v[84:85], v21 offset:2560
	ds_read_b64_tr_b16 v[86:87], v21 offset:3584
	buffer_load_dwordx4 a[36:39], v4, s[28:31], s42 offen offset:1024 sc1
	s_waitcnt lgkmcnt(4) vmcnt(13)
	v_mfma_f32_32x32x16_bf16 v[112:127], v[72:75], a[0:3], 0
	ds_read_b64_tr_b16 v[88:89], v21 offset:4096
	ds_read_b64_tr_b16 v[90:91], v21 offset:5120
	v_mfma_f32_32x32x16_bf16 v[128:143], v[76:79], a[0:3], 0
	ds_read_b64_tr_b16 v[92:93], v21 offset:4608
	ds_read_b64_tr_b16 v[94:95], v21 offset:5632
	buffer_load_dwordx4 a[40:43], v4, s[28:31], s42 offen offset:2048 sc1
	s_waitcnt lgkmcnt(4) vmcnt(13)
	v_mfma_f32_32x32x16_bf16 v[112:127], v[80:83], a[4:7], v[112:127]
	ds_read_b64_tr_b16 v[72:73], v21 offset:6144
	ds_read_b64_tr_b16 v[74:75], v21 offset:7168
	v_mfma_f32_32x32x16_bf16 v[128:143], v[84:87], a[4:7], v[128:143]
	ds_read_b64_tr_b16 v[76:77], v21 offset:6656
	ds_read_b64_tr_b16 v[78:79], v21 offset:7680
	buffer_load_dwordx4 a[44:47], v4, s[28:31], s42 offen offset:3072 sc1
	s_waitcnt lgkmcnt(4) vmcnt(13)
	v_mfma_f32_32x32x16_bf16 v[112:127], v[88:91], a[8:11], v[112:127]
	ds_read_b64_tr_b16 v[80:81], v21 offset:8192
	ds_read_b64_tr_b16 v[82:83], v21 offset:9216
	v_mfma_f32_32x32x16_bf16 v[128:143], v[92:95], a[8:11], v[128:143]
	ds_read_b64_tr_b16 v[84:85], v21 offset:8704
	ds_read_b64_tr_b16 v[86:87], v21 offset:9728
	buffer_load_dwordx4 a[48:51], v4, s[28:31], s43 offen offset:0 sc1
	s_waitcnt lgkmcnt(4) vmcnt(13)
	v_mfma_f32_32x32x16_bf16 v[112:127], v[72:75], a[12:15], v[112:127]
	ds_read_b64_tr_b16 v[88:89], v21 offset:10240
	ds_read_b64_tr_b16 v[90:91], v21 offset:11264
	v_mfma_f32_32x32x16_bf16 v[128:143], v[76:79], a[12:15], v[128:143]
	ds_read_b64_tr_b16 v[92:93], v21 offset:10752
	ds_read_b64_tr_b16 v[94:95], v21 offset:11776
	buffer_load_dwordx4 a[52:55], v4, s[28:31], s43 offen offset:1024 sc1
	s_waitcnt lgkmcnt(4) vmcnt(9)
	v_mfma_f32_32x32x16_bf16 v[112:127], v[80:83], a[16:19], v[112:127]
	ds_read_b64_tr_b16 v[72:73], v21 offset:12288
	ds_read_b64_tr_b16 v[74:75], v21 offset:13312
	v_mfma_f32_32x32x16_bf16 v[128:143], v[84:87], a[16:19], v[128:143]
	ds_read_b64_tr_b16 v[76:77], v21 offset:12800
	ds_read_b64_tr_b16 v[78:79], v21 offset:13824
	buffer_load_dwordx4 a[56:59], v4, s[28:31], s43 offen offset:2048 sc1
	s_waitcnt lgkmcnt(4) vmcnt(9)
	v_mfma_f32_32x32x16_bf16 v[112:127], v[88:91], a[20:23], v[112:127]
	ds_read_b64_tr_b16 v[80:81], v21 offset:14336
	ds_read_b64_tr_b16 v[82:83], v21 offset:15360
	v_cndmask_b32 v236, v236, 0, s[84:85]
	v_mfma_f32_32x32x16_bf16 v[128:143], v[92:95], a[20:23], v[128:143]
	ds_read_b64_tr_b16 v[84:85], v21 offset:14848
	ds_read_b64_tr_b16 v[86:87], v21 offset:15872
	v_cndmask_b32 v237, v237, 0, s[84:85]
	v_cndmask_b32 v238, v238, 0, s[84:85]
	buffer_load_dwordx4 a[60:63], v4, s[28:31], s43 offen offset:3072 sc1
	s_waitcnt lgkmcnt(4) vmcnt(9)
	v_mfma_f32_32x32x16_bf16 v[112:127], v[72:75], a[24:27], v[112:127]
	ds_read_b64_tr_b16 v[88:89], v21 offset:16384
	ds_read_b64_tr_b16 v[90:91], v21 offset:17408
	v_cndmask_b32 v239, v239, 0, s[84:85]
	v_add_f32 v224, v224, v228
	v_mfma_f32_32x32x16_bf16 v[128:143], v[76:79], a[24:27], v[128:143]
	ds_read_b64_tr_b16 v[92:93], v21 offset:16896
	ds_read_b64_tr_b16 v[94:95], v21 offset:17920
	v_add_f32 v225, v225, v229
	v_add_f32 v226, v226, v230
	buffer_load_dwordx4 a[64:67], v4, s[28:31], s44 offen offset:0 sc1
	s_waitcnt lgkmcnt(4) vmcnt(9)
	v_mfma_f32_32x32x16_bf16 v[112:127], v[80:83], a[28:31], v[112:127]
	ds_read_b64_tr_b16 v[72:73], v21 offset:18432
	ds_read_b64_tr_b16 v[74:75], v21 offset:19456
	v_add_f32 v227, v227, v231
	v_add_f32 v232, v232, v236
	v_mfma_f32_32x32x16_bf16 v[128:143], v[84:87], a[28:31], v[128:143]
	ds_read_b64_tr_b16 v[76:77], v21 offset:18944
	ds_read_b64_tr_b16 v[78:79], v21 offset:19968
	v_add_f32 v233, v233, v237
	buffer_load_dwordx4 a[68:71], v4, s[28:31], s44 offen offset:1024 sc1
	s_waitcnt lgkmcnt(4) vmcnt(9)
	v_mfma_f32_32x32x16_bf16 v[112:127], v[88:91], a[32:35], v[112:127]
	ds_read_b64_tr_b16 v[80:81], v21 offset:20480
	ds_read_b64_tr_b16 v[82:83], v21 offset:21504
	v_add_f32 v234, v234, v238
	v_add_f32 v235, v235, v239
	v_mfma_f32_32x32x16_bf16 v[128:143], v[92:95], a[32:35], v[128:143]
	ds_read_b64_tr_b16 v[84:85], v21 offset:20992
	ds_read_b64_tr_b16 v[86:87], v21 offset:22016
	v_add_f32 v224, v224, v232
	v_add_f32 v225, v225, v233
	buffer_load_dwordx4 a[72:75], v4, s[28:31], s44 offen offset:2048 sc1
	s_waitcnt lgkmcnt(4) vmcnt(9)
	v_mfma_f32_32x32x16_bf16 v[112:127], v[72:75], a[36:39], v[112:127]
	ds_read_b64_tr_b16 v[88:89], v21 offset:22528
	ds_read_b64_tr_b16 v[90:91], v21 offset:23552
	v_add_f32 v226, v226, v234
	v_add_f32 v227, v227, v235
	v_mfma_f32_32x32x16_bf16 v[128:143], v[76:79], a[36:39], v[128:143]
	ds_read_b64_tr_b16 v[92:93], v21 offset:23040
	ds_read_b64_tr_b16 v[94:95], v21 offset:24064
	s_lshl_b32 s48, s64, 12
	s_add_u32 s48, s48, 143360
	buffer_load_dwordx4 a[76:79], v4, s[28:31], s44 offen offset:3072 sc1
	s_waitcnt lgkmcnt(4) vmcnt(9)
	v_mfma_f32_32x32x16_bf16 v[112:127], v[80:83], a[40:43], v[112:127]
	ds_read_b64_tr_b16 v[72:73], v21 offset:24576
	ds_read_b64_tr_b16 v[74:75], v21 offset:25600
	v_add_u32 v100, s48, v2
	v_mfma_f32_32x32x16_bf16 v[128:143], v[84:87], a[40:43], v[128:143]
	ds_read_b64_tr_b16 v[76:77], v21 offset:25088
	ds_read_b64_tr_b16 v[78:79], v21 offset:26112
	ds_write_b128 v9, v[224:227]
	ds_read_b32 v228, v100 offset:0
	buffer_load_dwordx4 a[80:83], v4, s[28:31], s45 offen offset:0 sc1
	s_waitcnt lgkmcnt(6) vmcnt(9)
	v_mfma_f32_32x32x16_bf16 v[112:127], v[88:91], a[44:47], v[112:127]
	ds_read_b64_tr_b16 v[80:81], v21 offset:26624
	ds_read_b64_tr_b16 v[82:83], v21 offset:27648
	ds_read_b32 v229, v100 offset:256
	ds_read_b32 v230, v100 offset:512
	v_mfma_f32_32x32x16_bf16 v[128:143], v[92:95], a[44:47], v[128:143]
	ds_read_b64_tr_b16 v[84:85], v21 offset:27136
	ds_read_b64_tr_b16 v[86:87], v21 offset:28160
	ds_read_b32 v231, v100 offset:768
	s_waitcnt lgkmcnt(4)
	v_add_f32 v228, v228, v229
	buffer_load_dwordx4 a[84:87], v4, s[28:31], s45 offen offset:1024 sc1
	s_waitcnt vmcnt(9)
	v_mfma_f32_32x32x16_bf16 v[112:127], v[72:75], a[48:51], v[112:127]
	ds_read_b64_tr_b16 v[88:89], v21 offset:28672
	ds_read_b64_tr_b16 v[90:91], v21 offset:29696
	s_waitcnt lgkmcnt(2)
	v_add_f32 v230, v230, v231
	v_add_f32 v224, v228, v230
	v_mfma_f32_32x32x16_bf16 v[128:143], v[76:79], a[48:51], v[128:143]
	ds_read_b64_tr_b16 v[92:93], v21 offset:29184
	ds_read_b64_tr_b16 v[94:95], v21 offset:30208
	v_mov_b32 v225, v224
	buffer_load_dwordx4 a[88:91], v4, s[28:31], s45 offen offset:2048 sc1
	s_waitcnt vmcnt(9)
	v_mfma_f32_32x32x16_bf16 v[112:127], v[80:83], a[52:55], v[112:127]
	ds_read_b64_tr_b16 v[72:73], v21 offset:30720
	ds_read_b64_tr_b16 v[74:75], v21 offset:31744
	v_permlane32_swap_b32 v224, v225
	v_mul_f32 v96, 0x3b124925, v224
	v_mfma_f32_32x32x16_bf16 v[128:143], v[84:87], a[52:55], v[128:143]
	ds_read_b64_tr_b16 v[76:77], v21 offset:31232
	ds_read_b64_tr_b16 v[78:79], v21 offset:32256
	v_mul_f32 v97, 0x3b124925, v225
	v_cvt_pk_bf16_f32 v68, -v96, -v96
	buffer_load_dwordx4 a[92:95], v4, s[28:31], s45 offen offset:3072 sc1
	s_waitcnt lgkmcnt(4) vmcnt(9)
	v_mfma_f32_32x32x16_bf16 v[112:127], v[88:91], a[56:59], v[112:127]
	ds_read_b64_tr_b16 v[80:81], v21 offset:32768
	ds_read_b64_tr_b16 v[82:83], v21 offset:33792
	v_fma_f32 v97, -v96, v96, v97
	v_and_b32 v98, s94, v68
	v_mfma_f32_32x32x16_bf16 v[128:143], v[92:95], a[56:59], v[128:143]
	ds_read_b64_tr_b16 v[84:85], v21 offset:33280
	ds_read_b64_tr_b16 v[86:87], v21 offset:34304
	v_max_f32 v97, 0, v97
	v_sub_f32 v98, -v96, v98
	buffer_load_dwordx4 a[96:99], v4, s[28:31], s46 offen offset:0 sc1
	s_waitcnt lgkmcnt(4) vmcnt(9)
	v_mfma_f32_32x32x16_bf16 v[112:127], v[72:75], a[60:63], v[112:127]
	ds_read_b64_tr_b16 v[88:89], v21 offset:34816
	ds_read_b64_tr_b16 v[90:91], v21 offset:35840
	v_add_f32 v99, 0x3727c5ac, v97
	v_mfma_f32_32x32x16_bf16 v[128:143], v[76:79], a[60:63], v[128:143]
	ds_read_b64_tr_b16 v[92:93], v21 offset:35328
	ds_read_b64_tr_b16 v[94:95], v21 offset:36352
	v_mov_b32 v71, 0
	v_rsq_f32 v12, v99
	buffer_load_dwordx4 a[100:103], v4, s[28:31], s46 offen offset:1024 sc1
	s_waitcnt lgkmcnt(4) vmcnt(9)
	v_mfma_f32_32x32x16_bf16 v[112:127], v[80:83], a[64:67], v[112:127]
	ds_read_b64_tr_b16 v[72:73], v21 offset:36864
	ds_read_b64_tr_b16 v[74:75], v21 offset:37888
	v_mul_f32 v97, v97, v12
	v_mul_f32 v97, v97, v12
	v_mfma_f32_32x32x16_bf16 v[128:143], v[84:87], a[64:67], v[128:143]
	ds_read_b64_tr_b16 v[76:77], v21 offset:37376
	ds_read_b64_tr_b16 v[78:79], v21 offset:38400
	v_add_f32 v97, 0x3727c5ac, v97
	v_rsq_f32 v97, v97
	buffer_load_dwordx4 a[104:107], v4, s[28:31], s46 offen offset:2048 sc1
	s_waitcnt lgkmcnt(4) vmcnt(9)
	v_mfma_f32_32x32x16_bf16 v[112:127], v[88:91], a[68:71], v[112:127]
	ds_read_b64_tr_b16 v[80:81], v21 offset:38912
	ds_read_b64_tr_b16 v[82:83], v21 offset:39936
	v_mul_f32 v96, v12, v97
	v_rcp_f32 v20, v96
	v_mfma_f32_32x32x16_bf16 v[128:143], v[92:95], a[68:71], v[128:143]
	ds_read_b64_tr_b16 v[84:85], v21 offset:39424
	ds_read_b64_tr_b16 v[86:87], v21 offset:40448
	v_mul_f32 v18, 0xc0135761, v96
	buffer_load_dwordx4 a[108:111], v4, s[28:31], s46 offen offset:3072 sc1
	s_waitcnt lgkmcnt(4) vmcnt(9)
	v_mfma_f32_32x32x16_bf16 v[112:127], v[72:75], a[72:75], v[112:127]
	ds_read_b64_tr_b16 v[88:89], v21 offset:40960
	ds_read_b64_tr_b16 v[90:91], v21 offset:41984
	v_mul_f32 v97, v96, v96
	v_cvt_pk_bf16_f32 v69, v98, v20
	v_mfma_f32_32x32x16_bf16 v[128:143], v[76:79], a[72:75], v[128:143]
	ds_read_b64_tr_b16 v[92:93], v21 offset:41472
	ds_read_b64_tr_b16 v[94:95], v21 offset:42496
	v_mul_f32 v97, v97, v96
	v_and_b32 v99, s94, v69
	s_add_u32 m0, s90, 57344
	s_nop 0
	buffer_load_dwordx4 v8, s[20:23], s56 offen  lds
	s_waitcnt lgkmcnt(4) vmcnt(9)
	v_mfma_f32_32x32x16_bf16 v[112:127], v[80:83], a[76:79], v[112:127]
	ds_read_b64_tr_b16 v[72:73], v21 offset:43008
	ds_read_b64_tr_b16 v[74:75], v21 offset:44032
	v_mul_f32 v19, 0xbdd2d3e8, v97
	v_sub_f32 v99, v20, v99
	v_mfma_f32_32x32x16_bf16 v[128:143], v[84:87], a[76:79], v[128:143]
	ds_read_b64_tr_b16 v[76:77], v21 offset:43520
	ds_read_b64_tr_b16 v[78:79], v21 offset:44544
	v_cvt_pk_bf16_f32 v70, v99, 0
	s_add_u32 m0, s90, 61440
	s_add_u32 s54, s56, 28672
	buffer_load_dwordx4 v8, s[20:23], s54 offen  lds
	s_waitcnt lgkmcnt(4) vmcnt(9)
	v_mfma_f32_32x32x16_bf16 v[112:127], v[88:91], a[80:83], v[112:127]
	ds_read_b64_tr_b16 v[80:81], v21 offset:45056
	ds_read_b64_tr_b16 v[82:83], v21 offset:46080
	s_lshr_b32 s41, s57, 3
	v_mfma_f32_32x32x16_bf16 v[128:143], v[92:95], a[80:83], v[128:143]
	ds_read_b64_tr_b16 v[84:85], v21 offset:45568
	ds_read_b64_tr_b16 v[86:87], v21 offset:46592
	s_add_u32 s41, s41, s68
	s_add_u32 s41, s41, 65536
	s_add_u32 m0, s90, 65536
	s_nop 0
	buffer_load_dwordx4 v8, s[20:23], s57 offen  lds
	s_waitcnt lgkmcnt(4) vmcnt(9)
	v_mfma_f32_32x32x16_bf16 v[112:127], v[72:75], a[84:87], v[112:127]
	ds_read_b64_tr_b16 v[88:89], v21 offset:47104
	ds_read_b64_tr_b16 v[90:91], v21 offset:48128
	s_lshr_b32 s42, s58, 3
	v_mfma_f32_32x32x16_bf16 v[128:143], v[76:79], a[84:87], v[128:143]
	ds_read_b64_tr_b16 v[92:93], v21 offset:47616
	ds_read_b64_tr_b16 v[94:95], v21 offset:48640
	s_add_u32 s42, s42, s68
	s_add_u32 s42, s42, 65536
	s_add_u32 m0, s90, 69632
	s_add_u32 s54, s57, 28672
	buffer_load_dwordx4 v8, s[20:23], s54 offen  lds
	s_waitcnt lgkmcnt(4) vmcnt(9)
	v_mfma_f32_32x32x16_bf16 v[112:127], v[80:83], a[88:91], v[112:127]
	ds_read_b64_tr_b16 v[72:73], v21 offset:49152
	ds_read_b64_tr_b16 v[74:75], v21 offset:50176
	s_lshr_b32 s43, s59, 3
	s_add_u32 s43, s43, s68
	v_mfma_f32_32x32x16_bf16 v[128:143], v[84:87], a[88:91], v[128:143]
	ds_read_b64_tr_b16 v[76:77], v21 offset:49664
	ds_read_b64_tr_b16 v[78:79], v21 offset:50688
	s_add_u32 s43, s43, 65536
	s_add_u32 m0, s90, 73728
	s_nop 0
	buffer_load_dwordx4 v8, s[20:23], s58 offen  lds
	s_waitcnt lgkmcnt(4) vmcnt(9)
	v_mfma_f32_32x32x16_bf16 v[112:127], v[88:91], a[92:95], v[112:127]
	ds_read_b64_tr_b16 v[80:81], v21 offset:51200
	ds_read_b64_tr_b16 v[82:83], v21 offset:52224
	s_lshr_b32 s44, s60, 3
	s_add_u32 s44, s44, s68
	v_mfma_f32_32x32x16_bf16 v[128:143], v[92:95], a[92:95], v[128:143]
	ds_read_b64_tr_b16 v[84:85], v21 offset:51712
	ds_read_b64_tr_b16 v[86:87], v21 offset:52736
	s_add_u32 s44, s44, 65536
	s_add_u32 m0, s90, 77824
	s_add_u32 s54, s58, 28672
	buffer_load_dwordx4 v8, s[20:23], s54 offen  lds
	s_waitcnt lgkmcnt(4) vmcnt(9)
	v_mfma_f32_32x32x16_bf16 v[112:127], v[72:75], a[96:99], v[112:127]
	ds_read_b64_tr_b16 v[88:89], v21 offset:53248
	ds_read_b64_tr_b16 v[90:91], v21 offset:54272
	s_lshr_b32 s45, s61, 3
	s_add_u32 s45, s45, s68
	v_mfma_f32_32x32x16_bf16 v[128:143], v[76:79], a[96:99], v[128:143]
	ds_read_b64_tr_b16 v[92:93], v21 offset:53760
	ds_read_b64_tr_b16 v[94:95], v21 offset:54784
	s_add_u32 s45, s45, 65536
	s_lshr_b32 s46, s75, 3
	s_add_u32 m0, s90, 81920
	s_nop 0
	buffer_load_dwordx4 v8, s[20:23], s59 offen  lds
	s_waitcnt lgkmcnt(4) vmcnt(9)
	v_mfma_f32_32x32x16_bf16 v[112:127], v[80:83], a[100:103], v[112:127]
	ds_read_b64_tr_b16 v[72:73], v21 offset:55296
	ds_read_b64_tr_b16 v[74:75], v21 offset:56320
	s_add_u32 s46, s46, s68
	v_mfma_f32_32x32x16_bf16 v[128:143], v[84:87], a[100:103], v[128:143]
	ds_read_b64_tr_b16 v[76:77], v21 offset:55808
	ds_read_b64_tr_b16 v[78:79], v21 offset:56832
	s_add_u32 s46, s46, 65536
	s_lshl_b32 s53, s62, 11
	s_waitcnt lgkmcnt(4) vmcnt(8)
	v_mfma_f32_32x32x16_bf16 v[112:127], v[88:91], a[104:107], v[112:127]
	s_add_u32 s53, s53, s68
	v_mfma_f32_32x32x16_bf16 v[128:143], v[92:95], a[104:107], v[128:143]
	v_mov_b32 v96, -1
	v_mov_b32 v97, -1
	s_waitcnt lgkmcnt(0) vmcnt(7)
	v_mfma_f32_32x32x16_bf16 v[112:127], v[72:75], a[108:111], v[112:127]
	v_mov_b32 v98, -1
	v_mov_b32 v99, -1
	v_mfma_f32_32x32x16_bf16 v[128:143], v[76:79], a[108:111], v[128:143]
	v_mfma_f32_32x32x16_bf16 v[112:127], v[52:55], v[68:71], v[112:127]
	v_mfma_f32_32x32x16_bf16 v[128:143], v[56:59], v[68:71], v[128:143]
	s_barrier
	ds_read_b64_tr_b16 v[72:73], v22 offset:20480
	ds_read_b64_tr_b16 v[74:75], v22 offset:21504
	ds_read_b64_tr_b16 v[76:77], v22 offset:20992
	ds_read_b64_tr_b16 v[78:79], v22 offset:22016
	ds_read_b64_tr_b16 v[80:81], v22 offset:22528
	ds_read_b64_tr_b16 v[82:83], v22 offset:23552
	ds_read_b64_tr_b16 v[84:85], v22 offset:23040
	ds_read_b64_tr_b16 v[86:87], v22 offset:24064
	buffer_load_dword v17, v16, s[28:31], s68 offen
	s_waitcnt lgkmcnt(4)
	v_mfma_f32_32x32x16_bf16 v[144:159], v[72:75], a[0:3], 0
	ds_read_b64_tr_b16 v[88:89], v22 offset:24576
	ds_read_b64_tr_b16 v[90:91], v22 offset:25600
	v_mul_f32 v104, v112, v112
	v_mul_f32 v105, v113, v113
	v_mul_f32 v106, v114, v114
	v_mul_f32 v107, v115, v115
	v_mfma_f32_32x32x16_bf16 v[160:175], v[76:79], a[0:3], 0
	ds_read_b64_tr_b16 v[92:93], v22 offset:25088
	ds_read_b64_tr_b16 v[94:95], v22 offset:26112
	v_fma_f32 v104, v104, v19, v18
	v_fma_f32 v105, v105, v19, v18
	v_fma_f32 v106, v106, v19, v18
	v_fma_f32 v107, v107, v19, v18
	s_add_u32 m0, s90, 0
	s_add_u32 s54, s59, 28672
	buffer_load_dwordx4 v8, s[20:23], s54 offen  lds
	s_waitcnt lgkmcnt(4)
	v_mfma_f32_32x32x16_bf16 v[144:159], v[80:83], a[4:7], v[144:159]
	ds_read_b64_tr_b16 v[72:73], v22 offset:26624
	ds_read_b64_tr_b16 v[74:75], v22 offset:27648
	v_mul_f32 v104, v104, v112
	v_mul_f32 v105, v105, v113
	v_mul_f32 v106, v106, v114
	v_mul_f32 v107, v107, v115
	v_exp_f32 v104, v104
	v_mfma_f32_32x32x16_bf16 v[160:175], v[84:87], a[4:7], v[160:175]
	ds_read_b64_tr_b16 v[76:77], v22 offset:27136
	ds_read_b64_tr_b16 v[78:79], v22 offset:28160
	v_exp_f32 v105, v105
	v_exp_f32 v106, v106
	v_exp_f32 v107, v107
	v_fma_f32 v104, v104, v20, v20
	s_add_u32 m0, s90, 4096
	s_nop 0
	buffer_load_dwordx4 v8, s[20:23], s60 offen  lds
	s_waitcnt lgkmcnt(4)
	v_mfma_f32_32x32x16_bf16 v[144:159], v[88:91], a[8:11], v[144:159]
	ds_read_b64_tr_b16 v[80:81], v22 offset:28672
	ds_read_b64_tr_b16 v[82:83], v22 offset:29696
	v_fma_f32 v105, v105, v20, v20
	v_fma_f32 v106, v106, v20, v20
	v_fma_f32 v107, v107, v20, v20
	v_rcp_f32 v104, v104
	v_rcp_f32 v105, v105
	v_mfma_f32_32x32x16_bf16 v[160:175], v[92:95], a[8:11], v[160:175]
	ds_read_b64_tr_b16 v[84:85], v22 offset:29184
	ds_read_b64_tr_b16 v[86:87], v22 offset:30208
	v_rcp_f32 v106, v106
	v_rcp_f32 v107, v107
	v_mul_f32 v112, v112, v104
	v_mul_f32 v113, v113, v105
	s_add_u32 m0, s90, 8192
	s_add_u32 s54, s60, 28672
	buffer_load_dwordx4 v8, s[20:23], s54 offen  lds
	s_waitcnt lgkmcnt(4)
	v_mfma_f32_32x32x16_bf16 v[144:159], v[72:75], a[12:15], v[144:159]
	ds_read_b64_tr_b16 v[88:89], v22 offset:30720
	ds_read_b64_tr_b16 v[90:91], v22 offset:31744
	v_mul_f32 v114, v114, v106
	v_mul_f32 v115, v115, v107
	v_cvt_pk_bf16_f32 v224, v112, v113
	v_cvt_pk_bf16_f32 v225, v114, v115
	v_mul_f32 v108, v116, v116
	v_mfma_f32_32x32x16_bf16 v[160:175], v[76:79], a[12:15], v[160:175]
	ds_read_b64_tr_b16 v[92:93], v22 offset:31232
	ds_read_b64_tr_b16 v[94:95], v22 offset:32256
	v_mul_f32 v109, v117, v117
	v_mul_f32 v110, v118, v118
	v_mul_f32 v111, v119, v119
	v_fma_f32 v108, v108, v19, v18
	s_add_u32 m0, s90, 12288
	s_nop 0
	buffer_load_dwordx4 v8, s[20:23], s61 offen  lds
	s_waitcnt lgkmcnt(4)
	v_mfma_f32_32x32x16_bf16 v[144:159], v[80:83], a[16:19], v[144:159]
	ds_read_b64_tr_b16 v[72:73], v22 offset:32768
	ds_read_b64_tr_b16 v[74:75], v22 offset:33792
	v_fma_f32 v109, v109, v19, v18
	v_fma_f32 v110, v110, v19, v18
	v_fma_f32 v111, v111, v19, v18
	v_mul_f32 v108, v108, v116
	v_mfma_f32_32x32x16_bf16 v[160:175], v[84:87], a[16:19], v[160:175]
	ds_read_b64_tr_b16 v[76:77], v22 offset:33280
	ds_read_b64_tr_b16 v[78:79], v22 offset:34304
	v_mul_f32 v109, v109, v117
	v_mul_f32 v110, v110, v118
	v_mul_f32 v111, v111, v119
	v_exp_f32 v108, v108
	v_exp_f32 v109, v109
	s_add_u32 m0, s90, 16384
	s_add_u32 s54, s61, 28672
	buffer_load_dwordx4 v8, s[20:23], s54 offen  lds
	s_waitcnt lgkmcnt(4)
	v_mfma_f32_32x32x16_bf16 v[144:159], v[88:91], a[20:23], v[144:159]
	ds_read_b64_tr_b16 v[80:81], v22 offset:34816
	ds_read_b64_tr_b16 v[82:83], v22 offset:35840
	v_exp_f32 v110, v110
	v_exp_f32 v111, v111
	v_fma_f32 v108, v108, v20, v20
	v_fma_f32 v109, v109, v20, v20
	v_mfma_f32_32x32x16_bf16 v[160:175], v[92:95], a[20:23], v[160:175]
	ds_read_b64_tr_b16 v[84:85], v22 offset:35328
	ds_read_b64_tr_b16 v[86:87], v22 offset:36352
	v_fma_f32 v110, v110, v20, v20
	v_fma_f32 v111, v111, v20, v20
	v_rcp_f32 v108, v108
	v_rcp_f32 v109, v109
	v_rcp_f32 v110, v110
	s_add_u32 m0, s90, 20480
	s_nop 0
	buffer_load_dwordx4 v8, s[20:23], s75 offen  lds
	s_waitcnt lgkmcnt(4)
	v_mfma_f32_32x32x16_bf16 v[144:159], v[72:75], a[24:27], v[144:159]
	ds_read_b64_tr_b16 v[88:89], v22 offset:36864
	ds_read_b64_tr_b16 v[90:91], v22 offset:37888
	v_rcp_f32 v111, v111
	v_mul_f32 v116, v116, v108
	v_mul_f32 v117, v117, v109
	v_mul_f32 v118, v118, v110
	v_mfma_f32_32x32x16_bf16 v[160:175], v[76:79], a[24:27], v[160:175]
	ds_read_b64_tr_b16 v[92:93], v22 offset:37376
	ds_read_b64_tr_b16 v[94:95], v22 offset:38400
	v_mul_f32 v119, v119, v111
	v_cvt_pk_bf16_f32 v226, v116, v117
	v_cvt_pk_bf16_f32 v227, v118, v119
	v_mul_f32 v104, v120, v120
	v_mul_f32 v105, v121, v121
	s_add_u32 m0, s90, 24576
	s_add_u32 s54, s75, 28672
	buffer_load_dwordx4 v8, s[20:23], s54 offen  lds
	s_waitcnt lgkmcnt(4)
	v_mfma_f32_32x32x16_bf16 v[144:159], v[80:83], a[28:31], v[144:159]
	ds_read_b64_tr_b16 v[72:73], v22 offset:38912
	ds_read_b64_tr_b16 v[74:75], v22 offset:39936
	v_mul_f32 v106, v122, v122
	v_mul_f32 v107, v123, v123
	v_fma_f32 v104, v104, v19, v18
	v_fma_f32 v105, v105, v19, v18
	v_mfma_f32_32x32x16_bf16 v[160:175], v[84:87], a[28:31], v[160:175]
	ds_read_b64_tr_b16 v[76:77], v22 offset:39424
	ds_read_b64_tr_b16 v[78:79], v22 offset:40448
	v_fma_f32 v106, v106, v19, v18
	v_fma_f32 v107, v107, v19, v18
	v_mul_f32 v104, v104, v120
	v_mul_f32 v105, v105, v121
	s_add_u32 m0, s90, 28672
	s_add_u32 s54, s56, 57344
	buffer_load_dwordx4 v8, s[20:23], s54 offen  lds
	s_waitcnt lgkmcnt(4)
	v_mfma_f32_32x32x16_bf16 v[144:159], v[88:91], a[32:35], v[144:159]
	ds_read_b64_tr_b16 v[80:81], v22 offset:40960
	ds_read_b64_tr_b16 v[82:83], v22 offset:41984
	v_mul_f32 v106, v106, v122
	v_mul_f32 v107, v107, v123
	v_exp_f32 v104, v104
	v_exp_f32 v105, v105
	v_exp_f32 v106, v106
	v_mfma_f32_32x32x16_bf16 v[160:175], v[92:95], a[32:35], v[160:175]
	ds_read_b64_tr_b16 v[84:85], v22 offset:41472
	ds_read_b64_tr_b16 v[86:87], v22 offset:42496
	v_exp_f32 v107, v107
	v_fma_f32 v104, v104, v20, v20
	v_fma_f32 v105, v105, v20, v20
	v_fma_f32 v106, v106, v20, v20
	s_add_u32 m0, s90, 32768
	s_add_u32 s54, s56, 86016
	buffer_load_dwordx4 v8, s[20:23], s54 offen  lds
	s_waitcnt lgkmcnt(4)
	v_mfma_f32_32x32x16_bf16 v[144:159], v[72:75], a[36:39], v[144:159]
	ds_read_b64_tr_b16 v[88:89], v22 offset:43008
	ds_read_b64_tr_b16 v[90:91], v22 offset:44032
	v_fma_f32 v107, v107, v20, v20
	v_rcp_f32 v104, v104
	v_rcp_f32 v105, v105
	v_rcp_f32 v106, v106
	v_rcp_f32 v107, v107
	v_mfma_f32_32x32x16_bf16 v[160:175], v[76:79], a[36:39], v[160:175]
	ds_read_b64_tr_b16 v[92:93], v22 offset:43520
	ds_read_b64_tr_b16 v[94:95], v22 offset:44544
	v_mul_f32 v120, v120, v104
	v_mul_f32 v121, v121, v105
	v_mul_f32 v122, v122, v106
	v_mul_f32 v123, v123, v107
	s_add_u32 m0, s90, 36864
	s_add_u32 s54, s57, 57344
	buffer_load_dwordx4 v8, s[20:23], s54 offen  lds
	s_waitcnt lgkmcnt(4)
	v_mfma_f32_32x32x16_bf16 v[144:159], v[80:83], a[40:43], v[144:159]
	ds_read_b64_tr_b16 v[72:73], v22 offset:45056
	ds_read_b64_tr_b16 v[74:75], v22 offset:46080
	v_cvt_pk_bf16_f32 v228, v120, v121
	v_cvt_pk_bf16_f32 v229, v122, v123
	v_mul_f32 v108, v124, v124
	v_mul_f32 v109, v125, v125
	v_mul_f32 v110, v126, v126
	v_mfma_f32_32x32x16_bf16 v[160:175], v[84:87], a[40:43], v[160:175]
	ds_read_b64_tr_b16 v[76:77], v22 offset:45568
	ds_read_b64_tr_b16 v[78:79], v22 offset:46592
	v_mul_f32 v111, v127, v127
	v_fma_f32 v108, v108, v19, v18
	v_fma_f32 v109, v109, v19, v18
	v_fma_f32 v110, v110, v19, v18
	s_add_u32 m0, s90, 40960
	s_add_u32 s54, s57, 86016
	buffer_load_dwordx4 v8, s[20:23], s54 offen  lds
	s_waitcnt lgkmcnt(4)
	v_mfma_f32_32x32x16_bf16 v[144:159], v[88:91], a[44:47], v[144:159]
	ds_read_b64_tr_b16 v[80:81], v22 offset:47104
	ds_read_b64_tr_b16 v[82:83], v22 offset:48128
	v_fma_f32 v111, v111, v19, v18
	v_mul_f32 v108, v108, v124
	v_mul_f32 v109, v109, v125
	v_mul_f32 v110, v110, v126
	v_mul_f32 v111, v111, v127
	v_mfma_f32_32x32x16_bf16 v[160:175], v[92:95], a[44:47], v[160:175]
	ds_read_b64_tr_b16 v[84:85], v22 offset:47616
	ds_read_b64_tr_b16 v[86:87], v22 offset:48640
	v_exp_f32 v108, v108
	v_exp_f32 v109, v109
	v_exp_f32 v110, v110
	v_exp_f32 v111, v111
	s_add_u32 m0, s90, 45056
	s_add_u32 s54, s58, 57344
	buffer_load_dwordx4 v8, s[20:23], s54 offen  lds
	s_waitcnt lgkmcnt(4)
	v_mfma_f32_32x32x16_bf16 v[144:159], v[72:75], a[48:51], v[144:159]
	ds_read_b64_tr_b16 v[88:89], v22 offset:49152
	ds_read_b64_tr_b16 v[90:91], v22 offset:50176
	v_fma_f32 v108, v108, v20, v20
	v_fma_f32 v109, v109, v20, v20
	v_fma_f32 v110, v110, v20, v20
	v_fma_f32 v111, v111, v20, v20
	v_mfma_f32_32x32x16_bf16 v[160:175], v[76:79], a[48:51], v[160:175]
	ds_read_b64_tr_b16 v[92:93], v22 offset:49664
	ds_read_b64_tr_b16 v[94:95], v22 offset:50688
	v_rcp_f32 v108, v108
	v_rcp_f32 v109, v109
	v_rcp_f32 v110, v110
	v_rcp_f32 v111, v111
	v_mul_f32 v124, v124, v108
	s_add_u32 m0, s90, 49152
	s_add_u32 s54, s58, 86016
	buffer_load_dwordx4 v8, s[20:23], s54 offen  lds
	s_waitcnt lgkmcnt(4)
	v_mfma_f32_32x32x16_bf16 v[144:159], v[80:83], a[52:55], v[144:159]
	ds_read_b64_tr_b16 v[72:73], v22 offset:51200
	ds_read_b64_tr_b16 v[74:75], v22 offset:52224
	v_mul_f32 v125, v125, v109
	v_mul_f32 v126, v126, v110
	v_mul_f32 v127, v127, v111
	v_cvt_pk_bf16_f32 v230, v124, v125
	v_mfma_f32_32x32x16_bf16 v[160:175], v[84:87], a[52:55], v[160:175]
	ds_read_b64_tr_b16 v[76:77], v22 offset:51712
	ds_read_b64_tr_b16 v[78:79], v22 offset:52736
	v_cvt_pk_bf16_f32 v231, v126, v127
	buffer_store_dwordx4 v[224:227], v4, s[28:31], s50 offen offset:0 sc1
	buffer_store_dwordx4 v[228:231], v4, s[28:31], s50 offen offset:1024 sc1
	v_mul_f32 v104, v128, v128
	v_mul_f32 v105, v129, v129
	s_add_u32 m0, s90, 53248
	s_add_u32 s54, s59, 57344
	buffer_load_dwordx4 v8, s[20:23], s54 offen  lds
	s_waitcnt lgkmcnt(4)
	v_mfma_f32_32x32x16_bf16 v[144:159], v[88:91], a[56:59], v[144:159]
	ds_read_b64_tr_b16 v[80:81], v22 offset:53248
	ds_read_b64_tr_b16 v[82:83], v22 offset:54272
	v_mul_f32 v106, v130, v130
	v_mul_f32 v107, v131, v131
	v_fma_f32 v104, v104, v19, v18
	v_fma_f32 v105, v105, v19, v18
	v_mfma_f32_32x32x16_bf16 v[160:175], v[92:95], a[56:59], v[160:175]
	ds_read_b64_tr_b16 v[84:85], v22 offset:53760
	ds_read_b64_tr_b16 v[86:87], v22 offset:54784
	v_fma_f32 v106, v106, v19, v18
	v_fma_f32 v107, v107, v19, v18
	v_mul_f32 v104, v104, v128
	v_mul_f32 v105, v105, v129
	v_mul_f32 v106, v106, v130
	s_barrier
	s_add_u32 m0, s90, 86016
	s_add_u32 s54, s59, 86016
	buffer_load_dwordx4 v8, s[20:23], s54 offen  lds
	s_waitcnt lgkmcnt(4)
	v_mfma_f32_32x32x16_bf16 v[144:159], v[72:75], a[60:63], v[144:159]
	ds_read_b64_tr_b16 v[88:89], v22 offset:55296
	ds_read_b64_tr_b16 v[90:91], v22 offset:56320
	v_mul_f32 v107, v107, v131
	v_exp_f32 v104, v104
	v_exp_f32 v105, v105
	v_exp_f32 v106, v106
	v_mfma_f32_32x32x16_bf16 v[160:175], v[76:79], a[60:63], v[160:175]
	ds_read_b64_tr_b16 v[92:93], v22 offset:55808
	ds_read_b64_tr_b16 v[94:95], v22 offset:56832
	v_exp_f32 v107, v107
	v_fma_f32 v104, v104, v20, v20
	v_fma_f32 v105, v105, v20, v20
	v_fma_f32 v106, v106, v20, v20
	s_add_u32 m0, s90, 90112
	s_add_u32 s54, s60, 57344
	buffer_load_dwordx4 v8, s[20:23], s54 offen  lds
	s_waitcnt lgkmcnt(4)
	v_mfma_f32_32x32x16_bf16 v[144:159], v[80:83], a[64:67], v[144:159]
	ds_read_b64_tr_b16 v[72:73], v22 offset:57344
	ds_read_b64_tr_b16 v[74:75], v22 offset:58368
	v_fma_f32 v107, v107, v20, v20
	v_rcp_f32 v104, v104
	v_rcp_f32 v105, v105
	v_rcp_f32 v106, v106
	v_rcp_f32 v107, v107
	v_mfma_f32_32x32x16_bf16 v[160:175], v[84:87], a[64:67], v[160:175]
	ds_read_b64_tr_b16 v[76:77], v22 offset:57856
	ds_read_b64_tr_b16 v[78:79], v22 offset:58880
	v_mul_f32 v128, v128, v104
	v_mul_f32 v129, v129, v105
	v_mul_f32 v130, v130, v106
	v_mul_f32 v131, v131, v107
	s_add_u32 m0, s90, 94208
	s_add_u32 s54, s60, 86016
	buffer_load_dwordx4 v8, s[20:23], s54 offen  lds
	s_waitcnt lgkmcnt(4)
	v_mfma_f32_32x32x16_bf16 v[144:159], v[88:91], a[68:71], v[144:159]
	ds_read_b64_tr_b16 v[80:81], v22 offset:59392
	ds_read_b64_tr_b16 v[82:83], v22 offset:60416
	v_cvt_pk_bf16_f32 v232, v128, v129
	v_cvt_pk_bf16_f32 v233, v130, v131
	v_mul_f32 v108, v132, v132
	v_mul_f32 v109, v133, v133
	v_mul_f32 v110, v134, v134
	v_mfma_f32_32x32x16_bf16 v[160:175], v[92:95], a[68:71], v[160:175]
	ds_read_b64_tr_b16 v[84:85], v22 offset:59904
	ds_read_b64_tr_b16 v[86:87], v22 offset:60928
	v_mul_f32 v111, v135, v135
	v_fma_f32 v108, v108, v19, v18
	v_fma_f32 v109, v109, v19, v18
	v_fma_f32 v110, v110, v19, v18
	s_add_u32 m0, s90, 98304
	s_add_u32 s54, s61, 57344
	buffer_load_dwordx4 v8, s[20:23], s54 offen  lds
	s_waitcnt lgkmcnt(4)
	v_mfma_f32_32x32x16_bf16 v[144:159], v[72:75], a[72:75], v[144:159]
	ds_read_b64_tr_b16 v[88:89], v22 offset:61440
	ds_read_b64_tr_b16 v[90:91], v22 offset:62464
	v_fma_f32 v111, v111, v19, v18
	v_mul_f32 v108, v108, v132
	v_mul_f32 v109, v109, v133
	v_mul_f32 v110, v110, v134
	v_mul_f32 v111, v111, v135
	v_mfma_f32_32x32x16_bf16 v[160:175], v[76:79], a[72:75], v[160:175]
	ds_read_b64_tr_b16 v[92:93], v22 offset:61952
	ds_read_b64_tr_b16 v[94:95], v22 offset:62976
	v_exp_f32 v108, v108
	v_exp_f32 v109, v109
	v_exp_f32 v110, v110
	v_exp_f32 v111, v111
	s_add_u32 m0, s90, 102400
	s_add_u32 s54, s61, 86016
	buffer_load_dwordx4 v8, s[20:23], s54 offen  lds
	s_waitcnt lgkmcnt(4)
	v_mfma_f32_32x32x16_bf16 v[144:159], v[80:83], a[76:79], v[144:159]
	ds_read_b64_tr_b16 v[72:73], v22 offset:63488
	ds_read_b64_tr_b16 v[74:75], v22 offset:64512
	v_fma_f32 v108, v108, v20, v20
	v_fma_f32 v109, v109, v20, v20
	v_fma_f32 v110, v110, v20, v20
	v_fma_f32 v111, v111, v20, v20
	v_rcp_f32 v108, v108
	v_mfma_f32_32x32x16_bf16 v[160:175], v[84:87], a[76:79], v[160:175]
	ds_read_b64_tr_b16 v[76:77], v22 offset:64000
	ds_read_b64_tr_b16 v[78:79], v22 offset:65024
	v_rcp_f32 v109, v109
	v_rcp_f32 v110, v110
	v_rcp_f32 v111, v111
	v_mul_f32 v132, v132, v108
	s_add_u32 m0, s90, 106496
	s_add_u32 s54, s75, 57344
	buffer_load_dwordx4 v8, s[20:23], s54 offen  lds
	s_waitcnt lgkmcnt(4)
	v_mfma_f32_32x32x16_bf16 v[144:159], v[88:91], a[80:83], v[144:159]
	ds_read_b64_tr_b16 v[80:81], v23 offset:0
	ds_read_b64_tr_b16 v[82:83], v23 offset:1024
	v_mul_f32 v133, v133, v109
	v_mul_f32 v134, v134, v110
	v_mul_f32 v135, v135, v111
	v_cvt_pk_bf16_f32 v234, v132, v133
	v_mfma_f32_32x32x16_bf16 v[160:175], v[92:95], a[80:83], v[160:175]
	ds_read_b64_tr_b16 v[84:85], v23 offset:512
	ds_read_b64_tr_b16 v[86:87], v23 offset:1536
	v_cvt_pk_bf16_f32 v235, v134, v135
	v_mul_f32 v104, v136, v136
	v_mul_f32 v105, v137, v137
	v_mul_f32 v106, v138, v138
	v_mul_f32 v107, v139, v139
	s_add_u32 m0, s90, 110592
	s_add_u32 s54, s75, 86016
	buffer_load_dwordx4 v8, s[20:23], s54 offen  lds
	s_waitcnt lgkmcnt(4)
	v_mfma_f32_32x32x16_bf16 v[144:159], v[72:75], a[84:87], v[144:159]
	ds_read_b64_tr_b16 v[88:89], v23 offset:2048
	ds_read_b64_tr_b16 v[90:91], v23 offset:3072
	v_fma_f32 v104, v104, v19, v18
	v_fma_f32 v105, v105, v19, v18
	v_fma_f32 v106, v106, v19, v18
	v_fma_f32 v107, v107, v19, v18
	v_mfma_f32_32x32x16_bf16 v[160:175], v[76:79], a[84:87], v[160:175]
	ds_read_b64_tr_b16 v[92:93], v23 offset:2560
	ds_read_b64_tr_b16 v[94:95], v23 offset:3584
	v_mul_f32 v104, v104, v136
	v_mul_f32 v105, v105, v137
	v_mul_f32 v106, v106, v138
	v_mul_f32 v107, v107, v139
	v_exp_f32 v104, v104
	s_waitcnt lgkmcnt(4)
	v_mfma_f32_32x32x16_bf16 v[144:159], v[80:83], a[88:91], v[144:159]
	ds_read_b64_tr_b16 v[72:73], v23 offset:4096
	ds_read_b64_tr_b16 v[74:75], v23 offset:5120
	v_exp_f32 v105, v105
	v_exp_f32 v106, v106
	v_exp_f32 v107, v107
	v_fma_f32 v104, v104, v20, v20
	v_mfma_f32_32x32x16_bf16 v[160:175], v[84:87], a[88:91], v[160:175]
	ds_read_b64_tr_b16 v[76:77], v23 offset:4608
	ds_read_b64_tr_b16 v[78:79], v23 offset:5632
	v_fma_f32 v105, v105, v20, v20
	v_fma_f32 v106, v106, v20, v20
	v_fma_f32 v107, v107, v20, v20
	v_rcp_f32 v104, v104
	v_rcp_f32 v105, v105
	s_waitcnt lgkmcnt(4)
	v_mfma_f32_32x32x16_bf16 v[144:159], v[88:91], a[92:95], v[144:159]
	ds_read_b64_tr_b16 v[80:81], v23 offset:6144
	ds_read_b64_tr_b16 v[82:83], v23 offset:7168
	v_rcp_f32 v106, v106
	v_rcp_f32 v107, v107
	v_mul_f32 v136, v136, v104
	v_mul_f32 v137, v137, v105
	v_mfma_f32_32x32x16_bf16 v[160:175], v[92:95], a[92:95], v[160:175]
	ds_read_b64_tr_b16 v[84:85], v23 offset:6656
	ds_read_b64_tr_b16 v[86:87], v23 offset:7680
	v_mul_f32 v138, v138, v106
	v_mul_f32 v139, v139, v107
	v_cvt_pk_bf16_f32 v236, v136, v137
	v_cvt_pk_bf16_f32 v237, v138, v139
	buffer_store_dwordx4 v[96:99], v4, s[28:31], s53 offen offset:0
	buffer_store_dwordx4 v[96:99], v4, s[28:31], s53 offen offset:1024
	s_waitcnt lgkmcnt(4)
	v_mfma_f32_32x32x16_bf16 v[144:159], v[72:75], a[96:99], v[144:159]
	ds_read_b64_tr_b16 v[88:89], v23 offset:8192
	ds_read_b64_tr_b16 v[90:91], v23 offset:9216
	v_mul_f32 v108, v140, v140
	v_mul_f32 v109, v141, v141
	v_mul_f32 v110, v142, v142
	v_mul_f32 v111, v143, v143
	v_fma_f32 v108, v108, v19, v18
	v_mfma_f32_32x32x16_bf16 v[160:175], v[76:79], a[96:99], v[160:175]
	ds_read_b64_tr_b16 v[92:93], v23 offset:8704
	ds_read_b64_tr_b16 v[94:95], v23 offset:9728
	v_fma_f32 v109, v109, v19, v18
	v_fma_f32 v110, v110, v19, v18
	v_fma_f32 v111, v111, v19, v18
	v_mul_f32 v108, v108, v140
	s_waitcnt lgkmcnt(4)
	v_mfma_f32_32x32x16_bf16 v[144:159], v[80:83], a[100:103], v[144:159]
	ds_read_b64_tr_b16 v[72:73], v23 offset:10240
	ds_read_b64_tr_b16 v[74:75], v23 offset:11264
	v_mul_f32 v109, v109, v141
	v_mul_f32 v110, v110, v142
	v_mul_f32 v111, v111, v143
	v_exp_f32 v108, v108
	v_exp_f32 v109, v109
	v_mfma_f32_32x32x16_bf16 v[160:175], v[84:87], a[100:103], v[160:175]
	ds_read_b64_tr_b16 v[76:77], v23 offset:10752
	ds_read_b64_tr_b16 v[78:79], v23 offset:11776
	v_exp_f32 v110, v110
	v_exp_f32 v111, v111
	v_fma_f32 v108, v108, v20, v20
	v_fma_f32 v109, v109, v20, v20
	s_waitcnt lgkmcnt(4)
	v_mfma_f32_32x32x16_bf16 v[144:159], v[88:91], a[104:107], v[144:159]
	v_fma_f32 v110, v110, v20, v20
	v_fma_f32 v111, v111, v20, v20
	v_rcp_f32 v108, v108
	v_rcp_f32 v109, v109
	v_rcp_f32 v110, v110
	v_mfma_f32_32x32x16_bf16 v[160:175], v[92:95], a[104:107], v[160:175]
	v_rcp_f32 v111, v111
	v_mul_f32 v140, v140, v108
	v_mul_f32 v141, v141, v109
	v_mul_f32 v142, v142, v110
	s_waitcnt lgkmcnt(0)
	v_mfma_f32_32x32x16_bf16 v[144:159], v[72:75], a[108:111], v[144:159]
	v_mul_f32 v143, v143, v111
	v_cvt_pk_bf16_f32 v238, v140, v141
	v_cvt_pk_bf16_f32 v239, v142, v143
	buffer_store_dwordx4 v[232:235], v4, s[28:31], s50 offen offset:2048
	buffer_store_dwordx4 v[236:239], v4, s[28:31], s50 offen offset:3072
	v_mfma_f32_32x32x16_bf16 v[160:175], v[76:79], a[108:111], v[160:175]
	v_mfma_f32_32x32x16_bf16 v[144:159], v[60:63], v[68:71], v[144:159]
	v_mfma_f32_32x32x16_bf16 v[160:175], v[64:67], v[68:71], v[160:175]
	s_nop 10
	v_pk_mul_f32 v[104:105], v[144:145], v[144:145]
	v_pk_mul_f32 v[106:107], v[146:147], v[146:147]
	v_pk_mul_f32 v[108:109], v[148:149], v[148:149]
	v_pk_mul_f32 v[110:111], v[150:151], v[150:151]
	v_pk_fma_f32 v[104:105], v[104:105], v[18:19], v[18:19] op_sel:[0,1,0] op_sel_hi:[1,1,0]
	v_pk_fma_f32 v[106:107], v[106:107], v[18:19], v[18:19] op_sel:[0,1,0] op_sel_hi:[1,1,0]
	v_pk_fma_f32 v[108:109], v[108:109], v[18:19], v[18:19] op_sel:[0,1,0] op_sel_hi:[1,1,0]
	v_pk_fma_f32 v[110:111], v[110:111], v[18:19], v[18:19] op_sel:[0,1,0] op_sel_hi:[1,1,0]
	v_pk_mul_f32 v[104:105], v[104:105], v[144:145]
	v_pk_mul_f32 v[106:107], v[106:107], v[146:147]
	v_pk_mul_f32 v[108:109], v[108:109], v[148:149]
	v_pk_mul_f32 v[110:111], v[110:111], v[150:151]
	v_exp_f32 v104, v104
	v_exp_f32 v105, v105
	v_exp_f32 v106, v106
	v_exp_f32 v107, v107
	v_exp_f32 v108, v108
	v_exp_f32 v109, v109
	v_exp_f32 v110, v110
	v_exp_f32 v111, v111
	v_pk_fma_f32 v[104:105], v[104:105], v[20:21], v[20:21] op_sel_hi:[1,0,0]
	v_pk_fma_f32 v[106:107], v[106:107], v[20:21], v[20:21] op_sel_hi:[1,0,0]
	v_pk_fma_f32 v[108:109], v[108:109], v[20:21], v[20:21] op_sel_hi:[1,0,0]
	v_pk_fma_f32 v[110:111], v[110:111], v[20:21], v[20:21] op_sel_hi:[1,0,0]
	v_rcp_f32 v104, v104
	v_rcp_f32 v105, v105
	v_rcp_f32 v106, v106
	v_rcp_f32 v107, v107
	v_rcp_f32 v108, v108
	v_rcp_f32 v109, v109
	v_rcp_f32 v110, v110
	v_rcp_f32 v111, v111
	v_pk_mul_f32 v[144:145], v[144:145], v[104:105]
	v_pk_mul_f32 v[146:147], v[146:147], v[106:107]
	v_pk_mul_f32 v[148:149], v[148:149], v[108:109]
	v_pk_mul_f32 v[150:151], v[150:151], v[110:111]
	v_cvt_pk_bf16_f32 v240, v144, v145
	v_cvt_pk_bf16_f32 v241, v146, v147
	v_cvt_pk_bf16_f32 v242, v148, v149
	v_cvt_pk_bf16_f32 v243, v150, v151
	s_waitcnt vmcnt(0)
	s_mov_b64 exec, 1
	buffer_store_dword v11, off, s[28:31], s74 offset:256
	s_mov_b64 exec, -1
	v_pk_mul_f32 v[104:105], v[152:153], v[152:153]
	v_pk_mul_f32 v[106:107], v[154:155], v[154:155]
	v_pk_mul_f32 v[108:109], v[156:157], v[156:157]
	v_pk_mul_f32 v[110:111], v[158:159], v[158:159]
	v_pk_fma_f32 v[104:105], v[104:105], v[18:19], v[18:19] op_sel:[0,1,0] op_sel_hi:[1,1,0]
	v_pk_fma_f32 v[106:107], v[106:107], v[18:19], v[18:19] op_sel:[0,1,0] op_sel_hi:[1,1,0]
	v_pk_fma_f32 v[108:109], v[108:109], v[18:19], v[18:19] op_sel:[0,1,0] op_sel_hi:[1,1,0]
	v_pk_fma_f32 v[110:111], v[110:111], v[18:19], v[18:19] op_sel:[0,1,0] op_sel_hi:[1,1,0]
	v_pk_mul_f32 v[104:105], v[104:105], v[152:153]
	v_pk_mul_f32 v[106:107], v[106:107], v[154:155]
	v_pk_mul_f32 v[108:109], v[108:109], v[156:157]
	v_pk_mul_f32 v[110:111], v[110:111], v[158:159]
	v_exp_f32 v104, v104
	v_exp_f32 v105, v105
	v_exp_f32 v106, v106
	v_exp_f32 v107, v107
	v_exp_f32 v108, v108
	v_exp_f32 v109, v109
	v_exp_f32 v110, v110
	v_exp_f32 v111, v111
	v_pk_fma_f32 v[104:105], v[104:105], v[20:21], v[20:21] op_sel_hi:[1,0,0]
	v_pk_fma_f32 v[106:107], v[106:107], v[20:21], v[20:21] op_sel_hi:[1,0,0]
	v_pk_fma_f32 v[108:109], v[108:109], v[20:21], v[20:21] op_sel_hi:[1,0,0]
	v_pk_fma_f32 v[110:111], v[110:111], v[20:21], v[20:21] op_sel_hi:[1,0,0]
	v_rcp_f32 v104, v104
	v_rcp_f32 v105, v105
	v_rcp_f32 v106, v106
	v_rcp_f32 v107, v107
	v_rcp_f32 v108, v108
	v_rcp_f32 v109, v109
	v_rcp_f32 v110, v110
	v_rcp_f32 v111, v111
	v_pk_mul_f32 v[152:153], v[152:153], v[104:105]
	v_pk_mul_f32 v[154:155], v[154:155], v[106:107]
	v_pk_mul_f32 v[156:157], v[156:157], v[108:109]
	v_pk_mul_f32 v[158:159], v[158:159], v[110:111]
	v_cvt_pk_bf16_f32 v244, v152, v153
	v_cvt_pk_bf16_f32 v245, v154, v155
	v_cvt_pk_bf16_f32 v246, v156, v157
	v_cvt_pk_bf16_f32 v247, v158, v159
Lpoll_28:
	buffer_load_dword v14, v15, s[28:31], s73 offen offset:256 sc1
	s_waitcnt vmcnt(0)
	v_cmp_ne_u32 vcc, s65, v14
	s_nop 0
	s_cbranch_vccz Lpdone_29
	s_sub_u32 s67, s67, 1
	s_cbranch_scc0 Lpoll_28
	s_mov_b32 s67, 0
Lpdone_29:
	buffer_load_dwordx4 a[0:3], v4, s[28:31], s41 offen offset:0 sc1
	buffer_load_dwordx4 a[4:7], v4, s[28:31], s41 offen offset:1024 sc1
	buffer_load_dwordx4 a[8:11], v4, s[28:31], s41 offen offset:2048 sc1
	buffer_load_dwordx4 a[12:15], v4, s[28:31], s41 offen offset:3072 sc1
	buffer_load_dwordx4 a[16:19], v4, s[28:31], s42 offen offset:0 sc1
	buffer_load_dwordx4 a[20:23], v4, s[28:31], s42 offen offset:1024 sc1
	buffer_load_dwordx4 a[24:27], v4, s[28:31], s42 offen offset:2048 sc1
	buffer_load_dwordx4 a[28:31], v4, s[28:31], s42 offen offset:3072 sc1
	buffer_store_dwordx4 v[240:243], v4, s[28:31], s51 offen offset:0 sc1
	buffer_store_dwordx4 v[244:247], v4, s[28:31], s51 offen offset:1024 sc1
	v_pk_mul_f32 v[104:105], v[160:161], v[160:161]
	v_pk_mul_f32 v[106:107], v[162:163], v[162:163]
	v_pk_mul_f32 v[108:109], v[164:165], v[164:165]
	v_pk_mul_f32 v[110:111], v[166:167], v[166:167]
	v_pk_fma_f32 v[104:105], v[104:105], v[18:19], v[18:19] op_sel:[0,1,0] op_sel_hi:[1,1,0]
	v_pk_fma_f32 v[106:107], v[106:107], v[18:19], v[18:19] op_sel:[0,1,0] op_sel_hi:[1,1,0]
	v_pk_fma_f32 v[108:109], v[108:109], v[18:19], v[18:19] op_sel:[0,1,0] op_sel_hi:[1,1,0]
	v_pk_fma_f32 v[110:111], v[110:111], v[18:19], v[18:19] op_sel:[0,1,0] op_sel_hi:[1,1,0]
	v_pk_mul_f32 v[104:105], v[104:105], v[160:161]
	v_pk_mul_f32 v[106:107], v[106:107], v[162:163]
	v_pk_mul_f32 v[108:109], v[108:109], v[164:165]
	v_pk_mul_f32 v[110:111], v[110:111], v[166:167]
	v_exp_f32 v104, v104
	v_exp_f32 v105, v105
	v_exp_f32 v106, v106
	v_exp_f32 v107, v107
	v_exp_f32 v108, v108
	v_exp_f32 v109, v109
	v_exp_f32 v110, v110
	v_exp_f32 v111, v111
	buffer_load_dwordx4 a[32:35], v4, s[28:31], s43 offen offset:0 sc1
	v_pk_fma_f32 v[104:105], v[104:105], v[20:21], v[20:21] op_sel_hi:[1,0,0]
	v_pk_fma_f32 v[106:107], v[106:107], v[20:21], v[20:21] op_sel_hi:[1,0,0]
	v_pk_fma_f32 v[108:109], v[108:109], v[20:21], v[20:21] op_sel_hi:[1,0,0]
	v_pk_fma_f32 v[110:111], v[110:111], v[20:21], v[20:21] op_sel_hi:[1,0,0]
	v_rcp_f32 v104, v104
	v_rcp_f32 v105, v105
	buffer_load_dwordx4 a[36:39], v4, s[28:31], s43 offen offset:1024 sc1
	v_rcp_f32 v106, v106
	v_rcp_f32 v107, v107
	v_rcp_f32 v108, v108
	v_rcp_f32 v109, v109
	v_rcp_f32 v110, v110
	v_rcp_f32 v111, v111
	v_pk_mul_f32 v[160:161], v[160:161], v[104:105]
	buffer_load_dwordx4 a[40:43], v4, s[28:31], s43 offen offset:2048 sc1
	v_pk_mul_f32 v[162:163], v[162:163], v[106:107]
	v_pk_mul_f32 v[164:165], v[164:165], v[108:109]
	v_pk_mul_f32 v[166:167], v[166:167], v[110:111]
	v_cvt_pk_bf16_f32 v248, v160, v161
	v_cvt_pk_bf16_f32 v249, v162, v163
	v_cvt_pk_bf16_f32 v250, v164, v165
	v_cvt_pk_bf16_f32 v251, v166, v167
	buffer_load_dwordx4 a[44:47], v4, s[28:31], s43 offen offset:3072 sc1
	v_pk_mul_f32 v[104:105], v[168:169], v[168:169]
	v_pk_mul_f32 v[106:107], v[170:171], v[170:171]
	v_pk_mul_f32 v[108:109], v[172:173], v[172:173]
	v_pk_mul_f32 v[110:111], v[174:175], v[174:175]
	v_pk_fma_f32 v[104:105], v[104:105], v[18:19], v[18:19] op_sel:[0,1,0] op_sel_hi:[1,1,0]
	v_pk_fma_f32 v[106:107], v[106:107], v[18:19], v[18:19] op_sel:[0,1,0] op_sel_hi:[1,1,0]
	buffer_load_dwordx4 a[48:51], v4, s[28:31], s44 offen offset:0 sc1
	v_pk_fma_f32 v[108:109], v[108:109], v[18:19], v[18:19] op_sel:[0,1,0] op_sel_hi:[1,1,0]
	v_pk_fma_f32 v[110:111], v[110:111], v[18:19], v[18:19] op_sel:[0,1,0] op_sel_hi:[1,1,0]
	v_pk_mul_f32 v[104:105], v[104:105], v[168:169]
	v_pk_mul_f32 v[106:107], v[106:107], v[170:171]
	v_pk_mul_f32 v[108:109], v[108:109], v[172:173]
	v_pk_mul_f32 v[110:111], v[110:111], v[174:175]
	v_exp_f32 v104, v104
	buffer_load_dwordx4 a[52:55], v4, s[28:31], s44 offen offset:1024 sc1
	v_exp_f32 v105, v105
	v_exp_f32 v106, v106
	v_exp_f32 v107, v107
	v_exp_f32 v108, v108
	v_exp_f32 v109, v109
	v_exp_f32 v110, v110
	v_exp_f32 v111, v111
	buffer_load_dwordx4 a[56:59], v4, s[28:31], s44 offen offset:2048 sc1
	v_pk_fma_f32 v[104:105], v[104:105], v[20:21], v[20:21] op_sel_hi:[1,0,0]
	v_pk_fma_f32 v[106:107], v[106:107], v[20:21], v[20:21] op_sel_hi:[1,0,0]
	v_pk_fma_f32 v[108:109], v[108:109], v[20:21], v[20:21] op_sel_hi:[1,0,0]
	v_pk_fma_f32 v[110:111], v[110:111], v[20:21], v[20:21] op_sel_hi:[1,0,0]
	v_rcp_f32 v104, v104
	v_rcp_f32 v105, v105
	buffer_load_dwordx4 a[60:63], v4, s[28:31], s44 offen offset:3072 sc1
	v_rcp_f32 v106, v106
	v_rcp_f32 v107, v107
	v_rcp_f32 v108, v108
	v_rcp_f32 v109, v109
	v_rcp_f32 v110, v110
	v_rcp_f32 v111, v111
	v_pk_mul_f32 v[168:169], v[168:169], v[104:105]
	buffer_load_dwordx4 a[64:67], v4, s[28:31], s45 offen offset:0 sc1
	v_pk_mul_f32 v[170:171], v[170:171], v[106:107]
	v_pk_mul_f32 v[172:173], v[172:173], v[108:109]
	v_pk_mul_f32 v[174:175], v[174:175], v[110:111]
	v_cvt_pk_bf16_f32 v252, v168, v169
	v_cvt_pk_bf16_f32 v253, v170, v171
	v_cvt_pk_bf16_f32 v254, v172, v173
	v_cvt_pk_bf16_f32 v255, v174, v175
	buffer_store_dwordx4 v[248:251], v4, s[28:31], s51 offen offset:2048 sc1
	buffer_store_dwordx4 v[252:255], v4, s[28:31], s51 offen offset:3072 sc1
	v_mfma_f32_32x32x16_bf16 v[24:39], a[240:243], a[248:251], v[24:39]
	v_mfma_f32_32x32x16_bf16 v[24:39], a[244:247], a[252:255], v[24:39]
	s_barrier
	ds_read_b64_tr_b16 v[72:73], v21 offset:57344
	ds_read_b64_tr_b16 v[74:75], v21 offset:58368
	ds_read_b64_tr_b16 v[76:77], v21 offset:57856
	ds_read_b64_tr_b16 v[78:79], v21 offset:58880
	ds_read_b64_tr_b16 v[80:81], v21 offset:59392
	ds_read_b64_tr_b16 v[82:83], v21 offset:60416
	ds_read_b64_tr_b16 v[84:85], v21 offset:59904
	ds_read_b64_tr_b16 v[86:87], v21 offset:60928
	buffer_load_dwordx4 a[68:71], v4, s[28:31], s45 offen offset:1024 sc1
	s_waitcnt lgkmcnt(4)
	v_mfma_f32_32x32x16_bf16 v[176:191], v[72:75], v[224:227], 0
	ds_read_b64_tr_b16 v[88:89], v21 offset:61440
	ds_read_b64_tr_b16 v[90:91], v21 offset:62464
	v_mfma_f32_32x32x16_bf16 v[24:39], v[76:79], v[224:227], v[24:39]
	ds_read_b64_tr_b16 v[92:93], v21 offset:61952
	ds_read_b64_tr_b16 v[94:95], v21 offset:62976
	buffer_load_dwordx4 a[72:75], v4, s[28:31], s45 offen offset:2048 sc1
	s_waitcnt lgkmcnt(4)
	v_mfma_f32_32x32x16_bf16 v[176:191], v[80:83], v[228:231], v[176:191]
	ds_read_b64_tr_b16 v[72:73], v21 offset:63488
	ds_read_b64_tr_b16 v[74:75], v21 offset:64512
	v_mfma_f32_32x32x16_bf16 v[24:39], v[84:87], v[228:231], v[24:39]
	ds_read_b64_tr_b16 v[76:77], v21 offset:64000
	ds_read_b64_tr_b16 v[78:79], v21 offset:65024
	buffer_load_dwordx4 a[76:79], v4, s[28:31], s45 offen offset:3072 sc1
	s_waitcnt lgkmcnt(4)
	v_mfma_f32_32x32x16_bf16 v[176:191], v[88:91], v[232:235], v[176:191]
	ds_read_b64_tr_b16 v[80:81], v22 offset:0
	ds_read_b64_tr_b16 v[82:83], v22 offset:1024
	v_mfma_f32_32x32x16_bf16 v[24:39], v[92:95], v[232:235], v[24:39]
	ds_read_b64_tr_b16 v[84:85], v22 offset:512
	ds_read_b64_tr_b16 v[86:87], v22 offset:1536
	buffer_load_dwordx4 a[80:83], v4, s[28:31], s46 offen offset:0 sc1
	s_waitcnt lgkmcnt(4)
	v_mfma_f32_32x32x16_bf16 v[176:191], v[72:75], v[236:239], v[176:191]
	ds_read_b64_tr_b16 v[88:89], v22 offset:2048
	ds_read_b64_tr_b16 v[90:91], v22 offset:3072
	v_mfma_f32_32x32x16_bf16 v[24:39], v[76:79], v[236:239], v[24:39]
	ds_read_b64_tr_b16 v[92:93], v22 offset:2560
	ds_read_b64_tr_b16 v[94:95], v22 offset:3584
	buffer_load_dwordx4 a[84:87], v4, s[28:31], s46 offen offset:1024 sc1
	s_waitcnt lgkmcnt(4) vmcnt(25)
	v_mfma_f32_32x32x16_bf16 v[176:191], v[80:83], a[0:3], v[176:191]
	ds_read_b64_tr_b16 v[72:73], v22 offset:4096
	ds_read_b64_tr_b16 v[74:75], v22 offset:5120
	v_mfma_f32_32x32x16_bf16 v[24:39], v[84:87], a[0:3], v[24:39]
	ds_read_b64_tr_b16 v[76:77], v22 offset:4608
	ds_read_b64_tr_b16 v[78:79], v22 offset:5632
	buffer_load_dwordx4 a[88:91], v4, s[28:31], s46 offen offset:2048 sc1
	s_waitcnt lgkmcnt(4) vmcnt(25)
	v_mfma_f32_32x32x16_bf16 v[176:191], v[88:91], a[4:7], v[176:191]
	ds_read_b64_tr_b16 v[80:81], v22 offset:6144
	ds_read_b64_tr_b16 v[82:83], v22 offset:7168
	v_mfma_f32_32x32x16_bf16 v[24:39], v[92:95], a[4:7], v[24:39]
	ds_read_b64_tr_b16 v[84:85], v22 offset:6656
	ds_read_b64_tr_b16 v[86:87], v22 offset:7680
	buffer_load_dwordx4 a[92:95], v4, s[28:31], s46 offen offset:3072 sc1
	s_waitcnt lgkmcnt(4) vmcnt(25)
	v_mfma_f32_32x32x16_bf16 v[176:191], v[72:75], a[8:11], v[176:191]
	ds_read_b64_tr_b16 v[88:89], v22 offset:8192
	ds_read_b64_tr_b16 v[90:91], v22 offset:9216
	v_mfma_f32_32x32x16_bf16 v[24:39], v[76:79], a[8:11], v[24:39]
	ds_read_b64_tr_b16 v[92:93], v22 offset:8704
	ds_read_b64_tr_b16 v[94:95], v22 offset:9728
	s_waitcnt lgkmcnt(4) vmcnt(24)
	v_mfma_f32_32x32x16_bf16 v[176:191], v[80:83], a[12:15], v[176:191]
	ds_read_b64_tr_b16 v[72:73], v22 offset:10240
	ds_read_b64_tr_b16 v[74:75], v22 offset:11264
	v_mfma_f32_32x32x16_bf16 v[24:39], v[84:87], a[12:15], v[24:39]
	ds_read_b64_tr_b16 v[76:77], v22 offset:10752
	ds_read_b64_tr_b16 v[78:79], v22 offset:11776
	s_waitcnt lgkmcnt(4) vmcnt(23)
	v_mfma_f32_32x32x16_bf16 v[176:191], v[88:91], a[16:19], v[176:191]
	ds_read_b64_tr_b16 v[80:81], v22 offset:12288
	ds_read_b64_tr_b16 v[82:83], v22 offset:13312
	v_mfma_f32_32x32x16_bf16 v[24:39], v[92:95], a[16:19], v[24:39]
	ds_read_b64_tr_b16 v[84:85], v22 offset:12800
	ds_read_b64_tr_b16 v[86:87], v22 offset:13824
	s_waitcnt lgkmcnt(4) vmcnt(22)
	v_mfma_f32_32x32x16_bf16 v[176:191], v[72:75], a[20:23], v[176:191]
	ds_read_b64_tr_b16 v[88:89], v22 offset:14336
	ds_read_b64_tr_b16 v[90:91], v22 offset:15360
	v_mfma_f32_32x32x16_bf16 v[24:39], v[76:79], a[20:23], v[24:39]
	ds_read_b64_tr_b16 v[92:93], v22 offset:14848
	ds_read_b64_tr_b16 v[94:95], v22 offset:15872
	s_waitcnt lgkmcnt(4) vmcnt(21)
	v_mfma_f32_32x32x16_bf16 v[176:191], v[80:83], a[24:27], v[176:191]
	ds_read_b64_tr_b16 v[72:73], v22 offset:16384
	ds_read_b64_tr_b16 v[74:75], v22 offset:17408
	v_mfma_f32_32x32x16_bf16 v[24:39], v[84:87], a[24:27], v[24:39]
	ds_read_b64_tr_b16 v[76:77], v22 offset:16896
	ds_read_b64_tr_b16 v[78:79], v22 offset:17920
	s_waitcnt lgkmcnt(4) vmcnt(20)
	v_mfma_f32_32x32x16_bf16 v[176:191], v[88:91], a[28:31], v[176:191]
	ds_read_b64_tr_b16 v[80:81], v22 offset:18432
	ds_read_b64_tr_b16 v[82:83], v22 offset:19456
	v_mfma_f32_32x32x16_bf16 v[24:39], v[92:95], a[28:31], v[24:39]
	ds_read_b64_tr_b16 v[84:85], v22 offset:18944
	ds_read_b64_tr_b16 v[86:87], v22 offset:19968
	s_waitcnt vmcnt(7)
	s_mov_b64 exec, 1
	buffer_store_dword v11, off, s[28:31], s74 offset:384
	s_mov_b64 exec, -1
	s_waitcnt lgkmcnt(4)
	v_mfma_f32_32x32x16_bf16 v[176:191], v[72:75], a[32:35], v[176:191]
	ds_read_b64_tr_b16 v[88:89], v21 offset:0
	ds_read_b64_tr_b16 v[90:91], v21 offset:1024
	v_mfma_f32_32x32x16_bf16 v[24:39], v[76:79], a[32:35], v[24:39]
	ds_read_b64_tr_b16 v[92:93], v21 offset:512
	ds_read_b64_tr_b16 v[94:95], v21 offset:1536
	s_waitcnt lgkmcnt(4)
	v_mfma_f32_32x32x16_bf16 v[176:191], v[80:83], a[36:39], v[176:191]
	ds_read_b64_tr_b16 v[72:73], v21 offset:2048
	ds_read_b64_tr_b16 v[74:75], v21 offset:3072
	v_mfma_f32_32x32x16_bf16 v[24:39], v[84:87], a[36:39], v[24:39]
	ds_read_b64_tr_b16 v[76:77], v21 offset:2560
	ds_read_b64_tr_b16 v[78:79], v21 offset:3584
	s_waitcnt lgkmcnt(4)
	v_mfma_f32_32x32x16_bf16 v[176:191], v[88:91], a[40:43], v[176:191]
	ds_read_b64_tr_b16 v[80:81], v21 offset:4096
	ds_read_b64_tr_b16 v[82:83], v21 offset:5120
	v_mfma_f32_32x32x16_bf16 v[24:39], v[92:95], a[40:43], v[24:39]
	ds_read_b64_tr_b16 v[84:85], v21 offset:4608
	ds_read_b64_tr_b16 v[86:87], v21 offset:5632
	s_waitcnt lgkmcnt(4)
	v_mfma_f32_32x32x16_bf16 v[176:191], v[72:75], a[44:47], v[176:191]
	ds_read_b64_tr_b16 v[88:89], v21 offset:6144
	ds_read_b64_tr_b16 v[90:91], v21 offset:7168
	v_mfma_f32_32x32x16_bf16 v[24:39], v[76:79], a[44:47], v[24:39]
	ds_read_b64_tr_b16 v[92:93], v21 offset:6656
	ds_read_b64_tr_b16 v[94:95], v21 offset:7680
	s_waitcnt lgkmcnt(4)
	v_mfma_f32_32x32x16_bf16 v[176:191], v[80:83], a[48:51], v[176:191]
	ds_read_b64_tr_b16 v[72:73], v21 offset:8192
	ds_read_b64_tr_b16 v[74:75], v21 offset:9216
	v_mfma_f32_32x32x16_bf16 v[24:39], v[84:87], a[48:51], v[24:39]
	ds_read_b64_tr_b16 v[76:77], v21 offset:8704
	ds_read_b64_tr_b16 v[78:79], v21 offset:9728
	s_waitcnt lgkmcnt(4)
	v_mfma_f32_32x32x16_bf16 v[176:191], v[88:91], a[52:55], v[176:191]
	ds_read_b64_tr_b16 v[80:81], v21 offset:10240
	ds_read_b64_tr_b16 v[82:83], v21 offset:11264
	v_mfma_f32_32x32x16_bf16 v[24:39], v[92:95], a[52:55], v[24:39]
	ds_read_b64_tr_b16 v[84:85], v21 offset:10752
	ds_read_b64_tr_b16 v[86:87], v21 offset:11776
	s_waitcnt lgkmcnt(4)
	v_mfma_f32_32x32x16_bf16 v[176:191], v[72:75], a[56:59], v[176:191]
	ds_read_b64_tr_b16 v[88:89], v21 offset:12288
	ds_read_b64_tr_b16 v[90:91], v21 offset:13312
	v_mfma_f32_32x32x16_bf16 v[24:39], v[76:79], a[56:59], v[24:39]
	ds_read_b64_tr_b16 v[92:93], v21 offset:12800
	ds_read_b64_tr_b16 v[94:95], v21 offset:13824
	buffer_load_dword v14, v15, s[28:31], s73 offen offset:384 sc1
	s_waitcnt lgkmcnt(4)
	v_mfma_f32_32x32x16_bf16 v[176:191], v[80:83], a[60:63], v[176:191]
	ds_read_b64_tr_b16 v[72:73], v21 offset:14336
	ds_read_b64_tr_b16 v[74:75], v21 offset:15360
	v_mfma_f32_32x32x16_bf16 v[24:39], v[84:87], a[60:63], v[24:39]
	ds_read_b64_tr_b16 v[76:77], v21 offset:14848
	ds_read_b64_tr_b16 v[78:79], v21 offset:15872
	s_waitcnt lgkmcnt(4)
	v_mfma_f32_32x32x16_bf16 v[176:191], v[88:91], a[64:67], v[176:191]
	ds_read_b64_tr_b16 v[80:81], v21 offset:16384
	ds_read_b64_tr_b16 v[82:83], v21 offset:17408
	v_mfma_f32_32x32x16_bf16 v[24:39], v[92:95], a[64:67], v[24:39]
	ds_read_b64_tr_b16 v[84:85], v21 offset:16896
	ds_read_b64_tr_b16 v[86:87], v21 offset:17920
	s_waitcnt lgkmcnt(4) vmcnt(8)
	v_mfma_f32_32x32x16_bf16 v[176:191], v[72:75], a[68:71], v[176:191]
	ds_read_b64_tr_b16 v[88:89], v21 offset:18432
	ds_read_b64_tr_b16 v[90:91], v21 offset:19456
	v_mfma_f32_32x32x16_bf16 v[24:39], v[76:79], a[68:71], v[24:39]
	ds_read_b64_tr_b16 v[92:93], v21 offset:18944
	ds_read_b64_tr_b16 v[94:95], v21 offset:19968
	s_waitcnt lgkmcnt(4) vmcnt(7)
	v_mfma_f32_32x32x16_bf16 v[176:191], v[80:83], a[72:75], v[176:191]
	ds_read_b64_tr_b16 v[72:73], v21 offset:20480
	ds_read_b64_tr_b16 v[74:75], v21 offset:21504
	v_mfma_f32_32x32x16_bf16 v[24:39], v[84:87], a[72:75], v[24:39]
	ds_read_b64_tr_b16 v[76:77], v21 offset:20992
	ds_read_b64_tr_b16 v[78:79], v21 offset:22016
	s_waitcnt vmcnt(0)
	v_cmp_ne_u32 vcc, s65, v14
	s_nop 0
	s_cbranch_vccnz Lh1slow_30
Lh1ok_31:
	s_add_u32 s41, s41, 4096
	buffer_load_dwordx4 a[96:99], v4, s[28:31], s41 offen offset:0 sc1
	buffer_load_dwordx4 a[100:103], v4, s[28:31], s41 offen offset:1024 sc1
	buffer_load_dwordx4 a[104:107], v4, s[28:31], s41 offen offset:2048 sc1
	buffer_load_dwordx4 a[108:111], v4, s[28:31], s41 offen offset:3072 sc1
	s_waitcnt lgkmcnt(4)
	v_mfma_f32_32x32x16_bf16 v[176:191], v[88:91], a[76:79], v[176:191]
	ds_read_b64_tr_b16 v[80:81], v21 offset:22528
	ds_read_b64_tr_b16 v[82:83], v21 offset:23552
	v_mfma_f32_32x32x16_bf16 v[24:39], v[92:95], a[76:79], v[24:39]
	ds_read_b64_tr_b16 v[84:85], v21 offset:23040
	ds_read_b64_tr_b16 v[86:87], v21 offset:24064
	s_add_u32 s42, s42, 4096
	buffer_load_dwordx4 a[112:115], v4, s[28:31], s42 offen offset:0 sc1
	s_waitcnt lgkmcnt(4)
	v_mfma_f32_32x32x16_bf16 v[176:191], v[72:75], a[80:83], v[176:191]
	ds_read_b64_tr_b16 v[88:89], v21 offset:24576
	ds_read_b64_tr_b16 v[90:91], v21 offset:25600
	v_mfma_f32_32x32x16_bf16 v[24:39], v[76:79], a[80:83], v[24:39]
	ds_read_b64_tr_b16 v[92:93], v21 offset:25088
	ds_read_b64_tr_b16 v[94:95], v21 offset:26112
	buffer_load_dwordx4 a[116:119], v4, s[28:31], s42 offen offset:1024 sc1
	s_waitcnt lgkmcnt(4)
	v_mfma_f32_32x32x16_bf16 v[176:191], v[80:83], a[84:87], v[176:191]
	ds_read_b64_tr_b16 v[72:73], v21 offset:26624
	ds_read_b64_tr_b16 v[74:75], v21 offset:27648
	v_mfma_f32_32x32x16_bf16 v[24:39], v[84:87], a[84:87], v[24:39]
	ds_read_b64_tr_b16 v[76:77], v21 offset:27136
	ds_read_b64_tr_b16 v[78:79], v21 offset:28160
	buffer_load_dwordx4 a[120:123], v4, s[28:31], s42 offen offset:2048 sc1
	s_waitcnt lgkmcnt(4)
	v_mfma_f32_32x32x16_bf16 v[176:191], v[88:91], a[88:91], v[176:191]
	ds_read_b64_tr_b16 v[80:81], v21 offset:28672
	ds_read_b64_tr_b16 v[82:83], v21 offset:29696
	v_mfma_f32_32x32x16_bf16 v[24:39], v[92:95], a[88:91], v[24:39]
	ds_read_b64_tr_b16 v[84:85], v21 offset:29184
	ds_read_b64_tr_b16 v[86:87], v21 offset:30208
	buffer_load_dwordx4 a[124:127], v4, s[28:31], s42 offen offset:3072 sc1
	s_waitcnt lgkmcnt(4)
	v_mfma_f32_32x32x16_bf16 v[176:191], v[72:75], a[92:95], v[176:191]
	ds_read_b64_tr_b16 v[88:89], v21 offset:30720
	ds_read_b64_tr_b16 v[90:91], v21 offset:31744
	v_mfma_f32_32x32x16_bf16 v[24:39], v[76:79], a[92:95], v[24:39]
	ds_read_b64_tr_b16 v[92:93], v21 offset:31232
	ds_read_b64_tr_b16 v[94:95], v21 offset:32256
	s_add_u32 s43, s43, 4096
	buffer_load_dwordx4 a[0:3], v4, s[28:31], s43 offen offset:0 sc1
	s_waitcnt lgkmcnt(4)
	v_mfma_f32_32x32x16_bf16 v[176:191], v[80:83], v[240:243], v[176:191]
	ds_read_b64_tr_b16 v[72:73], v21 offset:32768
	ds_read_b64_tr_b16 v[74:75], v21 offset:33792
	v_mfma_f32_32x32x16_bf16 v[24:39], v[84:87], v[240:243], v[24:39]
	ds_read_b64_tr_b16 v[76:77], v21 offset:33280
	ds_read_b64_tr_b16 v[78:79], v21 offset:34304
	buffer_load_dwordx4 a[4:7], v4, s[28:31], s43 offen offset:1024 sc1
	s_waitcnt lgkmcnt(4)
	v_mfma_f32_32x32x16_bf16 v[176:191], v[88:91], v[244:247], v[176:191]
	ds_read_b64_tr_b16 v[80:81], v21 offset:34816
	ds_read_b64_tr_b16 v[82:83], v21 offset:35840
	v_mfma_f32_32x32x16_bf16 v[24:39], v[92:95], v[244:247], v[24:39]
	ds_read_b64_tr_b16 v[84:85], v21 offset:35328
	ds_read_b64_tr_b16 v[86:87], v21 offset:36352
	buffer_load_dwordx4 a[8:11], v4, s[28:31], s43 offen offset:2048 sc1
	s_waitcnt lgkmcnt(4)
	v_mfma_f32_32x32x16_bf16 v[176:191], v[72:75], v[248:251], v[176:191]
	ds_read_b64_tr_b16 v[88:89], v21 offset:36864
	ds_read_b64_tr_b16 v[90:91], v21 offset:37888
	v_mfma_f32_32x32x16_bf16 v[24:39], v[76:79], v[248:251], v[24:39]
	ds_read_b64_tr_b16 v[92:93], v21 offset:37376
	ds_read_b64_tr_b16 v[94:95], v21 offset:38400
	buffer_load_dwordx4 a[12:15], v4, s[28:31], s43 offen offset:3072 sc1
	s_waitcnt lgkmcnt(4)
	v_mfma_f32_32x32x16_bf16 v[176:191], v[80:83], v[252:255], v[176:191]
	ds_read_b64_tr_b16 v[72:73], v21 offset:38912
	ds_read_b64_tr_b16 v[74:75], v21 offset:39936
	v_mfma_f32_32x32x16_bf16 v[24:39], v[84:87], v[252:255], v[24:39]
	ds_read_b64_tr_b16 v[76:77], v21 offset:39424
	ds_read_b64_tr_b16 v[78:79], v21 offset:40448
	s_add_u32 s44, s44, 4096
	buffer_load_dwordx4 a[16:19], v4, s[28:31], s44 offen offset:0 sc1
	s_waitcnt lgkmcnt(4) vmcnt(12)
	v_mfma_f32_32x32x16_bf16 v[176:191], v[88:91], a[96:99], v[176:191]
	ds_read_b64_tr_b16 v[80:81], v21 offset:40960
	ds_read_b64_tr_b16 v[82:83], v21 offset:41984
	v_mfma_f32_32x32x16_bf16 v[24:39], v[92:95], a[96:99], v[24:39]
	ds_read_b64_tr_b16 v[84:85], v21 offset:41472
	ds_read_b64_tr_b16 v[86:87], v21 offset:42496
	buffer_load_dwordx4 a[20:23], v4, s[28:31], s44 offen offset:1024 sc1
	s_waitcnt lgkmcnt(4) vmcnt(12)
	v_mfma_f32_32x32x16_bf16 v[176:191], v[72:75], a[100:103], v[176:191]
	ds_read_b64_tr_b16 v[88:89], v21 offset:43008
	ds_read_b64_tr_b16 v[90:91], v21 offset:44032
	v_mfma_f32_32x32x16_bf16 v[24:39], v[76:79], a[100:103], v[24:39]
	ds_read_b64_tr_b16 v[92:93], v21 offset:43520
	ds_read_b64_tr_b16 v[94:95], v21 offset:44544
	buffer_load_dwordx4 a[24:27], v4, s[28:31], s44 offen offset:2048 sc1
	s_waitcnt lgkmcnt(4) vmcnt(12)
	v_mfma_f32_32x32x16_bf16 v[176:191], v[80:83], a[104:107], v[176:191]
	ds_read_b64_tr_b16 v[72:73], v21 offset:45056
	ds_read_b64_tr_b16 v[74:75], v21 offset:46080
	v_mfma_f32_32x32x16_bf16 v[24:39], v[84:87], a[104:107], v[24:39]
	ds_read_b64_tr_b16 v[76:77], v21 offset:45568
	ds_read_b64_tr_b16 v[78:79], v21 offset:46592
	buffer_load_dwordx4 a[28:31], v4, s[28:31], s44 offen offset:3072 sc1
	s_waitcnt lgkmcnt(4) vmcnt(12)
	v_mfma_f32_32x32x16_bf16 v[176:191], v[88:91], a[108:111], v[176:191]
	ds_read_b64_tr_b16 v[80:81], v21 offset:47104
	ds_read_b64_tr_b16 v[82:83], v21 offset:48128
	v_mfma_f32_32x32x16_bf16 v[24:39], v[92:95], a[108:111], v[24:39]
	ds_read_b64_tr_b16 v[84:85], v21 offset:47616
	ds_read_b64_tr_b16 v[86:87], v21 offset:48640
	s_add_u32 s45, s45, 4096
	buffer_load_dwordx4 a[32:35], v4, s[28:31], s45 offen offset:0 sc1
	s_waitcnt lgkmcnt(4) vmcnt(12)
	v_mfma_f32_32x32x16_bf16 v[176:191], v[72:75], a[112:115], v[176:191]
	ds_read_b64_tr_b16 v[88:89], v21 offset:49152
	ds_read_b64_tr_b16 v[90:91], v21 offset:50176
	v_mfma_f32_32x32x16_bf16 v[24:39], v[76:79], a[112:115], v[24:39]
	ds_read_b64_tr_b16 v[92:93], v21 offset:49664
	ds_read_b64_tr_b16 v[94:95], v21 offset:50688
	buffer_load_dwordx4 a[36:39], v4, s[28:31], s45 offen offset:1024 sc1
	s_waitcnt lgkmcnt(4) vmcnt(12)
	v_mfma_f32_32x32x16_bf16 v[176:191], v[80:83], a[116:119], v[176:191]
	ds_read_b64_tr_b16 v[72:73], v21 offset:51200
	ds_read_b64_tr_b16 v[74:75], v21 offset:52224
	v_mfma_f32_32x32x16_bf16 v[24:39], v[84:87], a[116:119], v[24:39]
	ds_read_b64_tr_b16 v[76:77], v21 offset:51712
	ds_read_b64_tr_b16 v[78:79], v21 offset:52736
	buffer_load_dwordx4 a[40:43], v4, s[28:31], s45 offen offset:2048 sc1
	s_waitcnt lgkmcnt(4) vmcnt(12)
	v_mfma_f32_32x32x16_bf16 v[176:191], v[88:91], a[120:123], v[176:191]
	ds_read_b64_tr_b16 v[80:81], v21 offset:53248
	ds_read_b64_tr_b16 v[82:83], v21 offset:54272
	v_mfma_f32_32x32x16_bf16 v[24:39], v[92:95], a[120:123], v[24:39]
	ds_read_b64_tr_b16 v[84:85], v21 offset:53760
	ds_read_b64_tr_b16 v[86:87], v21 offset:54784
	buffer_load_dwordx4 a[44:47], v4, s[28:31], s45 offen offset:3072 sc1
	s_waitcnt lgkmcnt(4) vmcnt(12)
	v_mfma_f32_32x32x16_bf16 v[176:191], v[72:75], a[124:127], v[176:191]
	ds_read_b64_tr_b16 v[88:89], v21 offset:55296
	ds_read_b64_tr_b16 v[90:91], v21 offset:56320
	v_mfma_f32_32x32x16_bf16 v[24:39], v[76:79], a[124:127], v[24:39]
	ds_read_b64_tr_b16 v[92:93], v21 offset:55808
	ds_read_b64_tr_b16 v[94:95], v21 offset:56832
	s_add_u32 s46, s46, 4096
	buffer_load_dwordx4 a[48:51], v4, s[28:31], s46 offen offset:0 sc1
	s_waitcnt lgkmcnt(4) vmcnt(12)
	v_mfma_f32_32x32x16_bf16 v[176:191], v[80:83], a[0:3], v[176:191]
	ds_read_b64_tr_b16 v[72:73], v22 offset:20480
	ds_read_b64_tr_b16 v[74:75], v22 offset:21504
	v_mfma_f32_32x32x16_bf16 v[24:39], v[84:87], a[0:3], v[24:39]
	ds_read_b64_tr_b16 v[76:77], v22 offset:20992
	ds_read_b64_tr_b16 v[78:79], v22 offset:22016
	buffer_load_dwordx4 a[52:55], v4, s[28:31], s46 offen offset:1024 sc1
	s_waitcnt lgkmcnt(4) vmcnt(12)
	v_mfma_f32_32x32x16_bf16 v[176:191], v[88:91], a[4:7], v[176:191]
	ds_read_b64_tr_b16 v[80:81], v22 offset:22528
	ds_read_b64_tr_b16 v[82:83], v22 offset:23552
	v_mfma_f32_32x32x16_bf16 v[24:39], v[92:95], a[4:7], v[24:39]
	ds_read_b64_tr_b16 v[84:85], v22 offset:23040
	ds_read_b64_tr_b16 v[86:87], v22 offset:24064
	buffer_load_dwordx4 a[56:59], v4, s[28:31], s46 offen offset:2048 sc1
	s_waitcnt lgkmcnt(4) vmcnt(12)
	v_mfma_f32_32x32x16_bf16 v[176:191], v[72:75], a[8:11], v[176:191]
	ds_read_b64_tr_b16 v[88:89], v22 offset:24576
	ds_read_b64_tr_b16 v[90:91], v22 offset:25600
	v_mfma_f32_32x32x16_bf16 v[24:39], v[76:79], a[8:11], v[24:39]
	ds_read_b64_tr_b16 v[92:93], v22 offset:25088
	ds_read_b64_tr_b16 v[94:95], v22 offset:26112
	buffer_load_dwordx4 a[60:63], v4, s[28:31], s46 offen offset:3072 sc1
	s_waitcnt lgkmcnt(4) vmcnt(12)
	v_mfma_f32_32x32x16_bf16 v[176:191], v[80:83], a[12:15], v[176:191]
	ds_read_b64_tr_b16 v[72:73], v22 offset:26624
	ds_read_b64_tr_b16 v[74:75], v22 offset:27648
	v_mfma_f32_32x32x16_bf16 v[24:39], v[84:87], a[12:15], v[24:39]
	ds_read_b64_tr_b16 v[76:77], v22 offset:27136
	ds_read_b64_tr_b16 v[78:79], v22 offset:28160
	s_waitcnt lgkmcnt(4) vmcnt(11)
	v_mfma_f32_32x32x16_bf16 v[176:191], v[88:91], a[16:19], v[176:191]
	ds_read_b64_tr_b16 v[80:81], v22 offset:28672
	ds_read_b64_tr_b16 v[82:83], v22 offset:29696
	v_mfma_f32_32x32x16_bf16 v[24:39], v[92:95], a[16:19], v[24:39]
	ds_read_b64_tr_b16 v[84:85], v22 offset:29184
	ds_read_b64_tr_b16 v[86:87], v22 offset:30208
	s_waitcnt lgkmcnt(4) vmcnt(10)
	v_mfma_f32_32x32x16_bf16 v[176:191], v[72:75], a[20:23], v[176:191]
	ds_read_b64_tr_b16 v[88:89], v22 offset:30720
	ds_read_b64_tr_b16 v[90:91], v22 offset:31744
	v_mfma_f32_32x32x16_bf16 v[24:39], v[76:79], a[20:23], v[24:39]
	ds_read_b64_tr_b16 v[92:93], v22 offset:31232
	ds_read_b64_tr_b16 v[94:95], v22 offset:32256
	s_waitcnt lgkmcnt(4) vmcnt(9)
	v_mfma_f32_32x32x16_bf16 v[176:191], v[80:83], a[24:27], v[176:191]
	ds_read_b64_tr_b16 v[72:73], v22 offset:32768
	ds_read_b64_tr_b16 v[74:75], v22 offset:33792
	v_mfma_f32_32x32x16_bf16 v[24:39], v[84:87], a[24:27], v[24:39]
	ds_read_b64_tr_b16 v[76:77], v22 offset:34816
	ds_read_b64_tr_b16 v[78:79], v22 offset:35840
	s_waitcnt lgkmcnt(4) vmcnt(8)
	v_mfma_f32_32x32x16_bf16 v[176:191], v[88:91], a[28:31], v[176:191]
	ds_read_b64_tr_b16 v[80:81], v22 offset:36864
	ds_read_b64_tr_b16 v[82:83], v22 offset:37888
	v_mfma_f32_32x32x16_bf16 v[24:39], v[92:95], a[28:31], v[24:39]
	ds_read_b64_tr_b16 v[84:85], v22 offset:38912
	ds_read_b64_tr_b16 v[86:87], v22 offset:39936
	s_waitcnt lgkmcnt(4) vmcnt(7)
	v_mfma_f32_32x32x16_bf16 v[176:191], v[72:75], a[32:35], v[176:191]
	ds_read_b64_tr_b16 v[88:89], v22 offset:40960
	ds_read_b64_tr_b16 v[90:91], v22 offset:41984
	s_waitcnt vmcnt(6)
	v_mfma_f32_32x32x16_bf16 v[176:191], v[76:79], a[36:39], v[176:191]
	ds_read_b64_tr_b16 v[92:93], v22 offset:43008
	ds_read_b64_tr_b16 v[94:95], v22 offset:44032
	s_waitcnt lgkmcnt(4) vmcnt(5)
	v_mfma_f32_32x32x16_bf16 v[176:191], v[80:83], a[40:43], v[176:191]
	ds_read_b64_tr_b16 v[72:73], v22 offset:45056
	ds_read_b64_tr_b16 v[74:75], v22 offset:46080
	s_waitcnt vmcnt(4)
	v_mfma_f32_32x32x16_bf16 v[176:191], v[84:87], a[44:47], v[176:191]
	ds_read_b64_tr_b16 v[76:77], v22 offset:47104
	ds_read_b64_tr_b16 v[78:79], v22 offset:48128
	s_waitcnt lgkmcnt(4) vmcnt(3)
	v_mfma_f32_32x32x16_bf16 v[176:191], v[88:91], a[48:51], v[176:191]
	ds_read_b64_tr_b16 v[80:81], v22 offset:33280
	ds_read_b64_tr_b16 v[82:83], v22 offset:34304
	s_waitcnt vmcnt(2)
	v_mfma_f32_32x32x16_bf16 v[176:191], v[92:95], a[52:55], v[176:191]
	ds_read_b64_tr_b16 v[84:85], v22 offset:35328
	ds_read_b64_tr_b16 v[86:87], v22 offset:36352
	s_waitcnt lgkmcnt(4) vmcnt(1)
	v_mfma_f32_32x32x16_bf16 v[176:191], v[72:75], a[56:59], v[176:191]
	ds_read_b64_tr_b16 v[88:89], v22 offset:37376
	ds_read_b64_tr_b16 v[90:91], v22 offset:38400
	s_waitcnt vmcnt(0)
	v_mfma_f32_32x32x16_bf16 v[176:191], v[76:79], a[60:63], v[176:191]
	ds_read_b64_tr_b16 v[92:93], v22 offset:39424
	ds_read_b64_tr_b16 v[94:95], v22 offset:40448
	s_waitcnt lgkmcnt(4)
	v_mfma_f32_32x32x16_bf16 v[24:39], v[80:83], a[32:35], v[24:39]
	ds_read_b64_tr_b16 v[72:73], v22 offset:41472
	ds_read_b64_tr_b16 v[74:75], v22 offset:42496
	v_mfma_f32_32x32x16_bf16 v[24:39], v[84:87], a[36:39], v[24:39]
	ds_read_b64_tr_b16 v[76:77], v22 offset:43520
	ds_read_b64_tr_b16 v[78:79], v22 offset:44544
	s_waitcnt lgkmcnt(4)
	v_mfma_f32_32x32x16_bf16 v[24:39], v[88:91], a[40:43], v[24:39]
	ds_read_b64_tr_b16 v[80:81], v22 offset:45568
	ds_read_b64_tr_b16 v[82:83], v22 offset:46592
	v_cvt_pk_bf16_f32 v96, v176, v177
	v_cvt_pk_bf16_f32 v97, v178, v179
	v_cvt_pk_bf16_f32 v98, v180, v181
	v_cvt_pk_bf16_f32 v99, v182, v183
	buffer_store_dwordx4 v[96:99], v4, s[28:31], s53 offen offset:0
	v_cvt_pk_bf16_f32 v100, v184, v185
	v_mfma_f32_32x32x16_bf16 v[24:39], v[92:95], a[44:47], v[24:39]
	ds_read_b64_tr_b16 v[84:85], v22 offset:47616
	ds_read_b64_tr_b16 v[86:87], v22 offset:48640
	v_cvt_pk_bf16_f32 v101, v186, v187
	v_cvt_pk_bf16_f32 v102, v188, v189
	v_cvt_pk_bf16_f32 v103, v190, v191
	buffer_store_dwordx4 v[100:103], v4, s[28:31], s53 offen offset:1024
	s_xor_b32 s48, s53, 2048
	s_xor_b32 s49, s74, 4
	s_waitcnt lgkmcnt(4)
	v_mfma_f32_32x32x16_bf16 v[24:39], v[72:75], a[48:51], v[24:39]
	v_mov_b32 v104, 0
	v_mfma_f32_32x32x16_bf16 v[24:39], v[76:79], a[52:55], v[24:39]
	s_waitcnt lgkmcnt(0)
	v_mfma_f32_32x32x16_bf16 v[24:39], v[80:83], a[56:59], v[24:39]
	v_mfma_f32_32x32x16_bf16 v[24:39], v[84:87], a[60:63], v[24:39]
	s_cmp_lg_u32 s66, 0
	s_cbranch_scc1 L_tail_fast1
L_tail_fast0:
	buffer_load_dwordx4 v[232:235], v4, s[28:31], s48 offen offset:0 sc1
	buffer_load_dwordx4 v[236:239], v4, s[28:31], s48 offen offset:1024 sc1
	v_add_u32 v106, s90, v4
	v_add_u32 v107, 57344, v106
	s_barrier
	s_waitcnt vmcnt(1)
	v_max3_u32 v105, v232, v233, v234
	s_waitcnt vmcnt(0)
	v_max3_u32 v108, v235, v236, v237
	v_max3_u32 v105, v105, v238, v239
	v_max_u32 v105, v105, v108
	v_cmp_eq_u32 vcc, -1, v105
	s_mov_b64 exec, 1
	buffer_store_dword v11, off, s[28:31], s74 offset:512
	s_mov_b64 exec, -1
	s_cbranch_vccnz Lpslow_34
Lpok_35:
	v_mfma_f32_32x32x16_bf16 v[24:39], a[240:243], v[232:235], v[24:39]
	v_mfma_f32_32x32x16_bf16 v[24:39], a[244:247], v[236:239], v[24:39]
	s_lshl_b32 s53, s62, 11
	s_add_u32 s53, s53, s68
	s_add_u32 s53, s53, 32768
	s_lshl_b32 s49, s62, 8
	s_add_u32 s49, s49, s68
	s_add_u32 s49, s49, 61440
	s_nop 5
	v_cvt_pk_bf16_f32 v224, v24, v25
	v_cvt_pk_bf16_f32 v225, v26, v27
	v_cvt_pk_bf16_f32 v226, v28, v29
	v_cvt_pk_bf16_f32 v227, v30, v31
	buffer_store_dwordx4 v[224:227], v4, s[28:31], s53 offen
	v_cvt_pk_bf16_f32 v228, v32, v33
	v_cvt_pk_bf16_f32 v229, v34, v35
	v_cvt_pk_bf16_f32 v230, v36, v37
	v_cvt_pk_bf16_f32 v231, v38, v39
	buffer_store_dwordx4 v[228:231], v4, s[28:31], s53 offen offset:1024
	v_pk_add_f32 v[96:97], v[24:25], v[26:27]
	v_pk_mul_f32 v[98:99], v[24:25], v[24:25]
	v_pk_fma_f32 v[98:99], v[26:27], v[26:27], v[98:99]
	v_pk_fma_f32 v[98:99], v[28:29], v[28:29], v[98:99]
	v_pk_add_f32 v[96:97], v[96:97], v[28:29]
	v_pk_fma_f32 v[98:99], v[30:31], v[30:31], v[98:99]
	v_pk_add_f32 v[96:97], v[96:97], v[30:31]
	v_pk_fma_f32 v[98:99], v[32:33], v[32:33], v[98:99]
	v_pk_add_f32 v[96:97], v[96:97], v[32:33]
	v_pk_fma_f32 v[98:99], v[34:35], v[34:35], v[98:99]
	v_pk_add_f32 v[96:97], v[96:97], v[34:35]
	v_pk_fma_f32 v[98:99], v[36:37], v[36:37], v[98:99]
	v_pk_add_f32 v[96:97], v[96:97], v[36:37]
	v_pk_fma_f32 v[98:99], v[38:39], v[38:39], v[98:99]
	v_pk_add_f32 v[96:97], v[96:97], v[38:39]
	v_add_f32 v96, v96, v97
	v_add_f32 v97, v98, v99
	s_nop 1
	v_permlane32_swap_b32 v96, v97
	v_add_f32 v96, v96, v97
	buffer_store_dword v96, v2, s[28:31], s49 offen
	ds_write_b128 v106, a[128:131] offset:0
	ds_write_b128 v106, a[132:135] offset:4096
	ds_write_b128 v106, a[136:139] offset:8192
	ds_write_b128 v106, a[140:143] offset:12288
	ds_write_b128 v106, a[144:147] offset:16384
	ds_write_b128 v106, a[148:151] offset:20480
	s_waitcnt vmcnt(0)
	s_mov_b64 exec, 1
	buffer_store_dword v11, off, s[28:31], s74 offset:640
	s_mov_b64 exec, -1
	ds_write_b128 v106, a[152:155] offset:24576
	ds_write_b128 v106, a[156:159] offset:28672
	ds_write_b128 v106, a[160:163] offset:32768
	ds_write_b128 v106, a[164:167] offset:36864
	ds_write_b128 v106, a[168:171] offset:40960
	ds_write_b128 v106, a[172:175] offset:45056
	ds_write_b128 v106, a[176:179] offset:49152
	ds_write_b128 v106, a[180:183] offset:53248
L_second_fast:
	s_add_u32 s48, s68, 32768
	s_add_u32 s40, s48, s76
	s_add_u32 s41, s48, s77
	s_add_u32 s42, s48, s78
	s_add_u32 s43, s48, s79
	s_add_u32 s44, s48, s80
	s_add_u32 s45, s48, s81
	s_add_u32 s46, s48, s82
	s_add_u32 s52, s68, 61440
Lpoll_37:
	buffer_load_dword v14, v6, s[28:31], s73 offen offset:640 sc1
	s_waitcnt vmcnt(0)
	v_cmp_ne_u32 vcc, s65, v14
	s_nop 0
	s_cbranch_vccz Lpdone_38
	s_sub_u32 s67, s67, 1
	s_cbranch_scc0 Lpoll_37
	s_mov_b32 s67, 0
Lpdone_38:
	s_add_u32 s69, s69, 524288
	s_mov_b32 s66, 1
	s_add_u32 s73, s73, 0x400
	s_add_u32 s74, s74, 0x400
	buffer_load_dwordx4 a[0:3], v4, s[28:31], s40 offen offset:0 sc1
	buffer_load_dwordx4 a[4:7], v4, s[28:31], s40 offen offset:1024 sc1
	buffer_load_dwordx4 a[8:11], v4, s[28:31], s40 offen offset:2048 sc1
	buffer_load_dwordx4 a[12:15], v4, s[28:31], s40 offen offset:3072 sc1
	buffer_load_dwordx4 v[224:227], v4, s[28:31], s52 offen offset:0 sc1
	buffer_load_dwordx4 v[228:231], v4, s[28:31], s52 offen offset:1024 sc1
	buffer_load_dwordx4 v[232:235], v4, s[28:31], s52 offen offset:2048 sc1
	buffer_load_dwordx4 v[236:239], v4, s[28:31], s52 offen offset:3072 sc1
	buffer_load_dwordx4 a[16:19], v4, s[28:31], s41 offen offset:0 sc1
	buffer_load_dwordx4 a[20:23], v4, s[28:31], s41 offen offset:1024 sc1
	buffer_load_dwordx4 a[24:27], v4, s[28:31], s41 offen offset:2048 sc1
	buffer_load_dwordx4 a[28:31], v4, s[28:31], s41 offen offset:3072 sc1
	buffer_load_dwordx4 a[32:35], v4, s[28:31], s42 offen offset:0 sc1
	s_waitcnt lgkmcnt(0)
	s_barrier
	v_add_u32 v106, s90, v4
	v_add_u32 v107, 57344, v106
	ds_read_b64_tr_b16 v[72:73], v21 offset:0
	ds_read_b64_tr_b16 v[74:75], v21 offset:512
	ds_read_b64_tr_b16 v[76:77], v21 offset:28672
	ds_read_b64_tr_b16 v[78:79], v21 offset:29184
	ds_read_b64_tr_b16 v[80:81], v21 offset:1024
	ds_read_b64_tr_b16 v[82:83], v21 offset:1536
	ds_read_b64_tr_b16 v[84:85], v21 offset:29696
	ds_read_b64_tr_b16 v[86:87], v21 offset:30208
	buffer_load_dwordx4 a[36:39], v4, s[28:31], s42 offen offset:1024 sc1
	s_waitcnt lgkmcnt(4) vmcnt(13)
	v_mfma_f32_32x32x16_bf16 v[112:127], a[0:3], v[72:75], 0
	ds_read_b64_tr_b16 v[88:89], v21 offset:2048
	ds_read_b64_tr_b16 v[90:91], v21 offset:2560
	v_mfma_f32_32x32x16_bf16 v[128:143], a[0:3], v[76:79], 0
	ds_read_b64_tr_b16 v[92:93], v21 offset:30720
	ds_read_b64_tr_b16 v[94:95], v21 offset:31232
	ds_write_b128 v107, a[184:187] offset:0
	buffer_load_dwordx4 a[40:43], v4, s[28:31], s42 offen offset:2048 sc1
	s_waitcnt lgkmcnt(5) vmcnt(13)
	v_mfma_f32_32x32x16_bf16 v[112:127], a[4:7], v[80:83], v[112:127]
	ds_read_b64_tr_b16 v[72:73], v21 offset:3072
	ds_read_b64_tr_b16 v[74:75], v21 offset:3584
	v_mfma_f32_32x32x16_bf16 v[128:143], a[4:7], v[84:87], v[128:143]
	ds_read_b64_tr_b16 v[76:77], v21 offset:31744
	ds_read_b64_tr_b16 v[78:79], v21 offset:32256
	ds_write_b128 v107, a[188:191] offset:4096
	buffer_load_dwordx4 a[44:47], v4, s[28:31], s42 offen offset:3072 sc1
	s_waitcnt lgkmcnt(6) vmcnt(13)
	v_mfma_f32_32x32x16_bf16 v[112:127], a[8:11], v[88:91], v[112:127]
	ds_read_b64_tr_b16 v[80:81], v21 offset:4096
	ds_read_b64_tr_b16 v[82:83], v21 offset:4608
	v_mfma_f32_32x32x16_bf16 v[128:143], a[8:11], v[92:95], v[128:143]
	ds_read_b64_tr_b16 v[84:85], v21 offset:32768
	ds_read_b64_tr_b16 v[86:87], v21 offset:33280
	ds_write_b128 v107, a[192:195] offset:8192
	buffer_load_dwordx4 a[48:51], v4, s[28:31], s43 offen offset:0 sc1
	s_waitcnt lgkmcnt(6) vmcnt(13)
	v_mfma_f32_32x32x16_bf16 v[112:127], a[12:15], v[72:75], v[112:127]
	ds_read_b64_tr_b16 v[88:89], v21 offset:5120
	ds_read_b64_tr_b16 v[90:91], v21 offset:5632
	v_mfma_f32_32x32x16_bf16 v[128:143], a[12:15], v[76:79], v[128:143]
	ds_read_b64_tr_b16 v[92:93], v21 offset:33792
	ds_read_b64_tr_b16 v[94:95], v21 offset:34304
	ds_write_b128 v107, a[196:199] offset:12288
	buffer_load_dwordx4 a[52:55], v4, s[28:31], s43 offen offset:1024 sc1
	s_waitcnt lgkmcnt(6) vmcnt(9)
	v_mfma_f32_32x32x16_bf16 v[112:127], a[16:19], v[80:83], v[112:127]
	ds_read_b64_tr_b16 v[72:73], v21 offset:6144
	ds_read_b64_tr_b16 v[74:75], v21 offset:6656
	v_mfma_f32_32x32x16_bf16 v[128:143], a[16:19], v[84:87], v[128:143]
	ds_read_b64_tr_b16 v[76:77], v21 offset:34816
	ds_read_b64_tr_b16 v[78:79], v21 offset:35328
	ds_write_b128 v107, a[200:203] offset:16384
	buffer_load_dwordx4 a[56:59], v4, s[28:31], s43 offen offset:2048 sc1
	s_waitcnt lgkmcnt(6) vmcnt(9)
	v_mfma_f32_32x32x16_bf16 v[112:127], a[20:23], v[88:91], v[112:127]
	ds_read_b64_tr_b16 v[80:81], v21 offset:7168
	ds_read_b64_tr_b16 v[82:83], v21 offset:7680
	v_mfma_f32_32x32x16_bf16 v[128:143], a[20:23], v[92:95], v[128:143]
	ds_read_b64_tr_b16 v[84:85], v21 offset:35840
	ds_read_b64_tr_b16 v[86:87], v21 offset:36352
	ds_write_b128 v107, a[204:207] offset:20480
	buffer_load_dwordx4 a[60:63], v4, s[28:31], s43 offen offset:3072 sc1
	s_waitcnt lgkmcnt(6) vmcnt(9)
	v_mfma_f32_32x32x16_bf16 v[112:127], a[24:27], v[72:75], v[112:127]
	ds_read_b64_tr_b16 v[88:89], v21 offset:8192
	ds_read_b64_tr_b16 v[90:91], v21 offset:8704
	v_mfma_f32_32x32x16_bf16 v[128:143], a[24:27], v[76:79], v[128:143]
	ds_read_b64_tr_b16 v[92:93], v21 offset:36864
	ds_read_b64_tr_b16 v[94:95], v21 offset:37376
	ds_write_b128 v107, a[208:211] offset:24576
	buffer_load_dwordx4 a[64:67], v4, s[28:31], s44 offen offset:0 sc1
	s_waitcnt lgkmcnt(6) vmcnt(9)
	v_mfma_f32_32x32x16_bf16 v[112:127], a[28:31], v[80:83], v[112:127]
	ds_read_b64_tr_b16 v[72:73], v21 offset:9216
	ds_read_b64_tr_b16 v[74:75], v21 offset:9728
	v_cndmask_b32 v236, v236, 0, s[84:85]
	v_mfma_f32_32x32x16_bf16 v[128:143], a[28:31], v[84:87], v[128:143]
	ds_read_b64_tr_b16 v[76:77], v21 offset:37888
	ds_read_b64_tr_b16 v[78:79], v21 offset:38400
	v_cndmask_b32 v237, v237, 0, s[84:85]
	v_cndmask_b32 v238, v238, 0, s[84:85]
	buffer_load_dwordx4 a[68:71], v4, s[28:31], s44 offen offset:1024 sc1
	s_waitcnt lgkmcnt(5) vmcnt(9)
	v_mfma_f32_32x32x16_bf16 v[112:127], a[32:35], v[88:91], v[112:127]
	ds_read_b64_tr_b16 v[80:81], v21 offset:10240
	ds_read_b64_tr_b16 v[82:83], v21 offset:10752
	v_cndmask_b32 v239, v239, 0, s[84:85]
	v_mfma_f32_32x32x16_bf16 v[128:143], a[32:35], v[92:95], v[128:143]
	ds_read_b64_tr_b16 v[84:85], v21 offset:38912
	ds_read_b64_tr_b16 v[86:87], v21 offset:39424
	v_add_f32 v224, v224, v228
	v_add_f32 v225, v225, v229
	buffer_load_dwordx4 a[72:75], v4, s[28:31], s44 offen offset:2048 sc1
	s_waitcnt lgkmcnt(4) vmcnt(9)
	v_mfma_f32_32x32x16_bf16 v[112:127], a[36:39], v[72:75], v[112:127]
	ds_read_b64_tr_b16 v[88:89], v21 offset:11264
	ds_read_b64_tr_b16 v[90:91], v21 offset:11776
	v_add_f32 v226, v226, v230
	v_mfma_f32_32x32x16_bf16 v[128:143], a[36:39], v[76:79], v[128:143]
	ds_read_b64_tr_b16 v[92:93], v21 offset:39936
	ds_read_b64_tr_b16 v[94:95], v21 offset:40448
	v_add_f32 v227, v227, v231
	v_add_f32 v232, v232, v236
	buffer_load_dwordx4 a[76:79], v4, s[28:31], s44 offen offset:3072 sc1
	s_waitcnt lgkmcnt(4) vmcnt(9)
	v_mfma_f32_32x32x16_bf16 v[112:127], a[40:43], v[80:83], v[112:127]
	ds_read_b64_tr_b16 v[72:73], v21 offset:12288
	ds_read_b64_tr_b16 v[74:75], v21 offset:12800
	v_add_f32 v233, v233, v237
	v_mfma_f32_32x32x16_bf16 v[128:143], a[40:43], v[84:87], v[128:143]
	ds_read_b64_tr_b16 v[76:77], v21 offset:40960
	ds_read_b64_tr_b16 v[78:79], v21 offset:41472
	v_add_f32 v234, v234, v238
	v_add_f32 v235, v235, v239
	buffer_load_dwordx4 a[80:83], v4, s[28:31], s45 offen offset:0 sc1
	s_waitcnt lgkmcnt(4) vmcnt(9)
	v_mfma_f32_32x32x16_bf16 v[112:127], a[44:47], v[88:91], v[112:127]
	ds_read_b64_tr_b16 v[80:81], v21 offset:13312
	ds_read_b64_tr_b16 v[82:83], v21 offset:13824
	v_add_f32 v224, v224, v232
	v_mfma_f32_32x32x16_bf16 v[128:143], a[44:47], v[92:95], v[128:143]
	ds_read_b64_tr_b16 v[84:85], v21 offset:41984
	ds_read_b64_tr_b16 v[86:87], v21 offset:42496
	v_add_f32 v225, v225, v233
	v_add_f32 v226, v226, v234
	buffer_load_dwordx4 a[84:87], v4, s[28:31], s45 offen offset:1024 sc1
	s_waitcnt lgkmcnt(4) vmcnt(9)
	v_mfma_f32_32x32x16_bf16 v[112:127], a[48:51], v[72:75], v[112:127]
	ds_read_b64_tr_b16 v[88:89], v21 offset:14336
	ds_read_b64_tr_b16 v[90:91], v21 offset:14848
	v_add_f32 v227, v227, v235
	v_mfma_f32_32x32x16_bf16 v[128:143], a[48:51], v[76:79], v[128:143]
	ds_read_b64_tr_b16 v[92:93], v21 offset:43008
	ds_read_b64_tr_b16 v[94:95], v21 offset:43520
	s_lshl_b32 s48, s64, 12
	s_add_u32 s48, s48, 143360
	buffer_load_dwordx4 a[88:91], v4, s[28:31], s45 offen offset:2048 sc1
	s_waitcnt lgkmcnt(4) vmcnt(9)
	v_mfma_f32_32x32x16_bf16 v[112:127], a[52:55], v[80:83], v[112:127]
	ds_read_b64_tr_b16 v[72:73], v21 offset:15360
	ds_read_b64_tr_b16 v[74:75], v21 offset:15872
	v_add_u32 v100, s48, v2
	v_mfma_f32_32x32x16_bf16 v[128:143], a[52:55], v[84:87], v[128:143]
	ds_read_b64_tr_b16 v[76:77], v21 offset:44032
	ds_read_b64_tr_b16 v[78:79], v21 offset:44544
	ds_write_b128 v9, v[224:227]
	ds_read_b32 v228, v100 offset:0
	buffer_load_dwordx4 a[92:95], v4, s[28:31], s45 offen offset:3072 sc1
	s_waitcnt lgkmcnt(6) vmcnt(9)
	v_mfma_f32_32x32x16_bf16 v[112:127], a[56:59], v[88:91], v[112:127]
	ds_read_b64_tr_b16 v[80:81], v21 offset:16384
	ds_read_b64_tr_b16 v[82:83], v21 offset:16896
	ds_read_b32 v229, v100 offset:256
	v_mfma_f32_32x32x16_bf16 v[128:143], a[56:59], v[92:95], v[128:143]
	ds_read_b64_tr_b16 v[84:85], v21 offset:45056
	ds_read_b64_tr_b16 v[86:87], v21 offset:45568
	ds_read_b32 v230, v100 offset:512
	ds_read_b32 v231, v100 offset:768
	buffer_load_dwordx4 a[96:99], v4, s[28:31], s46 offen offset:0 sc1
	s_waitcnt lgkmcnt(9) vmcnt(9)
	v_mfma_f32_32x32x16_bf16 v[112:127], a[60:63], v[72:75], v[112:127]
	ds_read_b64_tr_b16 v[88:89], v21 offset:17408
	ds_read_b64_tr_b16 v[90:91], v21 offset:17920
	s_waitcnt lgkmcnt(6)
	v_add_f32 v228, v228, v229
	v_mfma_f32_32x32x16_bf16 v[128:143], a[60:63], v[76:79], v[128:143]
	ds_read_b64_tr_b16 v[92:93], v21 offset:46080
	ds_read_b64_tr_b16 v[94:95], v21 offset:46592
	s_waitcnt lgkmcnt(4)
	v_add_f32 v230, v230, v231
	v_add_f32 v224, v228, v230
	buffer_load_dwordx4 a[100:103], v4, s[28:31], s46 offen offset:1024 sc1
	s_waitcnt vmcnt(9)
	v_mfma_f32_32x32x16_bf16 v[112:127], a[64:67], v[80:83], v[112:127]
	ds_read_b64_tr_b16 v[72:73], v21 offset:18432
	ds_read_b64_tr_b16 v[74:75], v21 offset:18944
	v_mov_b32 v225, v224
	v_mfma_f32_32x32x16_bf16 v[128:143], a[64:67], v[84:87], v[128:143]
	ds_read_b64_tr_b16 v[76:77], v21 offset:47104
	ds_read_b64_tr_b16 v[78:79], v21 offset:47616
	v_permlane32_swap_b32 v224, v225
	v_mul_f32 v96, 0x3b124925, v224
	buffer_load_dwordx4 a[104:107], v4, s[28:31], s46 offen offset:2048 sc1
	s_waitcnt lgkmcnt(4) vmcnt(9)
	v_mfma_f32_32x32x16_bf16 v[112:127], a[68:71], v[88:91], v[112:127]
	ds_read_b64_tr_b16 v[80:81], v21 offset:19456
	ds_read_b64_tr_b16 v[82:83], v21 offset:19968
	v_mul_f32 v97, 0x3b124925, v225
	v_mfma_f32_32x32x16_bf16 v[128:143], a[68:71], v[92:95], v[128:143]
	ds_read_b64_tr_b16 v[84:85], v21 offset:48128
	ds_read_b64_tr_b16 v[86:87], v21 offset:48640
	v_cvt_pk_bf16_f32 v68, -v96, -v96
	v_fma_f32 v97, -v96, v96, v97
	buffer_load_dwordx4 a[108:111], v4, s[28:31], s46 offen offset:3072 sc1
	s_waitcnt lgkmcnt(4) vmcnt(9)
	v_mfma_f32_32x32x16_bf16 v[112:127], a[72:75], v[72:75], v[112:127]
	ds_read_b64_tr_b16 v[88:89], v21 offset:20480
	ds_read_b64_tr_b16 v[90:91], v21 offset:20992
	v_and_b32 v98, s94, v68
	v_mfma_f32_32x32x16_bf16 v[128:143], a[72:75], v[76:79], v[128:143]
	ds_read_b64_tr_b16 v[92:93], v21 offset:49152
	ds_read_b64_tr_b16 v[94:95], v21 offset:49664
	v_max_f32 v97, 0, v97
	v_sub_f32 v98, -v96, v98
	s_add_u32 m0, s90, 86016
	s_mov_b32 s54, 128
	buffer_load_dwordx4 v7, s[16:19], s54 offen lds
	s_waitcnt lgkmcnt(4) vmcnt(9)
	v_mfma_f32_32x32x16_bf16 v[112:127], a[76:79], v[80:83], v[112:127]
	ds_read_b64_tr_b16 v[72:73], v21 offset:21504
	ds_read_b64_tr_b16 v[74:75], v21 offset:22016
	v_add_f32 v99, 0x3727c5ac, v97
	v_mfma_f32_32x32x16_bf16 v[128:143], a[76:79], v[84:87], v[128:143]
	ds_read_b64_tr_b16 v[76:77], v21 offset:50176
	ds_read_b64_tr_b16 v[78:79], v21 offset:50688
	v_mov_b32 v71, 0
	v_rsq_f32 v12, v99
	s_add_u32 m0, s90, 90112
	s_mov_b32 s54, 114816
	buffer_load_dwordx4 v7, s[16:19], s54 offen lds
	s_waitcnt lgkmcnt(4) vmcnt(9)
	v_mfma_f32_32x32x16_bf16 v[112:127], a[80:83], v[88:91], v[112:127]
	ds_read_b64_tr_b16 v[80:81], v21 offset:22528
	ds_read_b64_tr_b16 v[82:83], v21 offset:23040
	v_cvt_pk_bf16_f32 v69, v98, 0
	v_mfma_f32_32x32x16_bf16 v[128:143], a[80:83], v[92:95], v[128:143]
	ds_read_b64_tr_b16 v[84:85], v21 offset:51200
	ds_read_b64_tr_b16 v[86:87], v21 offset:51712
	v_mov_b32 v70, 0
	s_lshr_b32 s48, s90, 3
	s_add_u32 m0, s90, 94208
	s_mov_b32 s54, 229504
	buffer_load_dwordx4 v7, s[16:19], s54 offen lds
	s_waitcnt lgkmcnt(4) vmcnt(9)
	v_mfma_f32_32x32x16_bf16 v[112:127], a[84:87], v[72:75], v[112:127]
	ds_read_b64_tr_b16 v[88:89], v21 offset:23552
	ds_read_b64_tr_b16 v[90:91], v21 offset:24064
	s_add_u32 s48, s48, 161792
	v_mfma_f32_32x32x16_bf16 v[128:143], a[84:87], v[76:79], v[128:143]
	ds_read_b64_tr_b16 v[92:93], v21 offset:52224
	ds_read_b64_tr_b16 v[94:95], v21 offset:52736
	v_and_b32 v100, 0x7c, v2
	v_add_u32 v100, s48, v100
	s_add_u32 m0, s90, 98304
	s_mov_b32 s54, 344192
	buffer_load_dwordx4 v7, s[16:19], s54 offen lds
	s_waitcnt lgkmcnt(4) vmcnt(9)
	v_mfma_f32_32x32x16_bf16 v[112:127], a[88:91], v[80:83], v[112:127]
	ds_read_b64_tr_b16 v[72:73], v21 offset:24576
	ds_read_b64_tr_b16 v[74:75], v21 offset:25088
	ds_write_b32 v100, v12
	v_mfma_f32_32x32x16_bf16 v[128:143], a[88:91], v[84:87], v[128:143]
	ds_read_b64_tr_b16 v[76:77], v21 offset:53248
	ds_read_b64_tr_b16 v[78:79], v21 offset:53760
	v_lshrrev_b32 v101, 5, v1
	v_lshlrev_b32 v101, 4, v101
	s_add_u32 m0, s90, 102400
	s_mov_b32 s54, 458880
	buffer_load_dwordx4 v7, s[16:19], s54 offen lds
	s_waitcnt lgkmcnt(5) vmcnt(9)
	v_mfma_f32_32x32x16_bf16 v[112:127], a[92:95], v[88:91], v[112:127]
	ds_read_b64_tr_b16 v[80:81], v21 offset:25600
	ds_read_b64_tr_b16 v[82:83], v21 offset:26112
	v_add_u32 v101, s48, v101
	v_mfma_f32_32x32x16_bf16 v[128:143], a[92:95], v[92:95], v[128:143]
	ds_read_b64_tr_b16 v[84:85], v21 offset:54272
	ds_read_b64_tr_b16 v[86:87], v21 offset:54784
	ds_read_b128 v[176:179], v101 offset:0
	ds_read_b128 v[180:183], v101 offset:32
	s_add_u32 m0, s90, 106496
	s_mov_b32 s54, 573568
	buffer_load_dwordx4 v7, s[16:19], s54 offen lds
	s_waitcnt lgkmcnt(6) vmcnt(9)
	v_mfma_f32_32x32x16_bf16 v[112:127], a[96:99], v[72:75], v[112:127]
	ds_read_b64_tr_b16 v[88:89], v21 offset:26624
	ds_read_b64_tr_b16 v[90:91], v21 offset:27136
	ds_read_b128 v[184:187], v101 offset:64
	v_mfma_f32_32x32x16_bf16 v[128:143], a[96:99], v[76:79], v[128:143]
	ds_read_b64_tr_b16 v[92:93], v21 offset:55296
	ds_read_b64_tr_b16 v[94:95], v21 offset:55808
	ds_read_b128 v[188:191], v101 offset:96
	s_add_u32 m0, s90, 110592
	s_mov_b32 s54, 688256
	buffer_load_dwordx4 v7, s[16:19], s54 offen lds
	s_waitcnt lgkmcnt(8) vmcnt(9)
	v_mfma_f32_32x32x16_bf16 v[112:127], a[100:103], v[80:83], v[112:127]
	ds_read_b64_tr_b16 v[72:73], v21 offset:27648
	ds_read_b64_tr_b16 v[74:75], v21 offset:28160
	v_mfma_f32_32x32x16_bf16 v[128:143], a[100:103], v[84:87], v[128:143]
	ds_read_b64_tr_b16 v[76:77], v21 offset:56320
	ds_read_b64_tr_b16 v[78:79], v21 offset:56832
	s_add_u32 m0, s90, 114688
	s_mov_b32 s54, 802944
	buffer_load_dwordx4 v7, s[16:19], s54 offen lds
	s_waitcnt lgkmcnt(5) vmcnt(9)
	v_mfma_f32_32x32x16_bf16 v[112:127], a[104:107], v[88:91], v[112:127]
	v_mfma_f32_32x32x16_bf16 v[128:143], a[104:107], v[92:95], v[128:143]
	s_add_u32 m0, s90, 118784
	s_mov_b32 s54, 917632
	buffer_load_dwordx4 v7, s[16:19], s54 offen lds
	s_waitcnt lgkmcnt(0) vmcnt(9)
	v_mfma_f32_32x32x16_bf16 v[112:127], a[108:111], v[72:75], v[112:127]
	v_mfma_f32_32x32x16_bf16 v[128:143], a[108:111], v[76:79], v[128:143]
	v_mfma_f32_32x32x16_bf16 v[112:127], v[68:71], v[40:43], v[112:127]
	v_mfma_f32_32x32x16_bf16 v[128:143], v[68:71], v[44:47], v[128:143]
	s_mov_b32 exec_lo, 65535
	s_mov_b32 exec_hi, 0xfffc
	buffer_load_dword v17, v16, s[28:31], s68 offen
	s_mov_b64 exec, -1
	v_mov_b32 v96, 0x3f803f80
	s_lshl_b32 s52, s63, 9
	s_add_u32 s52, s52, s69
	s_nop 3
	v_pk_fma_f32 v[112:113], v[112:113], v[176:177], s[92:93] op_sel_hi:[1,1,0]
	v_pk_fma_f32 v[114:115], v[114:115], v[178:179], s[92:93] op_sel_hi:[1,1,0]
	v_pk_fma_f32 v[116:117], v[116:117], v[180:181], s[92:93] op_sel_hi:[1,1,0]
	v_pk_fma_f32 v[118:119], v[118:119], v[182:183], s[92:93] op_sel_hi:[1,1,0]
	v_pk_mul_f32 v[104:105], v[112:113], s[92:93] op_sel:[0,1] op_sel_hi:[1,1]
	v_pk_mul_f32 v[106:107], v[114:115], s[92:93] op_sel:[0,1] op_sel_hi:[1,1]
	v_pk_mul_f32 v[108:109], v[116:117], s[92:93] op_sel:[0,1] op_sel_hi:[1,1]
	v_pk_mul_f32 v[110:111], v[118:119], s[92:93] op_sel:[0,1] op_sel_hi:[1,1]
	v_exp_f32 v104, v104 clamp
	v_exp_f32 v105, v105 clamp
	v_exp_f32 v106, v106 clamp
	v_exp_f32 v107, v107 clamp
	v_exp_f32 v108, v108 clamp
	v_exp_f32 v109, v109 clamp
	v_exp_f32 v110, v110 clamp
	v_exp_f32 v111, v111 clamp
	v_max_f32 v112, s92, v112
	v_max_f32 v113, s92, v113
	v_max_f32 v114, s92, v114
	v_max_f32 v115, s92, v115
	v_max_f32 v116, s92, v116
	v_max_f32 v117, s92, v117
	v_max_f32 v118, s92, v118
	v_max_f32 v119, s92, v119
	v_pk_add_f32 v[112:113], v[112:113], v[104:105]
	v_pk_add_f32 v[114:115], v[114:115], v[106:107]
	v_pk_add_f32 v[116:117], v[116:117], v[108:109]
	v_pk_add_f32 v[118:119], v[118:119], v[110:111]
	v_cvt_pk_bf16_f32 v224, v112, v113
	v_cvt_pk_bf16_f32 v225, v114, v115
	v_cvt_pk_bf16_f32 v226, v116, v117
	v_cvt_pk_bf16_f32 v227, v118, v119
	v_pk_fma_f32 v[120:121], v[120:121], v[184:185], s[92:93] op_sel_hi:[1,1,0]
	v_pk_fma_f32 v[122:123], v[122:123], v[186:187], s[92:93] op_sel_hi:[1,1,0]
	v_pk_fma_f32 v[124:125], v[124:125], v[188:189], s[92:93] op_sel_hi:[1,1,0]
	v_pk_fma_f32 v[126:127], v[126:127], v[190:191], s[92:93] op_sel_hi:[1,1,0]
	v_pk_mul_f32 v[104:105], v[120:121], s[92:93] op_sel:[0,1] op_sel_hi:[1,1]
	v_pk_mul_f32 v[106:107], v[122:123], s[92:93] op_sel:[0,1] op_sel_hi:[1,1]
	v_pk_mul_f32 v[108:109], v[124:125], s[92:93] op_sel:[0,1] op_sel_hi:[1,1]
	v_pk_mul_f32 v[110:111], v[126:127], s[92:93] op_sel:[0,1] op_sel_hi:[1,1]
	v_exp_f32 v104, v104 clamp
	v_exp_f32 v105, v105 clamp
	v_exp_f32 v106, v106 clamp
	v_exp_f32 v107, v107 clamp
	v_exp_f32 v108, v108 clamp
	v_exp_f32 v109, v109 clamp
	v_exp_f32 v110, v110 clamp
	v_exp_f32 v111, v111 clamp
	v_max_f32 v120, s92, v120
	v_max_f32 v121, s92, v121
	v_max_f32 v122, s92, v122
	v_max_f32 v123, s92, v123
	v_max_f32 v124, s92, v124
	v_max_f32 v125, s92, v125
	v_max_f32 v126, s92, v126
	v_max_f32 v127, s92, v127
	v_pk_add_f32 v[120:121], v[120:121], v[104:105]
	v_pk_add_f32 v[122:123], v[122:123], v[106:107]
	v_pk_add_f32 v[124:125], v[124:125], v[108:109]
	v_pk_add_f32 v[126:127], v[126:127], v[110:111]
	v_cvt_pk_bf16_f32 v228, v120, v121
	v_cvt_pk_bf16_f32 v229, v122, v123
	v_cvt_pk_bf16_f32 v230, v124, v125
	v_cvt_pk_bf16_f32 v231, v126, v127
	v_pk_mul_f32 v[128:129], v[128:129], v[176:177]
	v_pk_mul_f32 v[130:131], v[130:131], v[178:179]
	v_pk_mul_f32 v[132:133], v[132:133], v[180:181]
	v_pk_mul_f32 v[134:135], v[134:135], v[182:183]
	v_pk_mul_f32 v[136:137], v[136:137], v[184:185]
	v_pk_mul_f32 v[138:139], v[138:139], v[186:187]
	v_pk_mul_f32 v[140:141], v[140:141], v[188:189]
	v_pk_mul_f32 v[142:143], v[142:143], v[190:191]
	v_cvt_pk_bf16_f32 v232, v128, v129
	v_cvt_pk_bf16_f32 v233, v130, v131
	v_cvt_pk_bf16_f32 v234, v132, v133
	v_cvt_pk_bf16_f32 v235, v134, v135
	v_cvt_pk_bf16_f32 v236, v136, v137
	v_cvt_pk_bf16_f32 v237, v138, v139
	v_cvt_pk_bf16_f32 v238, v140, v141
	v_cvt_pk_bf16_f32 v239, v142, v143
	v_cndmask_b32 v224, v224, 0, s[86:87]
	v_cndmask_b32 v225, v225, 0, s[86:87]
	v_cndmask_b32 v226, v226, 0, s[86:87]
	v_cndmask_b32 v227, v227, 0, s[86:87]
	v_cndmask_b32 v228, v228, 0, s[86:87]
	v_cndmask_b32 v229, v229, 0, s[86:87]
	v_cndmask_b32 v230, v230, 0, s[86:87]
	v_cndmask_b32 v231, v231, 0, s[86:87]
	v_cndmask_b32 v232, v232, v96, s[86:87]
	v_cndmask_b32 v233, v233, v96, s[86:87]
	v_cndmask_b32 v234, v234, v96, s[86:87]
	v_cndmask_b32 v235, v235, v96, s[86:87]
	v_cndmask_b32 v236, v236, v96, s[86:87]
	v_cndmask_b32 v237, v237, v96, s[86:87]
	v_cndmask_b32 v238, v238, v96, s[86:87]
	v_cndmask_b32 v239, v239, v96, s[86:87]
	v_mfma_f32_32x32x16_bf16 v[160:175], v[224:227], v[232:235], 0
	s_nop 0
	v_mfma_f32_32x32x16_bf16 v[160:175], v[228:231], v[236:239], v[160:175]
	s_nop 11
	ds_write_b128 v9, v[160:163] offset:0
	ds_write_b128 v9, v[164:167] offset:1024
	ds_write_b128 v9, v[168:171] offset:2048
	ds_write_b128 v9, v[172:175] offset:3072
	s_waitcnt lgkmcnt(0)
	s_barrier
	ds_read_b128 v[112:115], v10 offset:0
	ds_read_b128 v[116:119], v10 offset:4096
	ds_read_b128 v[120:123], v10 offset:8192
	ds_read_b128 v[124:127], v10 offset:12288
	ds_read_b64_tr_b16 v[72:73], v21 offset:57344
	ds_read_b64_tr_b16 v[74:75], v21 offset:57856
	ds_read_b64_tr_b16 v[76:77], v21 offset:58368
	ds_read_b64_tr_b16 v[78:79], v21 offset:58880
	ds_read_b64_tr_b16 v[80:81], v21 offset:59392
	ds_read_b64_tr_b16 v[82:83], v21 offset:59904
	ds_read_b64_tr_b16 v[84:85], v21 offset:60416
	ds_read_b64_tr_b16 v[86:87], v21 offset:60928
	s_waitcnt lgkmcnt(10)
	v_pk_add_f32 v[112:113], v[112:113], v[116:117]
	v_pk_add_f32 v[114:115], v[114:115], v[118:119]
	s_waitcnt lgkmcnt(8)
	v_pk_add_f32 v[120:121], v[120:121], v[124:125]
	v_pk_add_f32 v[122:123], v[122:123], v[126:127]
	v_pk_add_f32 v[112:113], v[112:113], v[120:121]
	v_pk_add_f32 v[114:115], v[114:115], v[122:123]
	v_cvt_pk_bf16_f32 v96, v112, v113
	v_cvt_pk_bf16_f32 v97, v114, v115
	buffer_store_dwordx2 v[96:97], v3, s[28:31], s52 offen sc1
	s_waitcnt lgkmcnt(4)
	v_mfma_f32_32x32x16_bf16 v[144:159], v[72:75], a[0:3], 0
	ds_read_b64_tr_b16 v[88:89], v21 offset:61440
	ds_read_b64_tr_b16 v[90:91], v21 offset:61952
	v_and_b32 v180, 31, v1
	v_mov_b32 v181, 0x3f80
	s_add_u32 m0, s90, 122880
	s_mov_b32 s54, 1032320
	buffer_load_dwordx4 v7, s[16:19], s54 offen lds
	v_mfma_f32_32x32x16_bf16 v[144:159], v[76:79], a[4:7], v[144:159]
	ds_read_b64_tr_b16 v[92:93], v21 offset:62464
	ds_read_b64_tr_b16 v[94:95], v21 offset:62976
	v_subrev_u32 v182, 0, v180
	v_cmp_gt_u32 vcc, 2, v182
	s_waitcnt lgkmcnt(4)
	v_mfma_f32_32x32x16_bf16 v[144:159], v[80:83], a[8:11], v[144:159]
	ds_read_b64_tr_b16 v[72:73], v21 offset:63488
	ds_read_b64_tr_b16 v[74:75], v21 offset:64000
	v_lshlrev_b32 v183, 4, v182
	v_lshlrev_b32 v183, v183, v181
	v_mfma_f32_32x32x16_bf16 v[144:159], v[84:87], a[12:15], v[144:159]
	ds_read_b64_tr_b16 v[76:77], v21 offset:64512
	ds_read_b64_tr_b16 v[78:79], v21 offset:65024
	v_cndmask_b32 v176, 0, v183, vcc
	v_subrev_u32 v182, 2, v180
	s_add_u32 m0, s90, 126976
	s_mov_b32 s54, 1147008
	buffer_load_dwordx4 v7, s[16:19], s54 offen lds
	s_waitcnt lgkmcnt(4)
	v_mfma_f32_32x32x16_bf16 v[144:159], v[88:91], a[16:19], v[144:159]
	ds_read_b64_tr_b16 v[80:81], v22 offset:0
	ds_read_b64_tr_b16 v[82:83], v22 offset:512
	v_cmp_gt_u32 vcc, 2, v182
	v_lshlrev_b32 v183, 4, v182
	v_mfma_f32_32x32x16_bf16 v[144:159], v[92:95], a[20:23], v[144:159]
	ds_read_b64_tr_b16 v[84:85], v22 offset:1024
	ds_read_b64_tr_b16 v[86:87], v22 offset:1536
	v_lshlrev_b32 v183, v183, v181
	v_cndmask_b32 v177, 0, v183, vcc
	s_add_u32 m0, s90, 131072
	s_mov_b32 s54, 1261696
	buffer_load_dwordx4 v7, s[16:19], s54 offen lds
	s_waitcnt lgkmcnt(4)
	v_mfma_f32_32x32x16_bf16 v[144:159], v[72:75], a[24:27], v[144:159]
	ds_read_b64_tr_b16 v[88:89], v22 offset:2048
	ds_read_b64_tr_b16 v[90:91], v22 offset:2560
	v_subrev_u32 v182, 4, v180
	v_cmp_gt_u32 vcc, 2, v182
	v_mfma_f32_32x32x16_bf16 v[144:159], v[76:79], a[28:31], v[144:159]
	ds_read_b64_tr_b16 v[92:93], v22 offset:3072
	ds_read_b64_tr_b16 v[94:95], v22 offset:3584
	v_lshlrev_b32 v183, 4, v182
	v_lshlrev_b32 v183, v183, v181
	s_add_u32 m0, s90, 135168
	s_mov_b32 s54, 1376384
	buffer_load_dwordx4 v7, s[16:19], s54 offen lds
	s_waitcnt lgkmcnt(4)
	v_mfma_f32_32x32x16_bf16 v[144:159], v[80:83], a[32:35], v[144:159]
	ds_read_b64_tr_b16 v[72:73], v22 offset:4096
	ds_read_b64_tr_b16 v[74:75], v22 offset:4608
	v_cndmask_b32 v178, 0, v183, vcc
	v_subrev_u32 v182, 6, v180
	v_mfma_f32_32x32x16_bf16 v[144:159], v[84:87], a[36:39], v[144:159]
	ds_read_b64_tr_b16 v[76:77], v22 offset:5120
	ds_read_b64_tr_b16 v[78:79], v22 offset:5632
	v_cmp_gt_u32 vcc, 2, v182
	v_lshlrev_b32 v183, 4, v182
	s_add_u32 m0, s90, 139264
	s_mov_b32 s54, 1491072
	buffer_load_dwordx4 v7, s[16:19], s54 offen lds
	s_waitcnt lgkmcnt(4)
	v_mfma_f32_32x32x16_bf16 v[144:159], v[88:91], a[40:43], v[144:159]
	ds_read_b64_tr_b16 v[80:81], v22 offset:6144
	ds_read_b64_tr_b16 v[82:83], v22 offset:6656
	v_lshlrev_b32 v183, v183, v181
	v_cndmask_b32 v179, 0, v183, vcc
	v_mfma_f32_32x32x16_bf16 v[144:159], v[92:95], a[44:47], v[144:159]
	ds_read_b64_tr_b16 v[84:85], v22 offset:7168
	ds_read_b64_tr_b16 v[86:87], v22 offset:7680
	s_waitcnt lgkmcnt(4)
	v_mfma_f32_32x32x16_bf16 v[144:159], v[72:75], a[48:51], v[144:159]
	ds_read_b64_tr_b16 v[88:89], v22 offset:8192
	ds_read_b64_tr_b16 v[90:91], v22 offset:8704
	s_add_u32 m0, s90, 0
	s_mov_b32 s54, 0
	buffer_load_dwordx4 v7, s[16:19], s54 offen lds
	v_mfma_f32_32x32x16_bf16 v[144:159], v[76:79], a[52:55], v[144:159]
	ds_read_b64_tr_b16 v[92:93], v22 offset:9216
	ds_read_b64_tr_b16 v[94:95], v22 offset:9728
	s_waitcnt lgkmcnt(4)
	v_mfma_f32_32x32x16_bf16 v[144:159], v[80:83], a[56:59], v[144:159]
	ds_read_b64_tr_b16 v[72:73], v22 offset:10240
	ds_read_b64_tr_b16 v[74:75], v22 offset:10752
	s_add_u32 m0, s90, 4096
	s_mov_b32 s54, 114688
	buffer_load_dwordx4 v7, s[16:19], s54 offen lds
	v_mfma_f32_32x32x16_bf16 v[144:159], v[84:87], a[60:63], v[144:159]
	ds_read_b64_tr_b16 v[76:77], v22 offset:11264
	ds_read_b64_tr_b16 v[78:79], v22 offset:11776
	s_waitcnt lgkmcnt(4)
	v_mfma_f32_32x32x16_bf16 v[144:159], v[88:91], a[64:67], v[144:159]
	ds_read_b64_tr_b16 v[80:81], v22 offset:12288
	ds_read_b64_tr_b16 v[82:83], v22 offset:12800
	s_add_u32 m0, s90, 8192
	s_mov_b32 s54, 229376
	buffer_load_dwordx4 v7, s[16:19], s54 offen lds
	v_mfma_f32_32x32x16_bf16 v[144:159], v[92:95], a[68:71], v[144:159]
	ds_read_b64_tr_b16 v[84:85], v22 offset:13312
	ds_read_b64_tr_b16 v[86:87], v22 offset:13824
	s_waitcnt lgkmcnt(4)
	v_mfma_f32_32x32x16_bf16 v[144:159], v[72:75], a[72:75], v[144:159]
	ds_read_b64_tr_b16 v[88:89], v22 offset:14336
	ds_read_b64_tr_b16 v[90:91], v22 offset:14848
	s_add_u32 m0, s90, 12288
	s_mov_b32 s54, 344064
	buffer_load_dwordx4 v7, s[16:19], s54 offen lds
	v_mfma_f32_32x32x16_bf16 v[144:159], v[76:79], a[76:79], v[144:159]
	ds_read_b64_tr_b16 v[92:93], v22 offset:15360
	ds_read_b64_tr_b16 v[94:95], v22 offset:15872
	s_waitcnt lgkmcnt(4)
	v_mfma_f32_32x32x16_bf16 v[144:159], v[80:83], a[80:83], v[144:159]
	ds_read_b64_tr_b16 v[72:73], v22 offset:16384
	ds_read_b64_tr_b16 v[74:75], v22 offset:16896
	v_mfma_f32_32x32x16_bf16 v[144:159], v[84:87], a[84:87], v[144:159]
	ds_read_b64_tr_b16 v[76:77], v22 offset:17408
	ds_read_b64_tr_b16 v[78:79], v22 offset:17920
	s_add_u32 m0, s90, 16384
	s_mov_b32 s54, 458752
	buffer_load_dwordx4 v7, s[16:19], s54 offen lds
	s_waitcnt lgkmcnt(4)
	v_mfma_f32_32x32x16_bf16 v[144:159], v[88:91], a[88:91], v[144:159]
	ds_read_b64_tr_b16 v[80:81], v22 offset:18432
	ds_read_b64_tr_b16 v[82:83], v22 offset:18944
	v_mfma_f32_32x32x16_bf16 v[144:159], v[92:95], a[92:95], v[144:159]
	ds_read_b64_tr_b16 v[84:85], v22 offset:19456
	ds_read_b64_tr_b16 v[86:87], v22 offset:19968
	s_add_u32 m0, s90, 20480
	s_mov_b32 s54, 573440
	buffer_load_dwordx4 v7, s[16:19], s54 offen lds
	s_waitcnt lgkmcnt(4)
	v_mfma_f32_32x32x16_bf16 v[144:159], v[72:75], a[96:99], v[144:159]
	v_mfma_f32_32x32x16_bf16 v[144:159], v[76:79], a[100:103], v[144:159]
	s_add_u32 m0, s90, 24576
	s_mov_b32 s54, 688128
	buffer_load_dwordx4 v7, s[16:19], s54 offen lds
	s_waitcnt lgkmcnt(0)
	v_mfma_f32_32x32x16_bf16 v[144:159], v[80:83], a[104:107], v[144:159]
	v_mfma_f32_32x32x16_bf16 v[144:159], v[84:87], a[108:111], v[144:159]
	s_add_u32 s48, s69, 4096
	buffer_load_dwordx4 v[192:195], v4, s[28:31], s69 offen offset:0 sc1
	buffer_load_dwordx4 v[196:199], v4, s[28:31], s69 offen offset:1024 sc1
	buffer_load_dwordx4 v[200:203], v4, s[28:31], s69 offen offset:2048 sc1
	buffer_load_dwordx4 v[204:207], v4, s[28:31], s69 offen offset:3072 sc1
	buffer_load_dwordx4 v[208:211], v4, s[28:31], s48 offen offset:0 sc1
	buffer_load_dwordx4 v[212:215], v4, s[28:31], s48 offen offset:1024 sc1
	buffer_load_dwordx4 v[216:219], v4, s[28:31], s48 offen offset:2048 sc1
	buffer_load_dwordx4 v[220:223], v4, s[28:31], s48 offen offset:3072 sc1
	s_barrier
	v_add_u32 v244, s90, v4
	v_add_u32 v244, 57344, v244
	v_mfma_f32_32x32x16_bf16 v[144:159], v[48:51], v[68:71], v[144:159]
	s_lshr_b32 s48, s64, 1
	s_lshl_b32 s48, s48, 10
	s_and_b32 s49, s64, 1
	s_lshl_b32 s49, s49, 3
	s_add_u32 s48, s48, s49
	s_add_u32 s48, s48, 159744
	v_and_b32 v242, 31, v1
	v_lshrrev_b32 v243, 5, v1
	v_lshlrev_b32 v242, 5, v242
	v_lshl_add_u32 v242, v243, 4, v242
	v_add_u32 v242, s48, v242
	v_add_u32 v243, 159744, v4
	s_lshl_b32 s49, s63, 7
	s_add_u32 s49, s49, s70
	s_lshl_b32 s50, s62, 11
	s_add_u32 s50, s50, s68
	ds_write_b128 v244, a[212:215] offset:0
	s_add_u32 m0, s90, 28672
	s_mov_b32 s54, 802816
	buffer_load_dwordx4 v7, s[16:19], s54 offen lds
	v_pk_fma_f32 v[144:145], v[144:145], v[12:13], s[92:93] op_sel_hi:[1,0,0]
	v_pk_fma_f32 v[146:147], v[146:147], v[12:13], s[92:93] op_sel_hi:[1,0,0]
	v_pk_fma_f32 v[148:149], v[148:149], v[12:13], s[92:93] op_sel_hi:[1,0,0]
	v_pk_fma_f32 v[150:151], v[150:151], v[12:13], s[92:93] op_sel_hi:[1,0,0]
	v_pk_mul_f32 v[104:105], v[144:145], s[92:93] op_sel:[0,1] op_sel_hi:[1,1]
	v_pk_mul_f32 v[106:107], v[146:147], s[92:93] op_sel:[0,1] op_sel_hi:[1,1]
	v_pk_mul_f32 v[108:109], v[148:149], s[92:93] op_sel:[0,1] op_sel_hi:[1,1]
	v_pk_mul_f32 v[110:111], v[150:151], s[92:93] op_sel:[0,1] op_sel_hi:[1,1]
	v_exp_f32 v104, v104 clamp
	ds_write_b128 v244, a[216:219] offset:4096
	s_add_u32 m0, s90, 32768
	s_mov_b32 s54, 917504
	buffer_load_dwordx4 v7, s[16:19], s54 offen lds
	v_exp_f32 v105, v105 clamp
	v_exp_f32 v106, v106 clamp
	v_exp_f32 v107, v107 clamp
	v_exp_f32 v108, v108 clamp
	v_exp_f32 v109, v109 clamp
	v_exp_f32 v110, v110 clamp
	v_exp_f32 v111, v111 clamp
	v_max_f32 v144, s92, v144
	v_max_f32 v145, s92, v145
	ds_write_b128 v244, a[220:223] offset:8192
	s_add_u32 m0, s90, 36864
	s_mov_b32 s54, 1032192
	buffer_load_dwordx4 v7, s[16:19], s54 offen lds
	v_max_f32 v146, s92, v146
	v_max_f32 v147, s92, v147
	v_max_f32 v148, s92, v148
	v_max_f32 v149, s92, v149
	v_max_f32 v150, s92, v150
	v_max_f32 v151, s92, v151
	v_pk_add_f32 v[144:145], v[144:145], v[104:105]
	v_pk_add_f32 v[146:147], v[146:147], v[106:107]
	v_pk_add_f32 v[148:149], v[148:149], v[108:109]
	ds_write_b128 v244, a[224:227] offset:12288
	s_add_u32 m0, s90, 40960
	s_mov_b32 s54, 1146880
	buffer_load_dwordx4 v7, s[16:19], s54 offen lds
	v_pk_add_f32 v[150:151], v[150:151], v[110:111]
	v_cvt_pk_bf16_f32 v248, v144, v145
	v_cvt_pk_bf16_f32 v249, v146, v147
	v_cvt_pk_bf16_f32 v250, v148, v149
	v_cvt_pk_bf16_f32 v251, v150, v151
	v_pk_fma_f32 v[152:153], v[152:153], v[12:13], s[92:93] op_sel_hi:[1,0,0]
	v_pk_fma_f32 v[154:155], v[154:155], v[12:13], s[92:93] op_sel_hi:[1,0,0]
	v_pk_fma_f32 v[156:157], v[156:157], v[12:13], s[92:93] op_sel_hi:[1,0,0]
	v_pk_fma_f32 v[158:159], v[158:159], v[12:13], s[92:93] op_sel_hi:[1,0,0]
	ds_write_b128 v244, a[228:231] offset:16384
	s_add_u32 m0, s90, 45056
	s_mov_b32 s54, 1261568
	buffer_load_dwordx4 v7, s[16:19], s54 offen lds
	v_pk_mul_f32 v[104:105], v[152:153], s[92:93] op_sel:[0,1] op_sel_hi:[1,1]
	v_pk_mul_f32 v[106:107], v[154:155], s[92:93] op_sel:[0,1] op_sel_hi:[1,1]
	v_pk_mul_f32 v[108:109], v[156:157], s[92:93] op_sel:[0,1] op_sel_hi:[1,1]
	v_pk_mul_f32 v[110:111], v[158:159], s[92:93] op_sel:[0,1] op_sel_hi:[1,1]
	v_exp_f32 v104, v104 clamp
	v_exp_f32 v105, v105 clamp
	v_exp_f32 v106, v106 clamp
	v_exp_f32 v107, v107 clamp
	v_exp_f32 v108, v108 clamp
	ds_write_b128 v244, a[232:235] offset:20480
	s_add_u32 m0, s90, 49152
	s_mov_b32 s54, 1376256
	buffer_load_dwordx4 v7, s[16:19], s54 offen lds
	v_exp_f32 v109, v109 clamp
	v_exp_f32 v110, v110 clamp
	v_exp_f32 v111, v111 clamp
	v_max_f32 v152, s92, v152
	v_max_f32 v153, s92, v153
	v_max_f32 v154, s92, v154
	v_max_f32 v155, s92, v155
	v_max_f32 v156, s92, v156
	v_max_f32 v157, s92, v157
	ds_write_b128 v244, a[236:239] offset:24576
	s_add_u32 m0, s90, 53248
	s_mov_b32 s54, 1490944
	buffer_load_dwordx4 v7, s[16:19], s54 offen lds
	v_max_f32 v158, s92, v158
	v_max_f32 v159, s92, v159
	v_pk_add_f32 v[152:153], v[152:153], v[104:105]
	v_pk_add_f32 v[154:155], v[154:155], v[106:107]
	v_pk_add_f32 v[156:157], v[156:157], v[108:109]
	v_pk_add_f32 v[158:159], v[158:159], v[110:111]
	v_cvt_pk_bf16_f32 v252, v152, v153
	v_cvt_pk_bf16_f32 v253, v154, v155
	v_cvt_pk_bf16_f32 v254, v156, v157
	v_cvt_pk_bf16_f32 v255, v158, v159
	s_waitcnt vmcnt(14)
	v_mfma_f32_32x32x16_bf16 v[112:127], v[176:179], v[192:195], 0
	s_waitcnt vmcnt(13)
	v_mfma_f32_32x32x16_bf16 v[112:127], v[176:179], v[196:199], v[112:127]
	s_waitcnt vmcnt(12)
	v_mfma_f32_32x32x16_bf16 v[112:127], v[176:179], v[200:203], v[112:127]
	s_waitcnt vmcnt(11)
	v_mfma_f32_32x32x16_bf16 v[112:127], v[176:179], v[204:207], v[112:127]
	s_waitcnt vmcnt(10)
	v_mfma_f32_32x32x16_bf16 v[112:127], v[176:179], v[208:211], v[112:127]
	s_waitcnt vmcnt(9)
	v_mfma_f32_32x32x16_bf16 v[112:127], v[176:179], v[212:215], v[112:127]
	s_waitcnt vmcnt(8)
	v_mfma_f32_32x32x16_bf16 v[112:127], v[176:179], v[216:219], v[112:127]
	s_waitcnt vmcnt(7)
	v_mfma_f32_32x32x16_bf16 v[112:127], v[176:179], v[220:223], v[112:127]
	s_nop 11
	v_cmp_u_f32 vcc, v112, v112
	s_nop 0
	s_cbranch_vccnz Lkvretry_39
Lkvok_40:
	s_nop 9
	v_cvt_pk_bf16_f32 v96, v112, v113
	v_cvt_pk_bf16_f32 v97, v114, v115
	ds_write_b64 v242, v[96:97]
	s_waitcnt lgkmcnt(0)
	s_barrier
	ds_read_b128 v[72:75], v243
	ds_read_b128 v[76:79], v243 offset:1024
	s_waitcnt lgkmcnt(1)
	v_mfma_f32_32x32x16_bf16 v[128:143], v[72:75], v[248:251], 0
	s_waitcnt lgkmcnt(0)
	v_mfma_f32_32x32x16_bf16 v[128:143], v[76:79], v[252:255], v[128:143]
	s_mov_b32 s40, s68
	s_add_u32 s41, s68, 4096
	s_add_u32 s42, s68, 8192
	s_add_u32 s43, s68, 12288
	s_add_u32 s44, s68, 16384
	s_add_u32 s45, s68, 20480
	s_add_u32 s46, s68, 24576
	s_add_u32 s47, s68, 28672
	s_nop 3
	v_add_f32 v96, s92, v140
	v_mov_b32 v97, v96
	s_nop 1
	v_permlane32_swap_b32 v96, v97
	v_rcp_f32 v97, v97
	s_nop 0
	v_cndmask_b32 v96, v97, 0, s[84:85]
	v_pk_mul_f32 v[128:129], v[128:129], v[96:97] op_sel:[0,1] op_sel_hi:[1,1]
	v_pk_mul_f32 v[130:131], v[130:131], v[96:97] op_sel:[0,1] op_sel_hi:[1,1]
	v_pk_mul_f32 v[132:133], v[132:133], v[96:97] op_sel:[0,1] op_sel_hi:[1,1]
	v_pk_mul_f32 v[134:135], v[134:135], v[96:97] op_sel:[0,1] op_sel_hi:[1,1]
	v_cvt_pk_bf16_f32 v224, v128, v129
	v_cvt_pk_bf16_f32 v225, v130, v131
	v_cvt_pk_bf16_f32 v226, v132, v133
	v_cvt_pk_bf16_f32 v227, v134, v135
	buffer_store_dwordx4 v[224:227], v4, s[28:31], s50 offen offset:0
	v_pk_mul_f32 v[136:137], v[136:137], v[96:97] op_sel:[0,1] op_sel_hi:[1,1]
	v_pk_mul_f32 v[138:139], v[138:139], v[96:97] op_sel:[0,1] op_sel_hi:[1,1]
	v_pk_mul_f32 v[140:141], v[140:141], v[96:97] op_sel_hi:[1,0]
	v_pk_mul_f32 v[142:143], v[142:143], v[96:97] op_sel_hi:[1,0]
	v_cvt_pk_bf16_f32 v228, v136, v137
	v_cvt_pk_bf16_f32 v229, v138, v139
	v_cvt_pk_bf16_f32 v230, v140, v141
	v_cvt_pk_bf16_f32 v231, v142, v143
	buffer_store_dwordx4 v[228:231], v4, s[28:31], s50 offen offset:1024
	s_waitcnt vmcnt(0)
	s_mov_b64 exec, 1
	buffer_store_dword v11, off, s[28:31], s74 offset:0
	s_mov_b64 exec, -1
	s_cmp_ge_u32 s62, 14
	s_cbranch_scc1 L_idle_fast1
Lpoll_44:
	buffer_load_dword v14, v5, s[28:31], s73 offen offset:0 sc1
	s_waitcnt vmcnt(0)
	v_cmp_ne_u32 vcc, s65, v14
	s_nop 0
	s_cbranch_vccz Lpdone_45
	s_sub_u32 s67, s67, 1
	s_cbranch_scc0 Lpoll_44
	s_mov_b32 s67, 0
Lpdone_45:
	buffer_load_dwordx4 a[0:3], v4, s[28:31], s40 offen offset:0 sc1
	buffer_load_dwordx4 a[4:7], v4, s[28:31], s40 offen offset:1024 sc1
	buffer_load_dwordx4 a[8:11], v4, s[28:31], s40 offen offset:2048 sc1
	buffer_load_dwordx4 a[12:15], v4, s[28:31], s40 offen offset:3072 sc1
	buffer_load_dwordx4 a[16:19], v4, s[28:31], s41 offen offset:0 sc1
	buffer_load_dwordx4 a[20:23], v4, s[28:31], s41 offen offset:1024 sc1
	buffer_load_dwordx4 a[24:27], v4, s[28:31], s41 offen offset:2048 sc1
	buffer_load_dwordx4 a[28:31], v4, s[28:31], s41 offen offset:3072 sc1
	buffer_load_dwordx4 a[32:35], v4, s[28:31], s42 offen offset:0 sc1
	buffer_load_dwordx4 a[36:39], v4, s[28:31], s42 offen offset:1024 sc1
	ds_read_b64_tr_b16 v[72:73], v21 offset:57344
	ds_read_b64_tr_b16 v[74:75], v21 offset:57856
	ds_read_b64_tr_b16 v[76:77], v21 offset:58368
	ds_read_b64_tr_b16 v[78:79], v21 offset:58880
	ds_read_b64_tr_b16 v[80:81], v21 offset:59136
	ds_read_b64_tr_b16 v[82:83], v21 offset:59648
	ds_read_b64_tr_b16 v[84:85], v21 offset:60160
	ds_read_b64_tr_b16 v[86:87], v21 offset:60672
	buffer_load_dwordx4 a[40:43], v4, s[28:31], s42 offen offset:2048 sc1
	s_waitcnt lgkmcnt(4) vmcnt(10)
	v_mfma_f32_32x32x16_bf16 v[24:39], v[72:75], a[0:3], v[24:39]
	ds_read_b64_tr_b16 v[88:89], v21 offset:60928
	ds_read_b64_tr_b16 v[90:91], v21 offset:61440
	buffer_load_dwordx4 a[44:47], v4, s[28:31], s42 offen offset:3072 sc1
	s_waitcnt vmcnt(10)
	v_mfma_f32_32x32x16_bf16 v[24:39], v[76:79], a[4:7], v[24:39]
	ds_read_b64_tr_b16 v[92:93], v21 offset:61952
	ds_read_b64_tr_b16 v[94:95], v21 offset:62464
	buffer_load_dwordx4 a[48:51], v4, s[28:31], s43 offen offset:0 sc1
	s_waitcnt lgkmcnt(4) vmcnt(10)
	v_mfma_f32_32x32x16_bf16 v[24:39], v[80:83], a[8:11], v[24:39]
	ds_read_b64_tr_b16 v[72:73], v21 offset:62720
	ds_read_b64_tr_b16 v[74:75], v21 offset:63232
	buffer_load_dwordx4 a[52:55], v4, s[28:31], s43 offen offset:1024 sc1
	s_waitcnt vmcnt(10)
	v_mfma_f32_32x32x16_bf16 v[24:39], v[84:87], a[12:15], v[24:39]
	ds_read_b64_tr_b16 v[76:77], v21 offset:63744
	ds_read_b64_tr_b16 v[78:79], v21 offset:64256
	buffer_load_dwordx4 a[56:59], v4, s[28:31], s43 offen offset:2048 sc1
	s_waitcnt lgkmcnt(4) vmcnt(10)
	v_mfma_f32_32x32x16_bf16 v[24:39], v[88:91], a[16:19], v[24:39]
	ds_read_b64_tr_b16 v[80:81], v21 offset:64512
	ds_read_b64_tr_b16 v[82:83], v21 offset:65024
	buffer_load_dwordx4 a[60:63], v4, s[28:31], s43 offen offset:3072 sc1
	s_waitcnt vmcnt(10)
	v_mfma_f32_32x32x16_bf16 v[24:39], v[92:95], a[20:23], v[24:39]
	ds_read_b64_tr_b16 v[84:85], v22 offset:0
	ds_read_b64_tr_b16 v[86:87], v22 offset:512
	buffer_load_dwordx4 a[64:67], v4, s[28:31], s44 offen offset:0 sc1
	s_waitcnt lgkmcnt(4) vmcnt(10)
	v_mfma_f32_32x32x16_bf16 v[24:39], v[72:75], a[24:27], v[24:39]
	ds_read_b64_tr_b16 v[88:89], v22 offset:768
	ds_read_b64_tr_b16 v[90:91], v22 offset:1280
	buffer_load_dwordx4 a[68:71], v4, s[28:31], s44 offen offset:1024 sc1
	s_waitcnt vmcnt(10)
	v_mfma_f32_32x32x16_bf16 v[24:39], v[76:79], a[28:31], v[24:39]
	ds_read_b64_tr_b16 v[92:93], v22 offset:1792
	ds_read_b64_tr_b16 v[94:95], v22 offset:2304
	buffer_load_dwordx4 a[72:75], v4, s[28:31], s44 offen offset:2048 sc1
	s_waitcnt lgkmcnt(4) vmcnt(10)
	v_mfma_f32_32x32x16_bf16 v[24:39], v[80:83], a[32:35], v[24:39]
	ds_read_b64_tr_b16 v[72:73], v22 offset:2560
	ds_read_b64_tr_b16 v[74:75], v22 offset:3072
	buffer_load_dwordx4 a[76:79], v4, s[28:31], s44 offen offset:3072 sc1
	s_waitcnt vmcnt(10)
	v_mfma_f32_32x32x16_bf16 v[24:39], v[84:87], a[36:39], v[24:39]
	ds_read_b64_tr_b16 v[76:77], v22 offset:3584
	ds_read_b64_tr_b16 v[78:79], v22 offset:4096
	buffer_load_dwordx4 a[80:83], v4, s[28:31], s45 offen offset:0 sc1
	s_waitcnt lgkmcnt(4) vmcnt(10)
	v_mfma_f32_32x32x16_bf16 v[24:39], v[88:91], a[40:43], v[24:39]
	ds_read_b64_tr_b16 v[80:81], v22 offset:4352
	ds_read_b64_tr_b16 v[82:83], v22 offset:4864
	buffer_load_dwordx4 a[84:87], v4, s[28:31], s45 offen offset:1024 sc1
	s_waitcnt vmcnt(10)
	v_mfma_f32_32x32x16_bf16 v[24:39], v[92:95], a[44:47], v[24:39]
	ds_read_b64_tr_b16 v[84:85], v22 offset:5376
	ds_read_b64_tr_b16 v[86:87], v22 offset:5888
	buffer_load_dwordx4 a[88:91], v4, s[28:31], s45 offen offset:2048 sc1
	s_waitcnt lgkmcnt(4) vmcnt(10)
	v_mfma_f32_32x32x16_bf16 v[24:39], v[72:75], a[48:51], v[24:39]
	ds_read_b64_tr_b16 v[88:89], v22 offset:6144
	ds_read_b64_tr_b16 v[90:91], v22 offset:6656
	buffer_load_dwordx4 a[92:95], v4, s[28:31], s45 offen offset:3072 sc1
	s_waitcnt vmcnt(10)
	v_mfma_f32_32x32x16_bf16 v[24:39], v[76:79], a[52:55], v[24:39]
	ds_read_b64_tr_b16 v[92:93], v22 offset:7168
	ds_read_b64_tr_b16 v[94:95], v22 offset:7680
	buffer_load_dwordx4 a[96:99], v4, s[28:31], s46 offen offset:0 sc1
	s_waitcnt lgkmcnt(4) vmcnt(10)
	v_mfma_f32_32x32x16_bf16 v[24:39], v[80:83], a[56:59], v[24:39]
	ds_read_b64_tr_b16 v[72:73], v22 offset:7936
	ds_read_b64_tr_b16 v[74:75], v22 offset:8448
	buffer_load_dwordx4 a[100:103], v4, s[28:31], s46 offen offset:1024 sc1
	s_waitcnt vmcnt(10)
	v_mfma_f32_32x32x16_bf16 v[24:39], v[84:87], a[60:63], v[24:39]
	ds_read_b64_tr_b16 v[76:77], v22 offset:8960
	ds_read_b64_tr_b16 v[78:79], v22 offset:9472
	buffer_load_dwordx4 a[104:107], v4, s[28:31], s46 offen offset:2048 sc1
	s_waitcnt lgkmcnt(4) vmcnt(10)
	v_mfma_f32_32x32x16_bf16 v[24:39], v[88:91], a[64:67], v[24:39]
	ds_read_b64_tr_b16 v[80:81], v22 offset:9728
	ds_read_b64_tr_b16 v[82:83], v22 offset:10240
	buffer_load_dwordx4 a[108:111], v4, s[28:31], s46 offen offset:3072 sc1
	s_waitcnt vmcnt(10)
	v_mfma_f32_32x32x16_bf16 v[24:39], v[92:95], a[68:71], v[24:39]
	ds_read_b64_tr_b16 v[84:85], v22 offset:10752
	ds_read_b64_tr_b16 v[86:87], v22 offset:11264
	buffer_load_dwordx4 a[112:115], v4, s[28:31], s47 offen offset:0 sc1
	s_waitcnt lgkmcnt(4) vmcnt(10)
	v_mfma_f32_32x32x16_bf16 v[24:39], v[72:75], a[72:75], v[24:39]
	ds_read_b64_tr_b16 v[88:89], v22 offset:11520
	ds_read_b64_tr_b16 v[90:91], v22 offset:12032
	buffer_load_dwordx4 a[116:119], v4, s[28:31], s47 offen offset:1024 sc1
	s_waitcnt vmcnt(10)
	v_mfma_f32_32x32x16_bf16 v[24:39], v[76:79], a[76:79], v[24:39]
	ds_read_b64_tr_b16 v[92:93], v22 offset:12544
	ds_read_b64_tr_b16 v[94:95], v22 offset:13056
	buffer_load_dwordx4 a[120:123], v4, s[28:31], s47 offen offset:2048 sc1
	s_waitcnt lgkmcnt(4) vmcnt(10)
	v_mfma_f32_32x32x16_bf16 v[24:39], v[80:83], a[80:83], v[24:39]
	ds_read_b64_tr_b16 v[72:73], v22 offset:13312
	ds_read_b64_tr_b16 v[74:75], v22 offset:13824
	buffer_load_dwordx4 a[124:127], v4, s[28:31], s47 offen offset:3072 sc1
	s_waitcnt vmcnt(10)
	v_mfma_f32_32x32x16_bf16 v[24:39], v[84:87], a[84:87], v[24:39]
	ds_read_b64_tr_b16 v[76:77], v22 offset:14336
	ds_read_b64_tr_b16 v[78:79], v22 offset:14848
	s_waitcnt lgkmcnt(4) vmcnt(9)
	v_mfma_f32_32x32x16_bf16 v[24:39], v[88:91], a[88:91], v[24:39]
	ds_read_b64_tr_b16 v[80:81], v22 offset:15104
	ds_read_b64_tr_b16 v[82:83], v22 offset:15616
	s_waitcnt vmcnt(8)
	v_mfma_f32_32x32x16_bf16 v[24:39], v[92:95], a[92:95], v[24:39]
	ds_read_b64_tr_b16 v[84:85], v22 offset:16128
	ds_read_b64_tr_b16 v[86:87], v22 offset:16640
	s_waitcnt lgkmcnt(4) vmcnt(7)
	v_mfma_f32_32x32x16_bf16 v[24:39], v[72:75], a[96:99], v[24:39]
	ds_read_b64_tr_b16 v[88:89], v22 offset:16896
	ds_read_b64_tr_b16 v[90:91], v22 offset:17408
	s_waitcnt vmcnt(6)
	v_mfma_f32_32x32x16_bf16 v[24:39], v[76:79], a[100:103], v[24:39]
	ds_read_b64_tr_b16 v[92:93], v22 offset:17920
	ds_read_b64_tr_b16 v[94:95], v22 offset:18432
	s_waitcnt lgkmcnt(4) vmcnt(5)
	v_mfma_f32_32x32x16_bf16 v[24:39], v[80:83], a[104:107], v[24:39]
	ds_read_b64_tr_b16 v[72:73], v22 offset:18688
	ds_read_b64_tr_b16 v[74:75], v22 offset:19200
	s_waitcnt vmcnt(4)
	v_mfma_f32_32x32x16_bf16 v[24:39], v[84:87], a[108:111], v[24:39]
	ds_read_b64_tr_b16 v[76:77], v22 offset:19712
	ds_read_b64_tr_b16 v[78:79], v22 offset:20224
	s_waitcnt lgkmcnt(4) vmcnt(3)
	v_mfma_f32_32x32x16_bf16 v[24:39], v[88:91], a[112:115], v[24:39]
	s_waitcnt vmcnt(2)
	v_mfma_f32_32x32x16_bf16 v[24:39], v[92:95], a[116:119], v[24:39]
	s_waitcnt lgkmcnt(0) vmcnt(1)
	v_mfma_f32_32x32x16_bf16 v[24:39], v[72:75], a[120:123], v[24:39]
	s_waitcnt vmcnt(0)
	v_mfma_f32_32x32x16_bf16 v[24:39], v[76:79], a[124:127], v[24:39]
	s_lshl_b32 s53, s62, 11
	s_add_u32 s53, s53, s68
	s_add_u32 s53, s53, 32768
	s_lshl_b32 s49, s62, 8
	s_add_u32 s49, s49, s68
	s_add_u32 s49, s49, 61440
	s_add_u32 s48, s68, 32768
	s_add_u32 s40, s48, 0
	s_add_u32 s41, s48, 4096
	s_add_u32 s42, s48, 8192
	s_add_u32 s43, s48, 12288
	s_add_u32 s44, s48, 16384
	s_add_u32 s45, s48, 20480
	s_add_u32 s46, s48, 24576
	s_add_u32 s52, s68, 61440
	v_cvt_pk_bf16_f32 v224, v24, v25
	v_cvt_pk_bf16_f32 v225, v26, v27
	v_cvt_pk_bf16_f32 v226, v28, v29
	v_cvt_pk_bf16_f32 v227, v30, v31
	buffer_store_dwordx4 v[224:227], v4, s[28:31], s53 offen
	v_cvt_pk_bf16_f32 v228, v32, v33
	v_cvt_pk_bf16_f32 v229, v34, v35
	v_cvt_pk_bf16_f32 v230, v36, v37
	v_cvt_pk_bf16_f32 v231, v38, v39
	buffer_store_dwordx4 v[228:231], v4, s[28:31], s53 offen offset:1024
	v_pk_add_f32 v[96:97], v[24:25], v[26:27]
	v_pk_mul_f32 v[98:99], v[24:25], v[24:25]
	v_pk_fma_f32 v[98:99], v[26:27], v[26:27], v[98:99]
	v_pk_fma_f32 v[98:99], v[28:29], v[28:29], v[98:99]
	v_pk_add_f32 v[96:97], v[96:97], v[28:29]
	v_pk_fma_f32 v[98:99], v[30:31], v[30:31], v[98:99]
	v_pk_add_f32 v[96:97], v[96:97], v[30:31]
	v_pk_fma_f32 v[98:99], v[32:33], v[32:33], v[98:99]
	v_pk_add_f32 v[96:97], v[96:97], v[32:33]
	v_pk_fma_f32 v[98:99], v[34:35], v[34:35], v[98:99]
	v_pk_add_f32 v[96:97], v[96:97], v[34:35]
	v_pk_fma_f32 v[98:99], v[36:37], v[36:37], v[98:99]
	v_pk_add_f32 v[96:97], v[96:97], v[36:37]
	v_pk_fma_f32 v[98:99], v[38:39], v[38:39], v[98:99]
	v_pk_add_f32 v[96:97], v[96:97], v[38:39]
	v_add_f32 v96, v96, v97
	v_add_f32 v97, v98, v99
	s_nop 1
	v_permlane32_swap_b32 v96, v97
	v_add_f32 v96, v96, v97
	buffer_store_dword v96, v2, s[28:31], s49 offen
	s_lshr_b32 s50, s56, 3
	s_add_u32 s50, s50, s68
	s_add_u32 s50, s50, 65536
	s_add_u32 s51, s50, 4096
	s_waitcnt vmcnt(0)
	s_mov_b64 exec, 1
	buffer_store_dword v11, off, s[28:31], s74 offset:128
	s_mov_b64 exec, -1
	s_cmp_lg_u32 s2, 0
	s_cbranch_scc1 Lep_46
	s_mov_b64 exec, 1
	buffer_store_dword v11, off, s[28:31], 0 offset:0
	s_mov_b64 exec, -1
Lep_46:
	s_branch L_mlp_fast
L_tail_fast1:
	buffer_load_dwordx4 v[232:235], v4, s[28:31], s48 offen offset:0 sc1
	buffer_load_dwordx4 v[236:239], v4, s[28:31], s48 offen offset:1024 sc1
	v_and_b32 v98, 31, v1
	v_lshrrev_b32 v99, 5, v1
	v_mul_u32_u24 v98, 896, v98
	v_lshl_add_u32 v98, v99, 4, v98
	s_lshl_b32 s50, s62, 6
	s_add_u32 s50, s50, s96
	s_lshl_b32 s3, s64, 12
	s_add_u32 s3, s3, 143360
	s_add_u32 s51, s50, 14336
	v_and_b32 v100, 31, v1
	v_bfe_u32 v101, v1, 1, 2
	v_xor_b32 v101, v101, v99
	v_lshlrev_b32 v100, 6, v100
	v_lshl_add_u32 v100, v101, 4, v100
	v_add_u32 v100, s3, v100
	v_xor_b32 v101, 32, v100
	v_bfe_u32 v102, v1, 3, 2
	v_lshlrev_b32 v102, 4, v102
	v_xor_b32 v102, v102, v4
	v_add_u32 v102, s3, v102
	v_lshrrev_b32 v103, 2, v1
	v_mul_u32_u24 v103, 896, v103
	v_and_b32 v106, 48, v4
	v_add_u32 v103, v103, v106
	s_waitcnt vmcnt(1)
	v_max3_u32 v105, v232, v233, v234
	s_waitcnt vmcnt(0)
	v_max3_u32 v108, v235, v236, v237
	v_max3_u32 v105, v105, v238, v239
	v_max_u32 v105, v105, v108
	v_cmp_eq_u32 vcc, -1, v105
	s_mov_b64 exec, 1
	buffer_store_dword v11, off, s[28:31], s74 offset:512
	s_mov_b64 exec, -1
	s_cbranch_vccnz Lpslow_47
Lpok_48:
	v_mfma_f32_32x32x16_bf16 v[24:39], a[240:243], v[232:235], v[24:39]
	v_mfma_f32_32x32x16_bf16 v[24:39], a[244:247], v[236:239], v[24:39]
	s_nop 11
	v_cvt_pk_bf16_f32 v224, v24, v25
	v_cvt_pk_bf16_f32 v225, v26, v27
	v_cvt_pk_bf16_f32 v226, v28, v29
	v_cvt_pk_bf16_f32 v227, v30, v31
	v_cvt_pk_bf16_f32 v228, v32, v33
	v_cvt_pk_bf16_f32 v229, v34, v35
	v_cvt_pk_bf16_f32 v230, v36, v37
	v_cvt_pk_bf16_f32 v231, v38, v39
	v_permlane32_swap_b32 v224, v226
	v_permlane32_swap_b32 v225, v227
	ds_write_b128 v100, v[224:227]
	v_permlane32_swap_b32 v228, v230
	v_permlane32_swap_b32 v229, v231
	ds_write_b128 v101, v[228:231]
	ds_read_b128 v[232:235], v102
	ds_read_b128 v[236:239], v102 offset:1024
	s_waitcnt lgkmcnt(1)
	buffer_store_dwordx4 v[232:235], v103, s[24:27], s50 offen
	s_waitcnt lgkmcnt(0)
	buffer_store_dwordx4 v[236:239], v103, s[24:27], s51 offen
	s_branch L_done
L_idle_fast0:
	s_and_b32 s50, s63, 1
	s_lshl_b32 s50, s50, 1
	s_add_u32 s50, s50, s71
	s_lshl_b32 s50, s50, 2
	s_add_u32 s50, s50, s64
	v_lshlrev_b32 v98, 3, v4
	s_lshl_b32 s48, s71, 14
	s_add_u32 s48, s48, s68
	s_add_u32 s48, s48, 32768
	s_mov_b32 s49, 2
Lpf_50:
	buffer_load_dword v17, v98, s[28:31], s48 offen
	s_add_u32 s48, s48, 8192
	s_sub_u32 s49, s49, 1
	s_cmp_lg_u32 s49, 0
	s_cbranch_scc1 Lpf_50
	v_mov_b32 v102, v98
	v_and_b32 v102, 1920, v102
	v_add_u32 v102, 2048, v102
	s_mul_i32 s48, s71, 100352
	s_add_u32 s48, s48, s68
	s_add_u32 s48, s48, 65536
	s_mov_b32 s49, 7
Lpf_51:
	buffer_load_dword v17, v102, s[28:31], s48 offen
	s_add_u32 s48, s48, 14336
	s_sub_u32 s49, s49, 1
	s_cmp_lg_u32 s49, 0
	s_cbranch_scc1 Lpf_51
	v_and_b32 v99, 31, v1
	v_min_u32 v99, 27, v99
	v_lshlrev_b32 v99, 7, v99
	v_lshrrev_b32 v100, 5, v1
	v_mul_u32_u24 v100, 114688, v100
	v_add_u32 v99, v99, v100
	s_mul_i32 s48, s50, 3584
	s_add_u32 s48, s48, 57344
	s_mov_b32 s49, 7
Lpf_52:
	buffer_load_dword v17, v99, s[20:23], s48 offen
	s_add_u32 s48, s48, 229376
	s_sub_u32 s49, s49, 1
	s_cmp_lg_u32 s49, 0
	s_cbranch_scc1 Lpf_52
	s_waitcnt vmcnt(0)
	s_barrier
	v_add_u32 v106, s90, v4
	v_add_u32 v107, 57344, v106
	ds_write_b128 v106, a[128:131] offset:0
	ds_write_b128 v106, a[132:135] offset:4096
	ds_write_b128 v106, a[136:139] offset:8192
	ds_write_b128 v106, a[140:143] offset:12288
	ds_write_b128 v106, a[144:147] offset:16384
	ds_write_b128 v106, a[148:151] offset:20480
	ds_write_b128 v106, a[152:155] offset:24576
	ds_write_b128 v106, a[156:159] offset:28672
	ds_write_b128 v106, a[160:163] offset:32768
	ds_write_b128 v106, a[164:167] offset:36864
	ds_write_b128 v106, a[168:171] offset:40960
	ds_write_b128 v106, a[172:175] offset:45056
	ds_write_b128 v106, a[176:179] offset:49152
	ds_write_b128 v106, a[180:183] offset:53248
Lpoll_53:
	s_sleep 8
	buffer_load_dword v14, v6, s[28:31], s73 offen offset:256 sc1
	s_waitcnt vmcnt(0)
	v_cmp_ne_u32 vcc, s65, v14
	s_nop 0
	s_cbranch_vccz Lpdone_54
	s_sub_u32 s67, s67, 1
	s_cbranch_scc0 Lpoll_53
	s_mov_b32 s67, 0
Lpdone_54:
	s_mov_b32 s18, 1605632
	s_lshl_b32 s48, s50, 13
	s_mov_b32 s49, 7
Lpf_55:
	buffer_load_dword v17, v98, s[16:19], s48 offen
	s_add_u32 s48, s48, 131072
	buffer_load_dword v17, v98, s[16:19], s48 offen
	s_add_u32 s48, s48, 131072
	buffer_load_dword v14, v6, s[28:31], s73 offen offset:512 sc1
	s_waitcnt vmcnt(0)
	v_cmp_eq_u32 vcc, s65, v14
	s_nop 0
	s_cbranch_vccnz Lpfe_56
	s_sub_u32 s49, s49, 1
	s_cmp_lg_u32 s49, 0
	s_cbranch_scc1 Lpf_55
Lpfe_56:
	s_mov_b32 s18, 0
	s_waitcnt vmcnt(0)
Lpoll_57:
	s_sleep 2
	buffer_load_dword v14, v6, s[28:31], s73 offen offset:512 sc1
	s_waitcnt vmcnt(0)
	v_cmp_ne_u32 vcc, s65, v14
	s_nop 0
	s_cbranch_vccz Lpdone_58
	s_sub_u32 s67, s67, 1
	s_cbranch_scc0 Lpoll_57
	s_mov_b32 s67, 0
Lpdone_58:
	s_branch L_second_fast
L_idle_fast1:
	s_and_b32 s50, s63, 1
	s_lshl_b32 s50, s50, 1
	s_add_u32 s50, s50, s71
	s_lshl_b32 s50, s50, 2
	s_add_u32 s50, s50, s64
	v_lshlrev_b32 v98, 3, v4
	s_lshl_b32 s48, s71, 14
	s_add_u32 s48, s48, s68
	s_add_u32 s48, s48, 32768
	s_mov_b32 s49, 2
Lpf_59:
	buffer_load_dword v17, v98, s[28:31], s48 offen
	s_add_u32 s48, s48, 8192
	s_sub_u32 s49, s49, 1
	s_cmp_lg_u32 s49, 0
	s_cbranch_scc1 Lpf_59
	v_mov_b32 v102, v98
	v_and_b32 v102, 1920, v102
	v_add_u32 v102, 2048, v102
	s_mul_i32 s48, s71, 100352
	s_add_u32 s48, s48, s68
	s_add_u32 s48, s48, 65536
	s_mov_b32 s49, 7
Lpf_60:
	buffer_load_dword v17, v102, s[28:31], s48 offen
	s_add_u32 s48, s48, 14336
	s_sub_u32 s49, s49, 1
	s_cmp_lg_u32 s49, 0
	s_cbranch_scc1 Lpf_60
	v_and_b32 v99, 31, v1
	v_min_u32 v99, 27, v99
	v_lshlrev_b32 v99, 7, v99
	v_lshrrev_b32 v100, 5, v1
	v_mul_u32_u24 v100, 114688, v100
	v_add_u32 v99, v99, v100
	s_mul_i32 s48, s50, 3584
	s_add_u32 s48, s48, 57344
	s_mov_b32 s49, 7
Lpf_61:
	buffer_load_dword v17, v99, s[20:23], s48 offen
	s_add_u32 s48, s48, 229376
	s_sub_u32 s49, s49, 1
	s_cmp_lg_u32 s49, 0
	s_cbranch_scc1 Lpf_61
	s_branch L_done
Lkvretry_18:
	s_mov_b64 exec, 1
	buffer_store_dword v11, off, s[28:31], s49 offset:4 sc1
	s_mov_b64 exec, -1
Lkvretry_20:
	s_mov_b64 s[88:89], -1
	s_and_b32 s3, s67, 15
	s_cbranch_scc1 Lkvretry_21
	v_lshlrev_b32 v96, 5, v5
	buffer_load_dword v14, v96, s[28:31], s70 offen offset:4 sc1
	s_waitcnt vmcnt(0)
	v_cmp_ne_u32 s[88:89], s65, v14
Lkvretry_21:
	s_add_u32 s48, s69, 4096
	buffer_load_dwordx4 v[192:195], v4, s[28:31], s69 offen offset:0 sc1
	buffer_load_dwordx4 v[196:199], v4, s[28:31], s69 offen offset:1024 sc1
	buffer_load_dwordx4 v[200:203], v4, s[28:31], s69 offen offset:2048 sc1
	buffer_load_dwordx4 v[204:207], v4, s[28:31], s69 offen offset:3072 sc1
	buffer_load_dwordx4 v[208:211], v4, s[28:31], s48 offen offset:0 sc1
	buffer_load_dwordx4 v[212:215], v4, s[28:31], s48 offen offset:1024 sc1
	buffer_load_dwordx4 v[216:219], v4, s[28:31], s48 offen offset:2048 sc1
	buffer_load_dwordx4 v[220:223], v4, s[28:31], s48 offen offset:3072 sc1
	v_mov_b32 v96, 0
	s_waitcnt vmcnt(7)
	v_max3_u32 v96, v96, v192, v193
	v_max3_u32 v96, v96, v194, v195
	s_waitcnt vmcnt(6)
	v_max3_u32 v96, v96, v196, v197
	v_max3_u32 v96, v96, v198, v199
	s_waitcnt vmcnt(5)
	v_max3_u32 v96, v96, v200, v201
	v_max3_u32 v96, v96, v202, v203
	s_waitcnt vmcnt(4)
	v_max3_u32 v96, v96, v204, v205
	v_max3_u32 v96, v96, v206, v207
	s_waitcnt vmcnt(3)
	v_max3_u32 v96, v96, v208, v209
	v_max3_u32 v96, v96, v210, v211
	s_waitcnt vmcnt(2)
	v_max3_u32 v96, v96, v212, v213
	v_max3_u32 v96, v96, v214, v215
	s_waitcnt vmcnt(1)
	v_max3_u32 v96, v96, v216, v217
	v_max3_u32 v96, v96, v218, v219
	s_waitcnt vmcnt(0)
	v_max3_u32 v96, v96, v220, v221
	v_max3_u32 v96, v96, v222, v223
	v_cmp_eq_u32 vcc, -1, v96
	s_nop 0
	s_cbranch_vccz Lkvretry_22
	s_cmp_eq_u64 s[88:89], 0
	s_cbranch_scc1 Lkvretry_22
	s_sub_u32 s67, s67, 1
	s_cbranch_scc0 Lkvretry_20
	s_mov_b32 s67, 0
Lkvretry_22:
	v_mfma_f32_32x32x16_bf16 v[112:127], v[176:179], v[192:195], 0
	v_mfma_f32_32x32x16_bf16 v[112:127], v[176:179], v[196:199], v[112:127]
	v_mfma_f32_32x32x16_bf16 v[112:127], v[176:179], v[200:203], v[112:127]
	v_mfma_f32_32x32x16_bf16 v[112:127], v[176:179], v[204:207], v[112:127]
	v_mfma_f32_32x32x16_bf16 v[112:127], v[176:179], v[208:211], v[112:127]
	v_mfma_f32_32x32x16_bf16 v[112:127], v[176:179], v[212:215], v[112:127]
	v_mfma_f32_32x32x16_bf16 v[112:127], v[176:179], v[216:219], v[112:127]
	v_mfma_f32_32x32x16_bf16 v[112:127], v[176:179], v[220:223], v[112:127]
	s_nop 11
	v_cmp_u_f32 vcc, v112, v112
	s_branch Lkvok_19
Lh1slow_30:
Lpoll_32:
	buffer_load_dword v14, v15, s[28:31], s73 offen offset:384 sc1
	s_waitcnt vmcnt(0)
	v_cmp_ne_u32 vcc, s65, v14
	s_nop 0
	s_cbranch_vccz Lpdone_33
	s_sub_u32 s67, s67, 1
	s_cbranch_scc0 Lpoll_32
	s_mov_b32 s67, 0
Lpdone_33:
	s_branch Lh1ok_31
Lpslow_34:
	s_mov_b64 s[88:89], -1
Lpslow_36:
	buffer_load_dword v14, v104, s[28:31], s49 offen offset:512 sc1
	buffer_load_dwordx4 v[232:235], v4, s[28:31], s48 offen offset:0 sc1
	buffer_load_dwordx4 v[236:239], v4, s[28:31], s48 offen offset:1024 sc1
	s_waitcnt vmcnt(1)
	v_max3_u32 v105, v232, v233, v234
	s_waitcnt vmcnt(0)
	v_max3_u32 v108, v235, v236, v237
	v_max3_u32 v105, v105, v238, v239
	v_max_u32 v105, v105, v108
	v_cmp_eq_u32 vcc, -1, v105
	s_nop 0
	s_cbranch_vccz Lpok_35
	s_cmp_eq_u64 s[88:89], 0
	s_cbranch_scc1 Lpok_35
	v_cmp_ne_u32 s[88:89], s65, v14
	s_sub_u32 s67, s67, 1
	s_cbranch_scc0 Lpslow_36
	s_mov_b32 s67, 0
	s_branch Lpok_35
Lkvretry_39:
	s_mov_b64 exec, 1
	buffer_store_dword v11, off, s[28:31], s49 offset:8 sc1
	s_mov_b64 exec, -1
Lkvretry_41:
	s_mov_b64 s[88:89], -1
	s_and_b32 s3, s67, 15
	s_cbranch_scc1 Lkvretry_42
	v_lshlrev_b32 v96, 5, v5
	buffer_load_dword v14, v96, s[28:31], s70 offen offset:8 sc1
	s_waitcnt vmcnt(0)
	v_cmp_ne_u32 s[88:89], s65, v14
Lkvretry_42:
	s_add_u32 s48, s69, 4096
	buffer_load_dwordx4 v[192:195], v4, s[28:31], s69 offen offset:0 sc1
	buffer_load_dwordx4 v[196:199], v4, s[28:31], s69 offen offset:1024 sc1
	buffer_load_dwordx4 v[200:203], v4, s[28:31], s69 offen offset:2048 sc1
	buffer_load_dwordx4 v[204:207], v4, s[28:31], s69 offen offset:3072 sc1
	buffer_load_dwordx4 v[208:211], v4, s[28:31], s48 offen offset:0 sc1
	buffer_load_dwordx4 v[212:215], v4, s[28:31], s48 offen offset:1024 sc1
	buffer_load_dwordx4 v[216:219], v4, s[28:31], s48 offen offset:2048 sc1
	buffer_load_dwordx4 v[220:223], v4, s[28:31], s48 offen offset:3072 sc1
	v_mov_b32 v96, 0
	s_waitcnt vmcnt(7)
	v_max3_u32 v96, v96, v192, v193
	v_max3_u32 v96, v96, v194, v195
	s_waitcnt vmcnt(6)
	v_max3_u32 v96, v96, v196, v197
	v_max3_u32 v96, v96, v198, v199
	s_waitcnt vmcnt(5)
	v_max3_u32 v96, v96, v200, v201
	v_max3_u32 v96, v96, v202, v203
	s_waitcnt vmcnt(4)
	v_max3_u32 v96, v96, v204, v205
	v_max3_u32 v96, v96, v206, v207
	s_waitcnt vmcnt(3)
	v_max3_u32 v96, v96, v208, v209
	v_max3_u32 v96, v96, v210, v211
	s_waitcnt vmcnt(2)
	v_max3_u32 v96, v96, v212, v213
	v_max3_u32 v96, v96, v214, v215
	s_waitcnt vmcnt(1)
	v_max3_u32 v96, v96, v216, v217
	v_max3_u32 v96, v96, v218, v219
	s_waitcnt vmcnt(0)
	v_max3_u32 v96, v96, v220, v221
	v_max3_u32 v96, v96, v222, v223
	v_cmp_eq_u32 vcc, -1, v96
	s_nop 0
	s_cbranch_vccz Lkvretry_43
	s_cmp_eq_u64 s[88:89], 0
	s_cbranch_scc1 Lkvretry_43
	s_sub_u32 s67, s67, 1
	s_cbranch_scc0 Lkvretry_41
	s_mov_b32 s67, 0
Lkvretry_43:
	v_mfma_f32_32x32x16_bf16 v[112:127], v[176:179], v[192:195], 0
	v_mfma_f32_32x32x16_bf16 v[112:127], v[176:179], v[196:199], v[112:127]
	v_mfma_f32_32x32x16_bf16 v[112:127], v[176:179], v[200:203], v[112:127]
	v_mfma_f32_32x32x16_bf16 v[112:127], v[176:179], v[204:207], v[112:127]
	v_mfma_f32_32x32x16_bf16 v[112:127], v[176:179], v[208:211], v[112:127]
	v_mfma_f32_32x32x16_bf16 v[112:127], v[176:179], v[212:215], v[112:127]
	v_mfma_f32_32x32x16_bf16 v[112:127], v[176:179], v[216:219], v[112:127]
	v_mfma_f32_32x32x16_bf16 v[112:127], v[176:179], v[220:223], v[112:127]
	s_nop 11
	v_cmp_u_f32 vcc, v112, v112
	s_branch Lkvok_40
Lpslow_47:
	s_mov_b64 s[88:89], -1
Lpslow_49:
	buffer_load_dword v14, v104, s[28:31], s49 offen offset:512 sc1
	buffer_load_dwordx4 v[232:235], v4, s[28:31], s48 offen offset:0 sc1
	buffer_load_dwordx4 v[236:239], v4, s[28:31], s48 offen offset:1024 sc1
	s_waitcnt vmcnt(1)
	v_max3_u32 v105, v232, v233, v234
	s_waitcnt vmcnt(0)
	v_max3_u32 v108, v235, v236, v237
	v_max3_u32 v105, v105, v238, v239
	v_max_u32 v105, v105, v108
	v_cmp_eq_u32 vcc, -1, v105
	s_nop 0
	s_cbranch_vccz Lpok_48
	s_cmp_eq_u64 s[88:89], 0
	s_cbranch_scc1 Lpok_48
	v_cmp_ne_u32 s[88:89], s65, v14
	s_sub_u32 s67, s67, 1
	s_cbranch_scc0 Lpslow_49
	s_mov_b32 s67, 0
	s_branch Lpok_48
L_done:
L_end:
	s_endpgm
L_start_slow:
	s_mov_b32 exec_lo, 65535
	s_mov_b32 exec_hi, 0xfffc
	buffer_load_dword v17, v16, s[28:31], s68 offen
	s_mov_b64 exec, -1
	v_mov_b32 v96, 0x3f803f80
	s_lshl_b32 s52, s63, 9
	s_add_u32 s52, s52, s69
	v_pk_fma_f32 v[112:113], v[112:113], v[176:177], s[92:93] op_sel_hi:[1,1,0]
	v_pk_fma_f32 v[114:115], v[114:115], v[178:179], s[92:93] op_sel_hi:[1,1,0]
	v_pk_fma_f32 v[116:117], v[116:117], v[180:181], s[92:93] op_sel_hi:[1,1,0]
	v_pk_fma_f32 v[118:119], v[118:119], v[182:183], s[92:93] op_sel_hi:[1,1,0]
	v_pk_mul_f32 v[104:105], v[112:113], s[92:93] op_sel:[0,1] op_sel_hi:[1,1]
	v_pk_mul_f32 v[106:107], v[114:115], s[92:93] op_sel:[0,1] op_sel_hi:[1,1]
	v_pk_mul_f32 v[108:109], v[116:117], s[92:93] op_sel:[0,1] op_sel_hi:[1,1]
	v_pk_mul_f32 v[110:111], v[118:119], s[92:93] op_sel:[0,1] op_sel_hi:[1,1]
	v_exp_f32 v104, v104 clamp
	v_exp_f32 v105, v105 clamp
	v_exp_f32 v106, v106 clamp
	v_exp_f32 v107, v107 clamp
	v_exp_f32 v108, v108 clamp
	v_exp_f32 v109, v109 clamp
	v_exp_f32 v110, v110 clamp
	v_exp_f32 v111, v111 clamp
	v_max_f32 v112, s92, v112
	v_max_f32 v113, s92, v113
	v_max_f32 v114, s92, v114
	v_max_f32 v115, s92, v115
	v_max_f32 v116, s92, v116
	v_max_f32 v117, s92, v117
	v_max_f32 v118, s92, v118
	v_max_f32 v119, s92, v119
	v_pk_add_f32 v[112:113], v[112:113], v[104:105]
	v_pk_add_f32 v[114:115], v[114:115], v[106:107]
	v_pk_add_f32 v[116:117], v[116:117], v[108:109]
	v_pk_add_f32 v[118:119], v[118:119], v[110:111]
	v_cvt_pk_bf16_f32 v224, v112, v113
	v_cvt_pk_bf16_f32 v225, v114, v115
	v_cvt_pk_bf16_f32 v226, v116, v117
	v_cvt_pk_bf16_f32 v227, v118, v119
	v_pk_fma_f32 v[120:121], v[120:121], v[184:185], s[92:93] op_sel_hi:[1,1,0]
	v_pk_fma_f32 v[122:123], v[122:123], v[186:187], s[92:93] op_sel_hi:[1,1,0]
	v_pk_fma_f32 v[124:125], v[124:125], v[188:189], s[92:93] op_sel_hi:[1,1,0]
	v_pk_fma_f32 v[126:127], v[126:127], v[190:191], s[92:93] op_sel_hi:[1,1,0]
	v_pk_mul_f32 v[104:105], v[120:121], s[92:93] op_sel:[0,1] op_sel_hi:[1,1]
	v_pk_mul_f32 v[106:107], v[122:123], s[92:93] op_sel:[0,1] op_sel_hi:[1,1]
	v_pk_mul_f32 v[108:109], v[124:125], s[92:93] op_sel:[0,1] op_sel_hi:[1,1]
	v_pk_mul_f32 v[110:111], v[126:127], s[92:93] op_sel:[0,1] op_sel_hi:[1,1]
	v_exp_f32 v104, v104 clamp
	v_exp_f32 v105, v105 clamp
	v_exp_f32 v106, v106 clamp
	v_exp_f32 v107, v107 clamp
	v_exp_f32 v108, v108 clamp
	v_exp_f32 v109, v109 clamp
	v_exp_f32 v110, v110 clamp
	v_exp_f32 v111, v111 clamp
	v_max_f32 v120, s92, v120
	v_max_f32 v121, s92, v121
	v_max_f32 v122, s92, v122
	v_max_f32 v123, s92, v123
	v_max_f32 v124, s92, v124
	v_max_f32 v125, s92, v125
	v_max_f32 v126, s92, v126
	v_max_f32 v127, s92, v127
	v_pk_add_f32 v[120:121], v[120:121], v[104:105]
	v_pk_add_f32 v[122:123], v[122:123], v[106:107]
	v_pk_add_f32 v[124:125], v[124:125], v[108:109]
	v_pk_add_f32 v[126:127], v[126:127], v[110:111]
	v_cvt_pk_bf16_f32 v228, v120, v121
	v_cvt_pk_bf16_f32 v229, v122, v123
	v_cvt_pk_bf16_f32 v230, v124, v125
	v_cvt_pk_bf16_f32 v231, v126, v127
	v_pk_mul_f32 v[128:129], v[128:129], v[176:177]
	v_pk_mul_f32 v[130:131], v[130:131], v[178:179]
	v_pk_mul_f32 v[132:133], v[132:133], v[180:181]
	v_pk_mul_f32 v[134:135], v[134:135], v[182:183]
	v_pk_mul_f32 v[136:137], v[136:137], v[184:185]
	v_pk_mul_f32 v[138:139], v[138:139], v[186:187]
	v_pk_mul_f32 v[140:141], v[140:141], v[188:189]
	v_pk_mul_f32 v[142:143], v[142:143], v[190:191]
	v_cvt_pk_bf16_f32 v232, v128, v129
	v_cvt_pk_bf16_f32 v233, v130, v131
	v_cvt_pk_bf16_f32 v234, v132, v133
	v_cvt_pk_bf16_f32 v235, v134, v135
	v_cvt_pk_bf16_f32 v236, v136, v137
	v_cvt_pk_bf16_f32 v237, v138, v139
	v_cvt_pk_bf16_f32 v238, v140, v141
	v_cvt_pk_bf16_f32 v239, v142, v143
	v_cndmask_b32 v224, v224, 0, s[86:87]
	v_cndmask_b32 v225, v225, 0, s[86:87]
	v_cndmask_b32 v226, v226, 0, s[86:87]
	v_cndmask_b32 v227, v227, 0, s[86:87]
	v_cndmask_b32 v228, v228, 0, s[86:87]
	v_cndmask_b32 v229, v229, 0, s[86:87]
	v_cndmask_b32 v230, v230, 0, s[86:87]
	v_cndmask_b32 v231, v231, 0, s[86:87]
	v_cndmask_b32 v232, v232, v96, s[86:87]
	v_cndmask_b32 v233, v233, v96, s[86:87]
	v_cndmask_b32 v234, v234, v96, s[86:87]
	v_cndmask_b32 v235, v235, v96, s[86:87]
	v_cndmask_b32 v236, v236, v96, s[86:87]
	v_cndmask_b32 v237, v237, v96, s[86:87]
	v_cndmask_b32 v238, v238, v96, s[86:87]
	v_cndmask_b32 v239, v239, v96, s[86:87]
	v_mfma_f32_32x32x16_bf16 v[160:175], v[224:227], v[232:235], 0
	s_nop 0
	v_mfma_f32_32x32x16_bf16 v[160:175], v[228:231], v[236:239], v[160:175]
	s_nop 11
	ds_write_b128 v9, v[160:163] offset:0
	ds_write_b128 v9, v[164:167] offset:1024
	ds_write_b128 v9, v[168:171] offset:2048
	ds_write_b128 v9, v[172:175] offset:3072
	s_waitcnt lgkmcnt(0)
	s_barrier
	ds_read_b128 v[112:115], v10 offset:0
	ds_read_b128 v[116:119], v10 offset:4096
	ds_read_b128 v[120:123], v10 offset:8192
	ds_read_b128 v[124:127], v10 offset:12288
	s_waitcnt lgkmcnt(2)
	v_pk_add_f32 v[112:113], v[112:113], v[116:117]
	v_pk_add_f32 v[114:115], v[114:115], v[118:119]
	s_waitcnt lgkmcnt(0)
	v_pk_add_f32 v[120:121], v[120:121], v[124:125]
	v_pk_add_f32 v[122:123], v[122:123], v[126:127]
	v_pk_add_f32 v[112:113], v[112:113], v[120:121]
	v_pk_add_f32 v[114:115], v[114:115], v[122:123]
	v_cvt_pk_bf16_f32 v96, v112, v113
	v_cvt_pk_bf16_f32 v97, v114, v115
	buffer_store_dwordx2 v[96:97], v3, s[28:31], s52 offen sc1
	s_lshl_b32 s52, s62, 6
	v_lshrrev_b32 v240, 2, v1
	v_mul_u32_u24 v240, 896, v240
	v_and_b32 v101, 48, v4
	v_add_u32 v240, v240, v101
	s_mul_i32 s55, s64, 14336
	s_add_u32 s55, s55, s52
	v_mov_b32 v224, 0x3f803f80
	v_mov_b32 v225, 0x3f803f80
	v_mov_b32 v226, 0x3f803f80
	v_mov_b32 v227, 0x3f803f80
	s_waitcnt vmcnt(2)
	s_barrier
	ds_read_b64_tr_b16 v[72:73], v21 offset:57344
	ds_read_b64_tr_b16 v[74:75], v21 offset:57856
	ds_read_b64_tr_b16 v[76:77], v21 offset:58368
	ds_read_b64_tr_b16 v[78:79], v21 offset:58880
	ds_read_b64_tr_b16 v[80:81], v21 offset:59392
	ds_read_b64_tr_b16 v[82:83], v21 offset:59904
	ds_read_b64_tr_b16 v[84:85], v21 offset:60416
	ds_read_b64_tr_b16 v[86:87], v21 offset:60928
	v_and_b32 v246, 31, v1
	v_lshlrev_b32 v246, 1, v246
	v_lshrrev_b32 v247, 5, v1
	v_lshlrev_b32 v247, 3, v247
	s_lshl_b32 s3, s62, 6
	s_lshl_b32 s53, s62, 8
	buffer_load_dwordx2 a[248:249], v247, s[36:39], s3 offen offset:0
	buffer_load_dwordx2 a[250:251], v247, s[36:39], s3 offen offset:16
	buffer_load_dwordx2 a[252:253], v247, s[36:39], s3 offen offset:32
	buffer_load_dwordx2 a[254:255], v247, s[36:39], s3 offen offset:48
	buffer_load_ushort v55, v246, s[32:35], s53 offen offset:0
	buffer_load_ushort v59, v246, s[32:35], s53 offen offset:64
	buffer_load_ushort v63, v246, s[32:35], s53 offen offset:128
	buffer_load_ushort v67, v246, s[32:35], s53 offen offset:192
	s_waitcnt lgkmcnt(4)
	v_mfma_f32_32x32x16_bf16 v[144:159], v[72:75], a[0:3], 0
	ds_read_b64_tr_b16 v[88:89], v21 offset:61440
	ds_read_b64_tr_b16 v[90:91], v21 offset:61952
	v_and_b32 v180, 31, v1
	v_mov_b32 v181, 0x3f80
	s_add_u32 m0, s90, 86016
	s_mov_b32 s54, 128
	buffer_load_dwordx4 v7, s[16:19], s54 offen lds
	v_mfma_f32_32x32x16_bf16 v[144:159], v[76:79], a[4:7], v[144:159]
	ds_read_b64_tr_b16 v[92:93], v21 offset:62464
	ds_read_b64_tr_b16 v[94:95], v21 offset:62976
	v_subrev_u32 v182, 0, v180
	v_cmp_gt_u32 vcc, 2, v182
	s_waitcnt lgkmcnt(4)
	v_mfma_f32_32x32x16_bf16 v[144:159], v[80:83], a[8:11], v[144:159]
	ds_read_b64_tr_b16 v[72:73], v21 offset:63488
	ds_read_b64_tr_b16 v[74:75], v21 offset:64000
	v_lshlrev_b32 v183, 4, v182
	v_lshlrev_b32 v183, v183, v181
	s_add_u32 m0, s90, 90112
	s_mov_b32 s54, 114816
	buffer_load_dwordx4 v7, s[16:19], s54 offen lds
	v_mfma_f32_32x32x16_bf16 v[144:159], v[84:87], a[12:15], v[144:159]
	ds_read_b64_tr_b16 v[76:77], v21 offset:64512
	ds_read_b64_tr_b16 v[78:79], v21 offset:65024
	v_cndmask_b32 v176, 0, v183, vcc
	v_subrev_u32 v182, 2, v180
	s_waitcnt lgkmcnt(4)
	v_mfma_f32_32x32x16_bf16 v[144:159], v[88:91], a[16:19], v[144:159]
	ds_read_b64_tr_b16 v[80:81], v22 offset:0
	ds_read_b64_tr_b16 v[82:83], v22 offset:512
	v_cmp_gt_u32 vcc, 2, v182
	v_lshlrev_b32 v183, 4, v182
	s_add_u32 m0, s90, 94208
	s_mov_b32 s54, 229504
	buffer_load_dwordx4 v7, s[16:19], s54 offen lds
	v_mfma_f32_32x32x16_bf16 v[144:159], v[92:95], a[20:23], v[144:159]
	ds_read_b64_tr_b16 v[84:85], v22 offset:1024
	ds_read_b64_tr_b16 v[86:87], v22 offset:1536
	v_lshlrev_b32 v183, v183, v181
	v_cndmask_b32 v177, 0, v183, vcc
	s_waitcnt lgkmcnt(4)
	v_mfma_f32_32x32x16_bf16 v[144:159], v[72:75], a[24:27], v[144:159]
	ds_read_b64_tr_b16 v[88:89], v22 offset:2048
	ds_read_b64_tr_b16 v[90:91], v22 offset:2560
	v_subrev_u32 v182, 4, v180
	v_cmp_gt_u32 vcc, 2, v182
	s_add_u32 m0, s90, 98304
	s_mov_b32 s54, 344192
	buffer_load_dwordx4 v7, s[16:19], s54 offen lds
	v_mfma_f32_32x32x16_bf16 v[144:159], v[76:79], a[28:31], v[144:159]
	ds_read_b64_tr_b16 v[92:93], v22 offset:3072
	ds_read_b64_tr_b16 v[94:95], v22 offset:3584
	v_lshlrev_b32 v183, 4, v182
	v_lshlrev_b32 v183, v183, v181
	s_waitcnt lgkmcnt(4)
	v_mfma_f32_32x32x16_bf16 v[144:159], v[80:83], a[32:35], v[144:159]
	ds_read_b64_tr_b16 v[72:73], v22 offset:4096
	ds_read_b64_tr_b16 v[74:75], v22 offset:4608
	v_cndmask_b32 v178, 0, v183, vcc
	v_subrev_u32 v182, 6, v180
	s_add_u32 m0, s90, 102400
	s_mov_b32 s54, 458880
	buffer_load_dwordx4 v7, s[16:19], s54 offen lds
	v_mfma_f32_32x32x16_bf16 v[144:159], v[84:87], a[36:39], v[144:159]
	ds_read_b64_tr_b16 v[76:77], v22 offset:5120
	ds_read_b64_tr_b16 v[78:79], v22 offset:5632
	v_cmp_gt_u32 vcc, 2, v182
	v_lshlrev_b32 v183, 4, v182
	s_waitcnt lgkmcnt(4)
	v_mfma_f32_32x32x16_bf16 v[144:159], v[88:91], a[40:43], v[144:159]
	ds_read_b64_tr_b16 v[80:81], v22 offset:6144
	ds_read_b64_tr_b16 v[82:83], v22 offset:6656
	v_lshlrev_b32 v183, v183, v181
	v_cndmask_b32 v179, 0, v183, vcc
	s_add_u32 m0, s90, 106496
	s_mov_b32 s54, 573568
	buffer_load_dwordx4 v7, s[16:19], s54 offen lds
	v_mfma_f32_32x32x16_bf16 v[144:159], v[92:95], a[44:47], v[144:159]
	ds_read_b64_tr_b16 v[84:85], v22 offset:7168
	ds_read_b64_tr_b16 v[86:87], v22 offset:7680
	s_waitcnt lgkmcnt(4)
	v_mfma_f32_32x32x16_bf16 v[144:159], v[72:75], a[48:51], v[144:159]
	ds_read_b64_tr_b16 v[88:89], v22 offset:8192
	ds_read_b64_tr_b16 v[90:91], v22 offset:8704
	s_add_u32 m0, s90, 110592
	s_mov_b32 s54, 688256
	buffer_load_dwordx4 v7, s[16:19], s54 offen lds
	v_mfma_f32_32x32x16_bf16 v[144:159], v[76:79], a[52:55], v[144:159]
	ds_read_b64_tr_b16 v[92:93], v22 offset:9216
	ds_read_b64_tr_b16 v[94:95], v22 offset:9728
	s_waitcnt lgkmcnt(4)
	v_mfma_f32_32x32x16_bf16 v[144:159], v[80:83], a[56:59], v[144:159]
	ds_read_b64_tr_b16 v[72:73], v22 offset:10240
	ds_read_b64_tr_b16 v[74:75], v22 offset:10752
	s_add_u32 m0, s90, 114688
	s_mov_b32 s54, 802944
	buffer_load_dwordx4 v7, s[16:19], s54 offen lds
	v_mfma_f32_32x32x16_bf16 v[144:159], v[84:87], a[60:63], v[144:159]
	ds_read_b64_tr_b16 v[76:77], v22 offset:11264
	ds_read_b64_tr_b16 v[78:79], v22 offset:11776
	s_waitcnt lgkmcnt(4)
	v_mfma_f32_32x32x16_bf16 v[144:159], v[88:91], a[64:67], v[144:159]
	ds_read_b64_tr_b16 v[80:81], v22 offset:12288
	ds_read_b64_tr_b16 v[82:83], v22 offset:12800
	s_add_u32 m0, s90, 118784
	s_mov_b32 s54, 917632
	buffer_load_dwordx4 v7, s[16:19], s54 offen lds
	v_mfma_f32_32x32x16_bf16 v[144:159], v[92:95], a[68:71], v[144:159]
	ds_read_b64_tr_b16 v[84:85], v22 offset:13312
	ds_read_b64_tr_b16 v[86:87], v22 offset:13824
	s_waitcnt lgkmcnt(4)
	v_mfma_f32_32x32x16_bf16 v[144:159], v[72:75], a[72:75], v[144:159]
	ds_read_b64_tr_b16 v[88:89], v22 offset:14336
	ds_read_b64_tr_b16 v[90:91], v22 offset:14848
	s_add_u32 m0, s90, 122880
	s_mov_b32 s54, 1032320
	buffer_load_dwordx4 v7, s[16:19], s54 offen lds
	v_mfma_f32_32x32x16_bf16 v[144:159], v[76:79], a[76:79], v[144:159]
	ds_read_b64_tr_b16 v[92:93], v22 offset:15360
	ds_read_b64_tr_b16 v[94:95], v22 offset:15872
	s_waitcnt lgkmcnt(4)
	v_mfma_f32_32x32x16_bf16 v[144:159], v[80:83], a[80:83], v[144:159]
	ds_read_b64_tr_b16 v[72:73], v22 offset:16384
	ds_read_b64_tr_b16 v[74:75], v22 offset:16896
	s_add_u32 m0, s90, 126976
	s_mov_b32 s54, 1147008
	buffer_load_dwordx4 v7, s[16:19], s54 offen lds
	v_mfma_f32_32x32x16_bf16 v[144:159], v[84:87], a[84:87], v[144:159]
	ds_read_b64_tr_b16 v[76:77], v22 offset:17408
	ds_read_b64_tr_b16 v[78:79], v22 offset:17920
	s_waitcnt lgkmcnt(4)
	v_mfma_f32_32x32x16_bf16 v[144:159], v[88:91], a[88:91], v[144:159]
	ds_read_b64_tr_b16 v[80:81], v22 offset:18432
	ds_read_b64_tr_b16 v[82:83], v22 offset:18944
	s_add_u32 m0, s90, 131072
	s_mov_b32 s54, 1261696
	buffer_load_dwordx4 v7, s[16:19], s54 offen lds
	v_mfma_f32_32x32x16_bf16 v[144:159], v[92:95], a[92:95], v[144:159]
	ds_read_b64_tr_b16 v[84:85], v22 offset:19456
	ds_read_b64_tr_b16 v[86:87], v22 offset:19968
	s_waitcnt lgkmcnt(4)
	v_mfma_f32_32x32x16_bf16 v[144:159], v[72:75], a[96:99], v[144:159]
	s_add_u32 m0, s90, 135168
	s_mov_b32 s54, 1376384
	buffer_load_dwordx4 v7, s[16:19], s54 offen lds
	v_mfma_f32_32x32x16_bf16 v[144:159], v[76:79], a[100:103], v[144:159]
	s_waitcnt lgkmcnt(0)
	v_mfma_f32_32x32x16_bf16 v[144:159], v[80:83], a[104:107], v[144:159]
	s_add_u32 m0, s90, 139264
	s_mov_b32 s54, 1491072
	buffer_load_dwordx4 v7, s[16:19], s54 offen lds
	v_mfma_f32_32x32x16_bf16 v[144:159], v[84:87], a[108:111], v[144:159]
	s_add_u32 s48, s69, 4096
	buffer_load_dwordx4 v[192:195], v4, s[28:31], s69 offen offset:0 sc1
	buffer_load_dwordx4 v[196:199], v4, s[28:31], s69 offen offset:1024 sc1
	buffer_load_dwordx4 v[200:203], v4, s[28:31], s69 offen offset:2048 sc1
	buffer_load_dwordx4 v[204:207], v4, s[28:31], s69 offen offset:3072 sc1
	buffer_load_dwordx4 v[208:211], v4, s[28:31], s48 offen offset:0 sc1
	buffer_load_dwordx4 v[212:215], v4, s[28:31], s48 offen offset:1024 sc1
	buffer_load_dwordx4 v[216:219], v4, s[28:31], s48 offen offset:2048 sc1
	buffer_load_dwordx4 v[220:223], v4, s[28:31], s48 offen offset:3072 sc1
	s_mul_i32 s48, s64, 7168
	s_add_u32 s48, s48, 57344
	v_add_u32 v96, s48, v21
	ds_read_b64_tr_b16 v[112:113], v96 offset:0
	ds_read_b64_tr_b16 v[114:115], v96 offset:512
	ds_read_b64_tr_b16 v[116:117], v96 offset:1024
	ds_read_b64_tr_b16 v[118:119], v96 offset:1536
	ds_read_b64_tr_b16 v[120:121], v96 offset:2048
	ds_read_b64_tr_b16 v[122:123], v96 offset:2560
	ds_read_b64_tr_b16 v[124:125], v96 offset:3072
	ds_read_b64_tr_b16 v[126:127], v96 offset:3584
	ds_read_b64_tr_b16 v[128:129], v96 offset:4096
	ds_read_b64_tr_b16 v[130:131], v96 offset:4608
	ds_read_b64_tr_b16 v[132:133], v96 offset:5120
	ds_read_b64_tr_b16 v[134:135], v96 offset:5632
	ds_read_b64_tr_b16 v[136:137], v96 offset:6144
	ds_read_b64_tr_b16 v[138:139], v96 offset:6656
	v_add_u32 v106, s90, v4
	v_add_u32 v106, 57344, v106
	ds_read_b128 a[184:187], v106 offset:0
	ds_read_b128 a[188:191], v106 offset:4096
	ds_read_b128 a[192:195], v106 offset:8192
	ds_read_b128 a[196:199], v106 offset:12288
	ds_read_b128 a[200:203], v106 offset:16384
	ds_read_b128 a[204:207], v106 offset:20480
	ds_read_b128 a[208:211], v106 offset:24576
	s_waitcnt lgkmcnt(15)
	v_mfma_f32_32x32x16_bf16 v[160:175], v[224:227], v[112:115], 0
	v_mfma_f32_32x32x16_bf16 v[160:175], v[224:227], v[116:119], v[160:175]
	v_mfma_f32_32x32x16_bf16 v[160:175], v[224:227], v[120:123], v[160:175]
	s_waitcnt lgkmcnt(13)
	v_mfma_f32_32x32x16_bf16 v[160:175], v[224:227], v[124:127], v[160:175]
	s_waitcnt lgkmcnt(11)
	v_mfma_f32_32x32x16_bf16 v[160:175], v[224:227], v[128:131], v[160:175]
	s_waitcnt lgkmcnt(9)
	v_mfma_f32_32x32x16_bf16 v[160:175], v[224:227], v[132:135], v[160:175]
	s_waitcnt lgkmcnt(7)
	v_mfma_f32_32x32x16_bf16 v[160:175], v[224:227], v[136:139], v[160:175]
	s_lshl_b32 s48, s72, 12
	s_lshl_b32 s49, s71, 11
	s_add_u32 s48, s48, s49
	s_add_u32 s49, s76, 0
	s_cmp_eq_u32 s49, s48
	s_cbranch_scc0 Lres_63
	v_mfma_f32_32x32x16_bf16 v[24:39], a[240:243], a[0:3], 0
	v_mfma_f32_32x32x16_bf16 v[24:39], a[244:247], a[4:7], v[24:39]
	s_branch Lres_62
Lres_63:
	s_add_u32 s49, s76, 2048
	s_cmp_eq_u32 s49, s48
	s_cbranch_scc0 Lres_64
	v_mfma_f32_32x32x16_bf16 v[24:39], a[240:243], a[8:11], 0
	v_mfma_f32_32x32x16_bf16 v[24:39], a[244:247], a[12:15], v[24:39]
	s_branch Lres_62
Lres_64:
	s_add_u32 s49, s77, 0
	s_cmp_eq_u32 s49, s48
	s_cbranch_scc0 Lres_65
	v_mfma_f32_32x32x16_bf16 v[24:39], a[240:243], a[16:19], 0
	v_mfma_f32_32x32x16_bf16 v[24:39], a[244:247], a[20:23], v[24:39]
	s_branch Lres_62
Lres_65:
	s_add_u32 s49, s77, 2048
	s_cmp_eq_u32 s49, s48
	s_cbranch_scc0 Lres_66
	v_mfma_f32_32x32x16_bf16 v[24:39], a[240:243], a[24:27], 0
	v_mfma_f32_32x32x16_bf16 v[24:39], a[244:247], a[28:31], v[24:39]
	s_branch Lres_62
Lres_66:
	s_add_u32 s49, s78, 0
	s_cmp_eq_u32 s49, s48
	s_cbranch_scc0 Lres_67
	v_mfma_f32_32x32x16_bf16 v[24:39], a[240:243], a[32:35], 0
	v_mfma_f32_32x32x16_bf16 v[24:39], a[244:247], a[36:39], v[24:39]
	s_branch Lres_62
Lres_67:
	s_add_u32 s49, s78, 2048
	s_cmp_eq_u32 s49, s48
	s_cbranch_scc0 Lres_68
	v_mfma_f32_32x32x16_bf16 v[24:39], a[240:243], a[40:43], 0
	v_mfma_f32_32x32x16_bf16 v[24:39], a[244:247], a[44:47], v[24:39]
	s_branch Lres_62
Lres_68:
	s_add_u32 s49, s79, 0
	s_cmp_eq_u32 s49, s48
	s_cbranch_scc0 Lres_69
	v_mfma_f32_32x32x16_bf16 v[24:39], a[240:243], a[48:51], 0
	v_mfma_f32_32x32x16_bf16 v[24:39], a[244:247], a[52:55], v[24:39]
	s_branch Lres_62
Lres_69:
	s_add_u32 s49, s79, 2048
	s_cmp_eq_u32 s49, s48
	s_cbranch_scc0 Lres_70
	v_mfma_f32_32x32x16_bf16 v[24:39], a[240:243], a[56:59], 0
	v_mfma_f32_32x32x16_bf16 v[24:39], a[244:247], a[60:63], v[24:39]
	s_branch Lres_62
Lres_70:
	s_add_u32 s49, s80, 0
	s_cmp_eq_u32 s49, s48
	s_cbranch_scc0 Lres_71
	v_mfma_f32_32x32x16_bf16 v[24:39], a[240:243], a[64:67], 0
	v_mfma_f32_32x32x16_bf16 v[24:39], a[244:247], a[68:71], v[24:39]
	s_branch Lres_62
Lres_71:
	s_add_u32 s49, s80, 2048
	s_cmp_eq_u32 s49, s48
	s_cbranch_scc0 Lres_72
	v_mfma_f32_32x32x16_bf16 v[24:39], a[240:243], a[72:75], 0
	v_mfma_f32_32x32x16_bf16 v[24:39], a[244:247], a[76:79], v[24:39]
	s_branch Lres_62
Lres_72:
	s_add_u32 s49, s81, 0
	s_cmp_eq_u32 s49, s48
	s_cbranch_scc0 Lres_73
	v_mfma_f32_32x32x16_bf16 v[24:39], a[240:243], a[80:83], 0
	v_mfma_f32_32x32x16_bf16 v[24:39], a[244:247], a[84:87], v[24:39]
	s_branch Lres_62
Lres_73:
	s_add_u32 s49, s81, 2048
	s_cmp_eq_u32 s49, s48
	s_cbranch_scc0 Lres_74
	v_mfma_f32_32x32x16_bf16 v[24:39], a[240:243], a[88:91], 0
	v_mfma_f32_32x32x16_bf16 v[24:39], a[244:247], a[92:95], v[24:39]
	s_branch Lres_62
Lres_74:
	s_add_u32 s49, s82, 0
	s_cmp_eq_u32 s49, s48
	s_cbranch_scc0 Lres_75
	v_mfma_f32_32x32x16_bf16 v[24:39], a[240:243], a[96:99], 0
	v_mfma_f32_32x32x16_bf16 v[24:39], a[244:247], a[100:103], v[24:39]
	s_branch Lres_62
Lres_75:
	s_add_u32 s49, s82, 2048
	s_cmp_eq_u32 s49, s48
	s_cbranch_scc0 Lres_76
	v_mfma_f32_32x32x16_bf16 v[24:39], a[240:243], a[104:107], 0
	v_mfma_f32_32x32x16_bf16 v[24:39], a[244:247], a[108:111], v[24:39]
	s_branch Lres_62
Lres_76:
Lres_62:
	s_lshr_b32 s48, s90, 2
	s_add_u32 s48, s48, 162304
	v_add_u32 v96, s48, v2
	ds_write_b32 v96, v160
	s_waitcnt lgkmcnt(0)
	s_barrier
	v_add_u32 v96, 162304, v2
	ds_read_b32 v224, v96 offset:0
	ds_read_b32 v225, v96 offset:256
	ds_read_b32 v226, v96 offset:512
	ds_read_b32 v227, v96 offset:768
	s_waitcnt lgkmcnt(2)
	v_add_f32 v224, v224, v225
	s_waitcnt lgkmcnt(0)
	v_add_f32 v226, v226, v227
	v_add_f32 v224, v224, v226
	v_cndmask_b32 v224, v224, 0, s[84:85]
	v_cvt_pk_bf16_f32 v49, v224, 0
	v_mov_b32 v51, 0
	v_lshlrev_b32 v102, 16, v49
	v_mov_b32 v50, 0
	v_sub_f32 v102, v224, v102
	v_cvt_pk_bf16_f32 v48, v224, v102
	s_nop 1
	v_mfma_f32_32x32x16_bf16 v[144:159], v[48:51], v[68:71], v[144:159]
	s_lshr_b32 s48, s64, 1
	s_lshl_b32 s48, s48, 10
	s_and_b32 s49, s64, 1
	s_lshl_b32 s49, s49, 3
	s_add_u32 s48, s48, s49
	s_add_u32 s48, s48, 159744
	v_and_b32 v242, 31, v1
	v_lshrrev_b32 v243, 5, v1
	v_lshlrev_b32 v242, 5, v242
	v_lshl_add_u32 v242, v243, 4, v242
	v_add_u32 v242, s48, v242
	v_add_u32 v243, 159744, v4
	s_lshl_b32 s49, s63, 7
	s_add_u32 s49, s49, s70
	s_lshl_b32 s50, s62, 11
	s_add_u32 s50, s50, s68
	s_add_u32 m0, s90, 57344
	s_nop 0
	buffer_load_dwordx4 v240, s[12:15], s55 offen  lds
	v_pk_fma_f32 v[144:145], v[144:145], v[12:13], s[92:93] op_sel_hi:[1,0,0]
	v_pk_fma_f32 v[146:147], v[146:147], v[12:13], s[92:93] op_sel_hi:[1,0,0]
	v_pk_fma_f32 v[148:149], v[148:149], v[12:13], s[92:93] op_sel_hi:[1,0,0]
	v_pk_fma_f32 v[150:151], v[150:151], v[12:13], s[92:93] op_sel_hi:[1,0,0]
	v_pk_mul_f32 v[104:105], v[144:145], s[92:93] op_sel:[0,1] op_sel_hi:[1,1]
	v_pk_mul_f32 v[106:107], v[146:147], s[92:93] op_sel:[0,1] op_sel_hi:[1,1]
	v_pk_mul_f32 v[108:109], v[148:149], s[92:93] op_sel:[0,1] op_sel_hi:[1,1]
	v_pk_mul_f32 v[110:111], v[150:151], s[92:93] op_sel:[0,1] op_sel_hi:[1,1]
	v_exp_f32 v104, v104 clamp
	s_add_u32 m0, s90, 61440
	s_add_u32 s54, s55, 57344
	buffer_load_dwordx4 v240, s[12:15], s54 offen  lds
	v_exp_f32 v105, v105 clamp
	v_exp_f32 v106, v106 clamp
	v_exp_f32 v107, v107 clamp
	v_exp_f32 v108, v108 clamp
	v_exp_f32 v109, v109 clamp
	v_exp_f32 v110, v110 clamp
	v_exp_f32 v111, v111 clamp
	v_max_f32 v144, s92, v144
	v_max_f32 v145, s92, v145
	s_add_u32 m0, s90, 65536
	s_add_u32 s54, s55, 114688
	buffer_load_dwordx4 v240, s[12:15], s54 offen  lds
	v_max_f32 v146, s92, v146
	v_max_f32 v147, s92, v147
	v_max_f32 v148, s92, v148
	v_max_f32 v149, s92, v149
	v_max_f32 v150, s92, v150
	v_max_f32 v151, s92, v151
	v_pk_add_f32 v[144:145], v[144:145], v[104:105]
	v_pk_add_f32 v[146:147], v[146:147], v[106:107]
	v_pk_add_f32 v[148:149], v[148:149], v[108:109]
	s_add_u32 m0, s90, 69632
	s_add_u32 s54, s55, 172032
	buffer_load_dwordx4 v240, s[12:15], s54 offen  lds
	v_pk_add_f32 v[150:151], v[150:151], v[110:111]
	v_cvt_pk_bf16_f32 v248, v144, v145
	v_cvt_pk_bf16_f32 v249, v146, v147
	v_cvt_pk_bf16_f32 v250, v148, v149
	v_cvt_pk_bf16_f32 v251, v150, v151
	v_pk_fma_f32 v[152:153], v[152:153], v[12:13], s[92:93] op_sel_hi:[1,0,0]
	v_pk_fma_f32 v[154:155], v[154:155], v[12:13], s[92:93] op_sel_hi:[1,0,0]
	v_pk_fma_f32 v[156:157], v[156:157], v[12:13], s[92:93] op_sel_hi:[1,0,0]
	v_pk_fma_f32 v[158:159], v[158:159], v[12:13], s[92:93] op_sel_hi:[1,0,0]
	s_add_u32 m0, s90, 73728
	s_add_u32 s54, s55, 229376
	buffer_load_dwordx4 v240, s[12:15], s54 offen  lds
	v_pk_mul_f32 v[104:105], v[152:153], s[92:93] op_sel:[0,1] op_sel_hi:[1,1]
	v_pk_mul_f32 v[106:107], v[154:155], s[92:93] op_sel:[0,1] op_sel_hi:[1,1]
	v_pk_mul_f32 v[108:109], v[156:157], s[92:93] op_sel:[0,1] op_sel_hi:[1,1]
	v_pk_mul_f32 v[110:111], v[158:159], s[92:93] op_sel:[0,1] op_sel_hi:[1,1]
	v_exp_f32 v104, v104 clamp
	v_exp_f32 v105, v105 clamp
	v_exp_f32 v106, v106 clamp
	v_exp_f32 v107, v107 clamp
	v_exp_f32 v108, v108 clamp
	s_add_u32 m0, s90, 77824
	s_add_u32 s54, s55, 286720
	buffer_load_dwordx4 v240, s[12:15], s54 offen  lds
	v_exp_f32 v109, v109 clamp
	v_exp_f32 v110, v110 clamp
	v_exp_f32 v111, v111 clamp
	v_max_f32 v152, s92, v152
	v_max_f32 v153, s92, v153
	v_max_f32 v154, s92, v154
	v_max_f32 v155, s92, v155
	v_max_f32 v156, s92, v156
	v_max_f32 v157, s92, v157
	s_add_u32 m0, s90, 81920
	s_add_u32 s54, s55, 344064
	buffer_load_dwordx4 v240, s[12:15], s54 offen  lds
	v_max_f32 v158, s92, v158
	v_max_f32 v159, s92, v159
	v_pk_add_f32 v[152:153], v[152:153], v[104:105]
	v_pk_add_f32 v[154:155], v[154:155], v[106:107]
	v_pk_add_f32 v[156:157], v[156:157], v[108:109]
	v_pk_add_f32 v[158:159], v[158:159], v[110:111]
	v_cvt_pk_bf16_f32 v252, v152, v153
	v_cvt_pk_bf16_f32 v253, v154, v155
	v_cvt_pk_bf16_f32 v254, v156, v157
	v_cvt_pk_bf16_f32 v255, v158, v159
	s_waitcnt vmcnt(14)
	v_mfma_f32_32x32x16_bf16 v[112:127], v[176:179], v[192:195], 0
	s_waitcnt vmcnt(13)
	v_mfma_f32_32x32x16_bf16 v[112:127], v[176:179], v[196:199], v[112:127]
	s_waitcnt vmcnt(12)
	v_mfma_f32_32x32x16_bf16 v[112:127], v[176:179], v[200:203], v[112:127]
	s_waitcnt vmcnt(11)
	v_mfma_f32_32x32x16_bf16 v[112:127], v[176:179], v[204:207], v[112:127]
	s_waitcnt vmcnt(10)
	v_mfma_f32_32x32x16_bf16 v[112:127], v[176:179], v[208:211], v[112:127]
	s_waitcnt vmcnt(9)
	v_mfma_f32_32x32x16_bf16 v[112:127], v[176:179], v[212:215], v[112:127]
	s_waitcnt vmcnt(8)
	v_mfma_f32_32x32x16_bf16 v[112:127], v[176:179], v[216:219], v[112:127]
	s_waitcnt vmcnt(7)
	v_mfma_f32_32x32x16_bf16 v[112:127], v[176:179], v[220:223], v[112:127]
	s_nop 11
	v_cmp_u_f32 vcc, v112, v112
	s_nop 0
	s_cbranch_vccnz Lkvretry_77
Lkvok_78:
	s_nop 9
	v_cvt_pk_bf16_f32 v96, v112, v113
	v_cvt_pk_bf16_f32 v97, v114, v115
	ds_write_b64 v242, v[96:97]
	s_waitcnt lgkmcnt(0)
	s_barrier
	ds_read_b128 v[72:75], v243
	ds_read_b128 v[76:79], v243 offset:1024
	s_waitcnt lgkmcnt(1)
	v_mfma_f32_32x32x16_bf16 v[128:143], v[72:75], v[248:251], 0
	s_waitcnt lgkmcnt(0)
	v_mfma_f32_32x32x16_bf16 v[128:143], v[76:79], v[252:255], v[128:143]
	s_mov_b32 s40, s68
	s_add_u32 s41, s68, 4096
	s_add_u32 s42, s68, 8192
	s_add_u32 s43, s68, 12288
	s_add_u32 s44, s68, 16384
	s_add_u32 s45, s68, 20480
	s_add_u32 s46, s68, 24576
	s_add_u32 s47, s68, 28672
	s_nop 3
	v_add_f32 v96, s92, v140
	v_mov_b32 v97, v96
	s_nop 1
	v_permlane32_swap_b32 v96, v97
	v_rcp_f32 v97, v97
	s_nop 0
	v_cndmask_b32 v96, v97, 0, s[84:85]
	v_pk_mul_f32 v[128:129], v[128:129], v[96:97] op_sel:[0,1] op_sel_hi:[1,1]
	v_pk_mul_f32 v[130:131], v[130:131], v[96:97] op_sel:[0,1] op_sel_hi:[1,1]
	v_pk_mul_f32 v[132:133], v[132:133], v[96:97] op_sel:[0,1] op_sel_hi:[1,1]
	v_pk_mul_f32 v[134:135], v[134:135], v[96:97] op_sel:[0,1] op_sel_hi:[1,1]
	v_cvt_pk_bf16_f32 v224, v128, v129
	v_cvt_pk_bf16_f32 v225, v130, v131
	v_cvt_pk_bf16_f32 v226, v132, v133
	v_cvt_pk_bf16_f32 v227, v134, v135
	buffer_store_dwordx4 v[224:227], v4, s[28:31], s50 offen offset:0 sc1
	v_pk_mul_f32 v[136:137], v[136:137], v[96:97] op_sel:[0,1] op_sel_hi:[1,1]
	v_pk_mul_f32 v[138:139], v[138:139], v[96:97] op_sel:[0,1] op_sel_hi:[1,1]
	v_pk_mul_f32 v[140:141], v[140:141], v[96:97] op_sel_hi:[1,0]
	v_pk_mul_f32 v[142:143], v[142:143], v[96:97] op_sel_hi:[1,0]
	v_cvt_pk_bf16_f32 v228, v136, v137
	v_cvt_pk_bf16_f32 v229, v138, v139
	v_cvt_pk_bf16_f32 v230, v140, v141
	v_cvt_pk_bf16_f32 v231, v142, v143
	buffer_store_dwordx4 v[228:231], v4, s[28:31], s50 offen offset:1024 sc1
	s_add_u32 m0, s90, 0
	s_mov_b32 s54, 0
	buffer_load_dwordx4 v7, s[16:19], s54 offen lds
	s_add_u32 m0, s90, 4096
	s_mov_b32 s54, 114688
	buffer_load_dwordx4 v7, s[16:19], s54 offen lds
	s_add_u32 m0, s90, 8192
	s_mov_b32 s54, 229376
	buffer_load_dwordx4 v7, s[16:19], s54 offen lds
	s_add_u32 m0, s90, 12288
	s_mov_b32 s54, 344064
	buffer_load_dwordx4 v7, s[16:19], s54 offen lds
	s_add_u32 m0, s90, 16384
	s_mov_b32 s54, 458752
	buffer_load_dwordx4 v7, s[16:19], s54 offen lds
	s_add_u32 m0, s90, 20480
	s_mov_b32 s54, 573440
	buffer_load_dwordx4 v7, s[16:19], s54 offen lds
	s_add_u32 m0, s90, 24576
	s_mov_b32 s54, 688128
	buffer_load_dwordx4 v7, s[16:19], s54 offen lds
	s_waitcnt vmcnt(7)
	s_mov_b64 exec, 1
	buffer_store_dword v11, off, s[28:31], s74 offset:0 sc1
	s_mov_b64 exec, -1
	s_cmp_ge_u32 s62, 14
	s_cbranch_scc1 L_idle_slow0
	s_add_u32 m0, s90, 28672
	s_mov_b32 s54, 802816
	buffer_load_dwordx4 v7, s[16:19], s54 offen lds
	s_add_u32 m0, s90, 32768
	s_mov_b32 s54, 917504
	buffer_load_dwordx4 v7, s[16:19], s54 offen lds
	s_add_u32 m0, s90, 36864
	s_mov_b32 s54, 1032192
	buffer_load_dwordx4 v7, s[16:19], s54 offen lds
	s_add_u32 m0, s90, 40960
	s_mov_b32 s54, 1146880
	buffer_load_dwordx4 v7, s[16:19], s54 offen lds
	s_add_u32 m0, s90, 45056
	s_mov_b32 s54, 1261568
	buffer_load_dwordx4 v7, s[16:19], s54 offen lds
	s_add_u32 m0, s90, 49152
	s_mov_b32 s54, 1376256
	buffer_load_dwordx4 v7, s[16:19], s54 offen lds
	s_add_u32 m0, s90, 53248
	s_mov_b32 s54, 1490944
	buffer_load_dwordx4 v7, s[16:19], s54 offen lds
	s_lshr_b32 s48, s64, 1
	s_lshl_b32 s48, s48, 9
	s_and_b32 s49, s64, 1
	s_mul_i32 s49, s49, 28672
	s_add_u32 s48, s48, s49
	s_add_u32 s48, s48, 86016
	v_add_u32 v100, s48, v21
	v_mov_b32 v232, 0x3f803f80
	v_mov_b32 v233, 0x3f803f80
	v_mov_b32 v234, 0x3f803f80
	v_mov_b32 v235, 0x3f803f80
	ds_read_b64_tr_b16 v[72:73], v100 offset:0
	ds_read_b64_tr_b16 v[74:75], v100 offset:1024
	ds_read_b64_tr_b16 v[76:77], v100 offset:2048
	ds_read_b64_tr_b16 v[78:79], v100 offset:3072
	ds_read_b64_tr_b16 v[80:81], v100 offset:4096
	ds_read_b64_tr_b16 v[82:83], v100 offset:5120
	ds_read_b64_tr_b16 v[84:85], v100 offset:6144
	ds_read_b64_tr_b16 v[86:87], v100 offset:7168
	ds_read_b64_tr_b16 v[88:89], v100 offset:8192
	ds_read_b64_tr_b16 v[90:91], v100 offset:9216
	s_waitcnt lgkmcnt(8)
	v_mfma_f32_32x32x16_bf16 v[112:127], v[232:235], v[72:75], 0
	ds_read_b64_tr_b16 v[92:93], v100 offset:10240
	ds_read_b64_tr_b16 v[94:95], v100 offset:11264
	s_waitcnt lgkmcnt(8)
	v_mfma_f32_32x32x16_bf16 v[112:127], v[232:235], v[76:79], v[112:127]
	ds_read_b64_tr_b16 v[72:73], v100 offset:12288
	ds_read_b64_tr_b16 v[74:75], v100 offset:13312
	s_waitcnt lgkmcnt(8)
	v_mfma_f32_32x32x16_bf16 v[112:127], v[232:235], v[80:83], v[112:127]
	ds_read_b64_tr_b16 v[76:77], v100 offset:14336
	ds_read_b64_tr_b16 v[78:79], v100 offset:15360
	s_waitcnt lgkmcnt(8)
	v_mfma_f32_32x32x16_bf16 v[112:127], v[232:235], v[84:87], v[112:127]
	ds_read_b64_tr_b16 v[80:81], v100 offset:16384
	ds_read_b64_tr_b16 v[82:83], v100 offset:17408
	s_waitcnt lgkmcnt(8)
	v_mfma_f32_32x32x16_bf16 v[112:127], v[232:235], v[88:91], v[112:127]
	ds_read_b64_tr_b16 v[84:85], v100 offset:18432
	ds_read_b64_tr_b16 v[86:87], v100 offset:19456
	s_waitcnt lgkmcnt(8)
	v_mfma_f32_32x32x16_bf16 v[112:127], v[232:235], v[92:95], v[112:127]
	ds_read_b64_tr_b16 v[88:89], v100 offset:20480
	ds_read_b64_tr_b16 v[90:91], v100 offset:21504
	s_waitcnt lgkmcnt(8)
	v_mfma_f32_32x32x16_bf16 v[112:127], v[232:235], v[72:75], v[112:127]
	ds_read_b64_tr_b16 v[92:93], v100 offset:22528
	ds_read_b64_tr_b16 v[94:95], v100 offset:23552
	s_waitcnt lgkmcnt(8)
	v_mfma_f32_32x32x16_bf16 v[112:127], v[232:235], v[76:79], v[112:127]
	ds_read_b64_tr_b16 v[72:73], v100 offset:24576
	ds_read_b64_tr_b16 v[74:75], v100 offset:25600
	s_waitcnt lgkmcnt(8)
	v_mfma_f32_32x32x16_bf16 v[112:127], v[232:235], v[80:83], v[112:127]
	ds_read_b64_tr_b16 v[76:77], v100 offset:26624
	ds_read_b64_tr_b16 v[78:79], v100 offset:27648
	s_waitcnt lgkmcnt(8)
	v_mfma_f32_32x32x16_bf16 v[112:127], v[232:235], v[84:87], v[112:127]
	s_waitcnt lgkmcnt(6)
	v_mfma_f32_32x32x16_bf16 v[112:127], v[232:235], v[88:91], v[112:127]
	s_waitcnt lgkmcnt(4)
	v_mfma_f32_32x32x16_bf16 v[112:127], v[232:235], v[92:95], v[112:127]
	s_waitcnt lgkmcnt(2)
	v_mfma_f32_32x32x16_bf16 v[112:127], v[232:235], v[72:75], v[112:127]
	s_waitcnt lgkmcnt(0)
	v_mfma_f32_32x32x16_bf16 v[112:127], v[232:235], v[76:79], v[112:127]
	s_lshr_b32 s48, s90, 3
	s_add_u32 s48, s48, 162816
	v_and_b32 v100, 0x7c, v2
	v_add_u32 v100, s48, v100
	s_nop 7
	ds_write_b32 v100, v112
Lpoll_82:
	buffer_load_dword v14, v5, s[28:31], s73 offen offset:0 sc1
	s_waitcnt vmcnt(0)
	v_cmp_ne_u32 vcc, s65, v14
	s_nop 0
	s_cbranch_vccz Lpdone_83
	s_sub_u32 s67, s67, 1
	s_cbranch_scc0 Lpoll_82
	s_mov_b32 s67, 0
Lpdone_83:
	buffer_load_dwordx4 a[0:3], v4, s[28:31], s40 offen offset:0 sc1
	buffer_load_dwordx4 a[4:7], v4, s[28:31], s40 offen offset:1024 sc1
	buffer_load_dwordx4 a[8:11], v4, s[28:31], s40 offen offset:2048 sc1
	buffer_load_dwordx4 a[12:15], v4, s[28:31], s40 offen offset:3072 sc1
	buffer_load_dwordx4 a[16:19], v4, s[28:31], s41 offen offset:0 sc1
	buffer_load_dwordx4 a[20:23], v4, s[28:31], s41 offen offset:1024 sc1
	buffer_load_dwordx4 a[24:27], v4, s[28:31], s41 offen offset:2048 sc1
	buffer_load_dwordx4 a[28:31], v4, s[28:31], s41 offen offset:3072 sc1
	buffer_load_dwordx4 a[32:35], v4, s[28:31], s42 offen offset:0 sc1
	buffer_load_dwordx4 a[36:39], v4, s[28:31], s42 offen offset:1024 sc1
	s_waitcnt lgkmcnt(0)
	s_barrier
	ds_read_b64_tr_b16 v[72:73], v21 offset:57344
	ds_read_b64_tr_b16 v[74:75], v21 offset:57856
	ds_read_b64_tr_b16 v[76:77], v21 offset:58368
	ds_read_b64_tr_b16 v[78:79], v21 offset:58880
	ds_read_b64_tr_b16 v[80:81], v21 offset:59136
	ds_read_b64_tr_b16 v[82:83], v21 offset:59648
	ds_read_b64_tr_b16 v[84:85], v21 offset:60160
	ds_read_b64_tr_b16 v[86:87], v21 offset:60672
	buffer_load_dwordx4 a[40:43], v4, s[28:31], s42 offen offset:2048 sc1
	s_waitcnt lgkmcnt(4) vmcnt(10)
	v_mfma_f32_32x32x16_bf16 v[24:39], v[72:75], a[0:3], v[24:39]
	ds_read_b64_tr_b16 v[88:89], v21 offset:60928
	ds_read_b64_tr_b16 v[90:91], v21 offset:61440
	buffer_load_dwordx4 a[44:47], v4, s[28:31], s42 offen offset:3072 sc1
	s_waitcnt vmcnt(10)
	v_mfma_f32_32x32x16_bf16 v[24:39], v[76:79], a[4:7], v[24:39]
	ds_read_b64_tr_b16 v[92:93], v21 offset:61952
	ds_read_b64_tr_b16 v[94:95], v21 offset:62464
	buffer_load_dwordx4 a[48:51], v4, s[28:31], s43 offen offset:0 sc1
	s_waitcnt lgkmcnt(4) vmcnt(10)
	v_mfma_f32_32x32x16_bf16 v[24:39], v[80:83], a[8:11], v[24:39]
	ds_read_b64_tr_b16 v[72:73], v21 offset:62720
	ds_read_b64_tr_b16 v[74:75], v21 offset:63232
	buffer_load_dwordx4 a[52:55], v4, s[28:31], s43 offen offset:1024 sc1
	s_waitcnt vmcnt(10)
	v_mfma_f32_32x32x16_bf16 v[24:39], v[84:87], a[12:15], v[24:39]
	ds_read_b64_tr_b16 v[76:77], v21 offset:63744
	ds_read_b64_tr_b16 v[78:79], v21 offset:64256
	buffer_load_dwordx4 a[56:59], v4, s[28:31], s43 offen offset:2048 sc1
	s_waitcnt lgkmcnt(4) vmcnt(10)
	v_mfma_f32_32x32x16_bf16 v[24:39], v[88:91], a[16:19], v[24:39]
	ds_read_b64_tr_b16 v[80:81], v21 offset:64512
	ds_read_b64_tr_b16 v[82:83], v21 offset:65024
	buffer_load_dwordx4 a[60:63], v4, s[28:31], s43 offen offset:3072 sc1
	s_waitcnt vmcnt(10)
	v_mfma_f32_32x32x16_bf16 v[24:39], v[92:95], a[20:23], v[24:39]
	ds_read_b64_tr_b16 v[84:85], v22 offset:0
	ds_read_b64_tr_b16 v[86:87], v22 offset:512
	buffer_load_dwordx4 a[64:67], v4, s[28:31], s44 offen offset:0 sc1
	s_waitcnt lgkmcnt(4) vmcnt(10)
	v_mfma_f32_32x32x16_bf16 v[24:39], v[72:75], a[24:27], v[24:39]
	ds_read_b64_tr_b16 v[88:89], v22 offset:768
	ds_read_b64_tr_b16 v[90:91], v22 offset:1280
	buffer_load_dwordx4 a[68:71], v4, s[28:31], s44 offen offset:1024 sc1
	s_waitcnt vmcnt(10)
	v_mfma_f32_32x32x16_bf16 v[24:39], v[76:79], a[28:31], v[24:39]
	ds_read_b64_tr_b16 v[92:93], v22 offset:1792
	ds_read_b64_tr_b16 v[94:95], v22 offset:2304
	buffer_load_dwordx4 a[72:75], v4, s[28:31], s44 offen offset:2048 sc1
	s_waitcnt lgkmcnt(4) vmcnt(10)
	v_mfma_f32_32x32x16_bf16 v[24:39], v[80:83], a[32:35], v[24:39]
	ds_read_b64_tr_b16 v[72:73], v22 offset:2560
	ds_read_b64_tr_b16 v[74:75], v22 offset:3072
	buffer_load_dwordx4 a[76:79], v4, s[28:31], s44 offen offset:3072 sc1
	s_waitcnt vmcnt(10)
	v_mfma_f32_32x32x16_bf16 v[24:39], v[84:87], a[36:39], v[24:39]
	ds_read_b64_tr_b16 v[76:77], v22 offset:3584
	ds_read_b64_tr_b16 v[78:79], v22 offset:4096
	buffer_load_dwordx4 a[80:83], v4, s[28:31], s45 offen offset:0 sc1
	s_waitcnt lgkmcnt(4) vmcnt(10)
	v_mfma_f32_32x32x16_bf16 v[24:39], v[88:91], a[40:43], v[24:39]
	ds_read_b64_tr_b16 v[80:81], v22 offset:4352
	ds_read_b64_tr_b16 v[82:83], v22 offset:4864
	buffer_load_dwordx4 a[84:87], v4, s[28:31], s45 offen offset:1024 sc1
	s_waitcnt vmcnt(10)
	v_mfma_f32_32x32x16_bf16 v[24:39], v[92:95], a[44:47], v[24:39]
	ds_read_b64_tr_b16 v[84:85], v22 offset:5376
	ds_read_b64_tr_b16 v[86:87], v22 offset:5888
	buffer_load_dwordx4 a[88:91], v4, s[28:31], s45 offen offset:2048 sc1
	s_waitcnt lgkmcnt(4) vmcnt(10)
	v_mfma_f32_32x32x16_bf16 v[24:39], v[72:75], a[48:51], v[24:39]
	ds_read_b64_tr_b16 v[88:89], v22 offset:6144
	ds_read_b64_tr_b16 v[90:91], v22 offset:6656
	buffer_load_dwordx4 a[92:95], v4, s[28:31], s45 offen offset:3072 sc1
	s_waitcnt vmcnt(10)
	v_mfma_f32_32x32x16_bf16 v[24:39], v[76:79], a[52:55], v[24:39]
	ds_read_b64_tr_b16 v[92:93], v22 offset:7168
	ds_read_b64_tr_b16 v[94:95], v22 offset:7680
	buffer_load_dwordx4 a[96:99], v4, s[28:31], s46 offen offset:0 sc1
	s_waitcnt lgkmcnt(4) vmcnt(10)
	v_mfma_f32_32x32x16_bf16 v[24:39], v[80:83], a[56:59], v[24:39]
	ds_read_b64_tr_b16 v[72:73], v22 offset:7936
	ds_read_b64_tr_b16 v[74:75], v22 offset:8448
	buffer_load_dwordx4 a[100:103], v4, s[28:31], s46 offen offset:1024 sc1
	s_waitcnt vmcnt(10)
	v_mfma_f32_32x32x16_bf16 v[24:39], v[84:87], a[60:63], v[24:39]
	ds_read_b64_tr_b16 v[76:77], v22 offset:8960
	ds_read_b64_tr_b16 v[78:79], v22 offset:9472
	buffer_load_dwordx4 a[104:107], v4, s[28:31], s46 offen offset:2048 sc1
	s_waitcnt lgkmcnt(4) vmcnt(10)
	v_mfma_f32_32x32x16_bf16 v[24:39], v[88:91], a[64:67], v[24:39]
	ds_read_b64_tr_b16 v[80:81], v22 offset:9728
	ds_read_b64_tr_b16 v[82:83], v22 offset:10240
	buffer_load_dwordx4 a[108:111], v4, s[28:31], s46 offen offset:3072 sc1
	s_waitcnt vmcnt(10)
	v_mfma_f32_32x32x16_bf16 v[24:39], v[92:95], a[68:71], v[24:39]
	ds_read_b64_tr_b16 v[84:85], v22 offset:10752
	ds_read_b64_tr_b16 v[86:87], v22 offset:11264
	buffer_load_dwordx4 a[112:115], v4, s[28:31], s47 offen offset:0 sc1
	s_waitcnt lgkmcnt(4) vmcnt(10)
	v_mfma_f32_32x32x16_bf16 v[24:39], v[72:75], a[72:75], v[24:39]
	ds_read_b64_tr_b16 v[88:89], v22 offset:11520
	ds_read_b64_tr_b16 v[90:91], v22 offset:12032
	buffer_load_dwordx4 a[116:119], v4, s[28:31], s47 offen offset:1024 sc1
	s_waitcnt vmcnt(10)
	v_mfma_f32_32x32x16_bf16 v[24:39], v[76:79], a[76:79], v[24:39]
	ds_read_b64_tr_b16 v[92:93], v22 offset:12544
	ds_read_b64_tr_b16 v[94:95], v22 offset:13056
	buffer_load_dwordx4 a[120:123], v4, s[28:31], s47 offen offset:2048 sc1
	s_waitcnt lgkmcnt(4) vmcnt(10)
	v_mfma_f32_32x32x16_bf16 v[24:39], v[80:83], a[80:83], v[24:39]
	ds_read_b64_tr_b16 v[72:73], v22 offset:13312
	ds_read_b64_tr_b16 v[74:75], v22 offset:13824
	buffer_load_dwordx4 a[124:127], v4, s[28:31], s47 offen offset:3072 sc1
	s_waitcnt vmcnt(10)
	v_mfma_f32_32x32x16_bf16 v[24:39], v[84:87], a[84:87], v[24:39]
	ds_read_b64_tr_b16 v[76:77], v22 offset:14336
	ds_read_b64_tr_b16 v[78:79], v22 offset:14848
	s_waitcnt lgkmcnt(4) vmcnt(9)
	v_mfma_f32_32x32x16_bf16 v[24:39], v[88:91], a[88:91], v[24:39]
	ds_read_b64_tr_b16 v[80:81], v22 offset:15104
	ds_read_b64_tr_b16 v[82:83], v22 offset:15616
	s_waitcnt vmcnt(8)
	v_mfma_f32_32x32x16_bf16 v[24:39], v[92:95], a[92:95], v[24:39]
	ds_read_b64_tr_b16 v[84:85], v22 offset:16128
	ds_read_b64_tr_b16 v[86:87], v22 offset:16640
	s_waitcnt lgkmcnt(4) vmcnt(7)
	v_mfma_f32_32x32x16_bf16 v[24:39], v[72:75], a[96:99], v[24:39]
	ds_read_b64_tr_b16 v[88:89], v22 offset:16896
	ds_read_b64_tr_b16 v[90:91], v22 offset:17408
	s_waitcnt vmcnt(6)
	v_mfma_f32_32x32x16_bf16 v[24:39], v[76:79], a[100:103], v[24:39]
	ds_read_b64_tr_b16 v[92:93], v22 offset:17920
	ds_read_b64_tr_b16 v[94:95], v22 offset:18432
	s_waitcnt lgkmcnt(4) vmcnt(5)
	v_mfma_f32_32x32x16_bf16 v[24:39], v[80:83], a[104:107], v[24:39]
	ds_read_b64_tr_b16 v[72:73], v22 offset:18688
	ds_read_b64_tr_b16 v[74:75], v22 offset:19200
	s_waitcnt vmcnt(4)
	v_mfma_f32_32x32x16_bf16 v[24:39], v[84:87], a[108:111], v[24:39]
	ds_read_b64_tr_b16 v[76:77], v22 offset:19712
	ds_read_b64_tr_b16 v[78:79], v22 offset:20224
	s_waitcnt lgkmcnt(4) vmcnt(3)
	v_mfma_f32_32x32x16_bf16 v[24:39], v[88:91], a[112:115], v[24:39]
	s_waitcnt vmcnt(2)
	v_mfma_f32_32x32x16_bf16 v[24:39], v[92:95], a[116:119], v[24:39]
	s_waitcnt lgkmcnt(0) vmcnt(1)
	v_mfma_f32_32x32x16_bf16 v[24:39], v[72:75], a[120:123], v[24:39]
	s_waitcnt vmcnt(0)
	v_mfma_f32_32x32x16_bf16 v[24:39], v[76:79], a[124:127], v[24:39]
	s_lshl_b32 s53, s62, 11
	s_add_u32 s53, s53, s68
	s_add_u32 s53, s53, 32768
	s_lshl_b32 s49, s62, 8
	s_add_u32 s49, s49, s68
	s_add_u32 s49, s49, 61440
	s_add_u32 s48, s68, 32768
	s_add_u32 s40, s48, 0
	s_add_u32 s41, s48, 4096
	s_add_u32 s42, s48, 8192
	s_add_u32 s43, s48, 12288
	s_add_u32 s44, s48, 16384
	s_add_u32 s45, s48, 20480
	s_add_u32 s46, s48, 24576
	s_add_u32 s52, s68, 61440
	v_cvt_pk_bf16_f32 v224, v24, v25
	v_cvt_pk_bf16_f32 v225, v26, v27
	v_cvt_pk_bf16_f32 v226, v28, v29
	v_cvt_pk_bf16_f32 v227, v30, v31
	buffer_store_dwordx4 v[224:227], v4, s[28:31], s53 offen sc1
	v_cvt_pk_bf16_f32 v228, v32, v33
	v_cvt_pk_bf16_f32 v229, v34, v35
	v_cvt_pk_bf16_f32 v230, v36, v37
	v_cvt_pk_bf16_f32 v231, v38, v39
	buffer_store_dwordx4 v[228:231], v4, s[28:31], s53 offen offset:1024 sc1
	v_pk_add_f32 v[96:97], v[24:25], v[26:27]
	v_pk_mul_f32 v[98:99], v[24:25], v[24:25]
	v_pk_fma_f32 v[98:99], v[26:27], v[26:27], v[98:99]
	v_pk_fma_f32 v[98:99], v[28:29], v[28:29], v[98:99]
	v_pk_add_f32 v[96:97], v[96:97], v[28:29]
	v_pk_fma_f32 v[98:99], v[30:31], v[30:31], v[98:99]
	v_pk_add_f32 v[96:97], v[96:97], v[30:31]
	v_pk_fma_f32 v[98:99], v[32:33], v[32:33], v[98:99]
	v_pk_add_f32 v[96:97], v[96:97], v[32:33]
	v_pk_fma_f32 v[98:99], v[34:35], v[34:35], v[98:99]
	v_pk_add_f32 v[96:97], v[96:97], v[34:35]
	v_pk_fma_f32 v[98:99], v[36:37], v[36:37], v[98:99]
	v_pk_add_f32 v[96:97], v[96:97], v[36:37]
	v_pk_fma_f32 v[98:99], v[38:39], v[38:39], v[98:99]
	v_pk_add_f32 v[96:97], v[96:97], v[38:39]
	v_add_f32 v96, v96, v97
	v_add_f32 v97, v98, v99
	s_nop 1
	v_permlane32_swap_b32 v96, v97
	v_add_f32 v96, v96, v97
	buffer_store_dword v96, v2, s[28:31], s49 offen sc1
	s_lshr_b32 s50, s56, 3
	s_add_u32 s50, s50, s68
	s_add_u32 s50, s50, 65536
	s_add_u32 s51, s50, 4096
	v_add_u32 v106, s90, v4
	v_add_u32 v106, 57344, v106
	ds_read_b128 a[212:215], v106 offset:0
	ds_read_b128 a[216:219], v106 offset:4096
	ds_read_b128 a[220:223], v106 offset:8192
	ds_read_b128 a[224:227], v106 offset:12288
	ds_read_b128 a[228:231], v106 offset:16384
	ds_read_b128 a[232:235], v106 offset:20480
	ds_read_b128 a[236:239], v106 offset:24576
	s_lshr_b32 s48, s64, 1
	s_lshl_b32 s48, s48, 9
	s_and_b32 s49, s64, 1
	s_mul_i32 s49, s49, 28672
	s_add_u32 s48, s48, s49
	s_add_u32 s48, s48, 0
	v_add_u32 v100, s48, v21
	v_mov_b32 v232, 0x3f803f80
	v_mov_b32 v233, 0x3f803f80
	v_mov_b32 v234, 0x3f803f80
	v_mov_b32 v235, 0x3f803f80
	ds_read_b64_tr_b16 v[72:73], v100 offset:0
	ds_read_b64_tr_b16 v[74:75], v100 offset:1024
	ds_read_b64_tr_b16 v[76:77], v100 offset:2048
	ds_read_b64_tr_b16 v[78:79], v100 offset:3072
	ds_read_b64_tr_b16 v[80:81], v100 offset:4096
	ds_read_b64_tr_b16 v[82:83], v100 offset:5120
	ds_read_b64_tr_b16 v[84:85], v100 offset:6144
	ds_read_b64_tr_b16 v[86:87], v100 offset:7168
	ds_read_b64_tr_b16 v[88:89], v100 offset:8192
	ds_read_b64_tr_b16 v[90:91], v100 offset:9216
	s_waitcnt lgkmcnt(8)
	v_mfma_f32_32x32x16_bf16 v[112:127], v[232:235], v[72:75], 0
	ds_read_b64_tr_b16 v[92:93], v100 offset:10240
	ds_read_b64_tr_b16 v[94:95], v100 offset:11264
	s_waitcnt lgkmcnt(8)
	v_mfma_f32_32x32x16_bf16 v[112:127], v[232:235], v[76:79], v[112:127]
	s_waitcnt vmcnt(0)
	s_mov_b64 exec, 1
	buffer_store_dword v11, off, s[28:31], s74 offset:128 sc1
	s_mov_b64 exec, -1
	ds_read_b64_tr_b16 v[72:73], v100 offset:12288
	ds_read_b64_tr_b16 v[74:75], v100 offset:13312
	s_waitcnt lgkmcnt(8)
	v_mfma_f32_32x32x16_bf16 v[112:127], v[232:235], v[80:83], v[112:127]
	ds_read_b64_tr_b16 v[76:77], v100 offset:14336
	ds_read_b64_tr_b16 v[78:79], v100 offset:15360
	s_waitcnt lgkmcnt(8)
	v_mfma_f32_32x32x16_bf16 v[112:127], v[232:235], v[84:87], v[112:127]
	ds_read_b64_tr_b16 v[80:81], v100 offset:16384
	ds_read_b64_tr_b16 v[82:83], v100 offset:17408
	s_waitcnt lgkmcnt(8)
	v_mfma_f32_32x32x16_bf16 v[112:127], v[232:235], v[88:91], v[112:127]
	ds_read_b64_tr_b16 v[84:85], v100 offset:18432
	ds_read_b64_tr_b16 v[86:87], v100 offset:19456
	s_waitcnt lgkmcnt(8)
	v_mfma_f32_32x32x16_bf16 v[112:127], v[232:235], v[92:95], v[112:127]
	ds_read_b64_tr_b16 v[88:89], v100 offset:20480
	ds_read_b64_tr_b16 v[90:91], v100 offset:21504
	s_waitcnt lgkmcnt(8)
	v_mfma_f32_32x32x16_bf16 v[112:127], v[232:235], v[72:75], v[112:127]
	ds_read_b64_tr_b16 v[92:93], v100 offset:22528
	ds_read_b64_tr_b16 v[94:95], v100 offset:23552
	s_waitcnt lgkmcnt(8)
	v_mfma_f32_32x32x16_bf16 v[112:127], v[232:235], v[76:79], v[112:127]
	ds_read_b64_tr_b16 v[72:73], v100 offset:24576
	ds_read_b64_tr_b16 v[74:75], v100 offset:25600
	s_waitcnt lgkmcnt(8)
	v_mfma_f32_32x32x16_bf16 v[112:127], v[232:235], v[80:83], v[112:127]
	ds_read_b64_tr_b16 v[76:77], v100 offset:26624
	ds_read_b64_tr_b16 v[78:79], v100 offset:27648
	s_waitcnt lgkmcnt(8)
	v_mfma_f32_32x32x16_bf16 v[112:127], v[232:235], v[84:87], v[112:127]
	s_waitcnt lgkmcnt(6)
	v_mfma_f32_32x32x16_bf16 v[112:127], v[232:235], v[88:91], v[112:127]
	s_waitcnt lgkmcnt(4)
	v_mfma_f32_32x32x16_bf16 v[112:127], v[232:235], v[92:95], v[112:127]
	s_waitcnt lgkmcnt(2)
	v_mfma_f32_32x32x16_bf16 v[112:127], v[232:235], v[72:75], v[112:127]
	s_waitcnt lgkmcnt(0)
	v_mfma_f32_32x32x16_bf16 v[112:127], v[232:235], v[76:79], v[112:127]
	s_lshr_b32 s48, s90, 3
	s_add_u32 s48, s48, 162304
	v_and_b32 v100, 0x7c, v2
	v_add_u32 v100, s48, v100
	s_nop 7
	ds_write_b32 v100, v112
L_mlp_slow:
Lpoll_84:
	buffer_load_dword v14, v6, s[28:31], s73 offen offset:128 sc1
	s_waitcnt vmcnt(0)
	v_cmp_ne_u32 vcc, s65, v14
	s_nop 0
	s_cbranch_vccz Lpdone_85
	s_sub_u32 s67, s67, 1
	s_cbranch_scc0 Lpoll_84
	s_mov_b32 s67, 0
Lpdone_85:
	buffer_load_dwordx4 a[0:3], v4, s[28:31], s40 offen offset:0 sc1
	buffer_load_dwordx4 a[4:7], v4, s[28:31], s40 offen offset:1024 sc1
	buffer_load_dwordx4 a[8:11], v4, s[28:31], s40 offen offset:2048 sc1
	buffer_load_dwordx4 a[12:15], v4, s[28:31], s40 offen offset:3072 sc1
	buffer_load_dwordx4 v[224:227], v4, s[28:31], s52 offen offset:0 sc1
	buffer_load_dwordx4 v[228:231], v4, s[28:31], s52 offen offset:1024 sc1
	buffer_load_dwordx4 v[232:235], v4, s[28:31], s52 offen offset:2048 sc1
	buffer_load_dwordx4 v[236:239], v4, s[28:31], s52 offen offset:3072 sc1
	buffer_load_dwordx4 a[16:19], v4, s[28:31], s41 offen offset:0 sc1
	buffer_load_dwordx4 a[20:23], v4, s[28:31], s41 offen offset:1024 sc1
	buffer_load_dwordx4 a[24:27], v4, s[28:31], s41 offen offset:2048 sc1
	buffer_load_dwordx4 a[28:31], v4, s[28:31], s41 offen offset:3072 sc1
	buffer_load_dwordx4 a[32:35], v4, s[28:31], s42 offen offset:0 sc1
	s_waitcnt lgkmcnt(0)
	s_barrier
	s_cmp_lg_u32 s66, 0
	s_cbranch_scc1 Lskip_86
	v_and_b32 v96, 0x7c, v2
	v_add_u32 v96, 162304, v96
	ds_read_b32 v240, v96 offset:0
	ds_read_b32 v241, v96 offset:128
	ds_read_b32 v242, v96 offset:256
	ds_read_b32 v243, v96 offset:384
	ds_read_b32 v244, v96 offset:512
	ds_read_b32 v245, v96 offset:640
	ds_read_b32 v246, v96 offset:768
	ds_read_b32 v247, v96 offset:896
	v_lshlrev_b32 v248, 16, v55
	s_waitcnt lgkmcnt(6)
	v_add_f32 v240, v240, v241
	v_cndmask_b32 v240, v240, 0, s[84:85]
	v_cndmask_b32 v248, v248, 0, s[84:85]
	v_cvt_pk_bf16_f32 v53, v240, v248
	v_mov_b32 v55, 0
	v_lshlrev_b32 v102, 16, v53
	v_cvt_pk_bf16_f32 v54, v248, 0
	v_sub_f32 v102, v240, v102
	v_cvt_pk_bf16_f32 v52, v240, v102
	v_lshlrev_b32 v248, 16, v59
	s_waitcnt lgkmcnt(4)
	v_add_f32 v242, v242, v243
	v_cndmask_b32 v242, v242, 0, s[84:85]
	v_cndmask_b32 v248, v248, 0, s[84:85]
	v_cvt_pk_bf16_f32 v57, v242, v248
	v_mov_b32 v59, 0
	v_lshlrev_b32 v102, 16, v57
	v_cvt_pk_bf16_f32 v58, v248, 0
	v_sub_f32 v102, v242, v102
	v_cvt_pk_bf16_f32 v56, v242, v102
	v_lshlrev_b32 v248, 16, v63
	s_waitcnt lgkmcnt(2)
	v_add_f32 v244, v244, v245
	v_cndmask_b32 v244, v244, 0, s[84:85]
	v_cndmask_b32 v248, v248, 0, s[84:85]
	v_cvt_pk_bf16_f32 v61, v244, v248
	v_mov_b32 v63, 0
	v_lshlrev_b32 v102, 16, v61
	v_cvt_pk_bf16_f32 v62, v248, 0
	v_sub_f32 v102, v244, v102
	v_cvt_pk_bf16_f32 v60, v244, v102
	v_lshlrev_b32 v248, 16, v67
	s_waitcnt lgkmcnt(0)
	v_add_f32 v246, v246, v247
	v_cndmask_b32 v246, v246, 0, s[84:85]
	v_cndmask_b32 v248, v248, 0, s[84:85]
	v_cvt_pk_bf16_f32 v65, v246, v248
	v_mov_b32 v67, 0
	v_lshlrev_b32 v102, 16, v65
	v_cvt_pk_bf16_f32 v66, v248, 0
	v_sub_f32 v102, v246, v102
	v_cvt_pk_bf16_f32 v64, v246, v102
Lskip_86:
	ds_read_b64_tr_b16 v[72:73], v21 offset:0
	ds_read_b64_tr_b16 v[74:75], v21 offset:1024
	ds_read_b64_tr_b16 v[76:77], v21 offset:512
	ds_read_b64_tr_b16 v[78:79], v21 offset:1536
	ds_read_b64_tr_b16 v[80:81], v21 offset:2048
	ds_read_b64_tr_b16 v[82:83], v21 offset:3072
	ds_read_b64_tr_b16 v[84:85], v21 offset:2560
	ds_read_b64_tr_b16 v[86:87], v21 offset:3584
	buffer_load_dwordx4 a[36:39], v4, s[28:31], s42 offen offset:1024 sc1
	s_waitcnt lgkmcnt(4) vmcnt(13)
	v_mfma_f32_32x32x16_bf16 v[112:127], v[72:75], a[0:3], 0
	ds_read_b64_tr_b16 v[88:89], v21 offset:4096
	ds_read_b64_tr_b16 v[90:91], v21 offset:5120
	v_mfma_f32_32x32x16_bf16 v[128:143], v[76:79], a[0:3], 0
	ds_read_b64_tr_b16 v[92:93], v21 offset:4608
	ds_read_b64_tr_b16 v[94:95], v21 offset:5632
	buffer_load_dwordx4 a[40:43], v4, s[28:31], s42 offen offset:2048 sc1
	s_waitcnt lgkmcnt(4) vmcnt(13)
	v_mfma_f32_32x32x16_bf16 v[112:127], v[80:83], a[4:7], v[112:127]
	ds_read_b64_tr_b16 v[72:73], v21 offset:6144
	ds_read_b64_tr_b16 v[74:75], v21 offset:7168
	v_mfma_f32_32x32x16_bf16 v[128:143], v[84:87], a[4:7], v[128:143]
	ds_read_b64_tr_b16 v[76:77], v21 offset:6656
	ds_read_b64_tr_b16 v[78:79], v21 offset:7680
	buffer_load_dwordx4 a[44:47], v4, s[28:31], s42 offen offset:3072 sc1
	s_waitcnt lgkmcnt(4) vmcnt(13)
	v_mfma_f32_32x32x16_bf16 v[112:127], v[88:91], a[8:11], v[112:127]
	ds_read_b64_tr_b16 v[80:81], v21 offset:8192
	ds_read_b64_tr_b16 v[82:83], v21 offset:9216
	v_mfma_f32_32x32x16_bf16 v[128:143], v[92:95], a[8:11], v[128:143]
	ds_read_b64_tr_b16 v[84:85], v21 offset:8704
	ds_read_b64_tr_b16 v[86:87], v21 offset:9728
	buffer_load_dwordx4 a[48:51], v4, s[28:31], s43 offen offset:0 sc1
	s_waitcnt lgkmcnt(4) vmcnt(13)
	v_mfma_f32_32x32x16_bf16 v[112:127], v[72:75], a[12:15], v[112:127]
	ds_read_b64_tr_b16 v[88:89], v21 offset:10240
	ds_read_b64_tr_b16 v[90:91], v21 offset:11264
	v_mfma_f32_32x32x16_bf16 v[128:143], v[76:79], a[12:15], v[128:143]
	ds_read_b64_tr_b16 v[92:93], v21 offset:10752
	ds_read_b64_tr_b16 v[94:95], v21 offset:11776
	buffer_load_dwordx4 a[52:55], v4, s[28:31], s43 offen offset:1024 sc1
	s_waitcnt lgkmcnt(4) vmcnt(9)
	v_mfma_f32_32x32x16_bf16 v[112:127], v[80:83], a[16:19], v[112:127]
	ds_read_b64_tr_b16 v[72:73], v21 offset:12288
	ds_read_b64_tr_b16 v[74:75], v21 offset:13312
	v_mfma_f32_32x32x16_bf16 v[128:143], v[84:87], a[16:19], v[128:143]
	ds_read_b64_tr_b16 v[76:77], v21 offset:12800
	ds_read_b64_tr_b16 v[78:79], v21 offset:13824
	buffer_load_dwordx4 a[56:59], v4, s[28:31], s43 offen offset:2048 sc1
	s_waitcnt lgkmcnt(4) vmcnt(9)
	v_mfma_f32_32x32x16_bf16 v[112:127], v[88:91], a[20:23], v[112:127]
	ds_read_b64_tr_b16 v[80:81], v21 offset:14336
	ds_read_b64_tr_b16 v[82:83], v21 offset:15360
	v_cndmask_b32 v236, v236, 0, s[84:85]
	v_mfma_f32_32x32x16_bf16 v[128:143], v[92:95], a[20:23], v[128:143]
	ds_read_b64_tr_b16 v[84:85], v21 offset:14848
	ds_read_b64_tr_b16 v[86:87], v21 offset:15872
	v_cndmask_b32 v237, v237, 0, s[84:85]
	v_cndmask_b32 v238, v238, 0, s[84:85]
	buffer_load_dwordx4 a[60:63], v4, s[28:31], s43 offen offset:3072 sc1
	s_waitcnt lgkmcnt(4) vmcnt(9)
	v_mfma_f32_32x32x16_bf16 v[112:127], v[72:75], a[24:27], v[112:127]
	ds_read_b64_tr_b16 v[88:89], v21 offset:16384
	ds_read_b64_tr_b16 v[90:91], v21 offset:17408
	v_cndmask_b32 v239, v239, 0, s[84:85]
	v_add_f32 v224, v224, v228
	v_mfma_f32_32x32x16_bf16 v[128:143], v[76:79], a[24:27], v[128:143]
	ds_read_b64_tr_b16 v[92:93], v21 offset:16896
	ds_read_b64_tr_b16 v[94:95], v21 offset:17920
	v_add_f32 v225, v225, v229
	v_add_f32 v226, v226, v230
	buffer_load_dwordx4 a[64:67], v4, s[28:31], s44 offen offset:0 sc1
	s_waitcnt lgkmcnt(4) vmcnt(9)
	v_mfma_f32_32x32x16_bf16 v[112:127], v[80:83], a[28:31], v[112:127]
	ds_read_b64_tr_b16 v[72:73], v21 offset:18432
	ds_read_b64_tr_b16 v[74:75], v21 offset:19456
	v_add_f32 v227, v227, v231
	v_add_f32 v232, v232, v236
	v_mfma_f32_32x32x16_bf16 v[128:143], v[84:87], a[28:31], v[128:143]
	ds_read_b64_tr_b16 v[76:77], v21 offset:18944
	ds_read_b64_tr_b16 v[78:79], v21 offset:19968
	v_add_f32 v233, v233, v237
	buffer_load_dwordx4 a[68:71], v4, s[28:31], s44 offen offset:1024 sc1
	s_waitcnt lgkmcnt(4) vmcnt(9)
	v_mfma_f32_32x32x16_bf16 v[112:127], v[88:91], a[32:35], v[112:127]
	ds_read_b64_tr_b16 v[80:81], v21 offset:20480
	ds_read_b64_tr_b16 v[82:83], v21 offset:21504
	v_add_f32 v234, v234, v238
	v_add_f32 v235, v235, v239
	v_mfma_f32_32x32x16_bf16 v[128:143], v[92:95], a[32:35], v[128:143]
	ds_read_b64_tr_b16 v[84:85], v21 offset:20992
	ds_read_b64_tr_b16 v[86:87], v21 offset:22016
	v_add_f32 v224, v224, v232
	v_add_f32 v225, v225, v233
	buffer_load_dwordx4 a[72:75], v4, s[28:31], s44 offen offset:2048 sc1
	s_waitcnt lgkmcnt(4) vmcnt(9)
	v_mfma_f32_32x32x16_bf16 v[112:127], v[72:75], a[36:39], v[112:127]
	ds_read_b64_tr_b16 v[88:89], v21 offset:22528
	ds_read_b64_tr_b16 v[90:91], v21 offset:23552
	v_add_f32 v226, v226, v234
	v_add_f32 v227, v227, v235
	v_mfma_f32_32x32x16_bf16 v[128:143], v[76:79], a[36:39], v[128:143]
	ds_read_b64_tr_b16 v[92:93], v21 offset:23040
	ds_read_b64_tr_b16 v[94:95], v21 offset:24064
	s_lshl_b32 s48, s64, 12
	s_add_u32 s48, s48, 143360
	buffer_load_dwordx4 a[76:79], v4, s[28:31], s44 offen offset:3072 sc1
	s_waitcnt lgkmcnt(4) vmcnt(9)
	v_mfma_f32_32x32x16_bf16 v[112:127], v[80:83], a[40:43], v[112:127]
	ds_read_b64_tr_b16 v[72:73], v21 offset:24576
	ds_read_b64_tr_b16 v[74:75], v21 offset:25600
	v_add_u32 v100, s48, v2
	v_mfma_f32_32x32x16_bf16 v[128:143], v[84:87], a[40:43], v[128:143]
	ds_read_b64_tr_b16 v[76:77], v21 offset:25088
	ds_read_b64_tr_b16 v[78:79], v21 offset:26112
	ds_write_b128 v9, v[224:227]
	ds_read_b32 v228, v100 offset:0
	buffer_load_dwordx4 a[80:83], v4, s[28:31], s45 offen offset:0 sc1
	s_waitcnt lgkmcnt(6) vmcnt(9)
	v_mfma_f32_32x32x16_bf16 v[112:127], v[88:91], a[44:47], v[112:127]
	ds_read_b64_tr_b16 v[80:81], v21 offset:26624
	ds_read_b64_tr_b16 v[82:83], v21 offset:27648
	ds_read_b32 v229, v100 offset:256
	ds_read_b32 v230, v100 offset:512
	v_mfma_f32_32x32x16_bf16 v[128:143], v[92:95], a[44:47], v[128:143]
	ds_read_b64_tr_b16 v[84:85], v21 offset:27136
	ds_read_b64_tr_b16 v[86:87], v21 offset:28160
	ds_read_b32 v231, v100 offset:768
	s_waitcnt lgkmcnt(4)
	v_add_f32 v228, v228, v229
	buffer_load_dwordx4 a[84:87], v4, s[28:31], s45 offen offset:1024 sc1
	s_waitcnt vmcnt(9)
	v_mfma_f32_32x32x16_bf16 v[112:127], v[72:75], a[48:51], v[112:127]
	ds_read_b64_tr_b16 v[88:89], v21 offset:28672
	ds_read_b64_tr_b16 v[90:91], v21 offset:29696
	s_waitcnt lgkmcnt(2)
	v_add_f32 v230, v230, v231
	v_add_f32 v224, v228, v230
	v_mfma_f32_32x32x16_bf16 v[128:143], v[76:79], a[48:51], v[128:143]
	ds_read_b64_tr_b16 v[92:93], v21 offset:29184
	ds_read_b64_tr_b16 v[94:95], v21 offset:30208
	v_mov_b32 v225, v224
	buffer_load_dwordx4 a[88:91], v4, s[28:31], s45 offen offset:2048 sc1
	s_waitcnt vmcnt(9)
	v_mfma_f32_32x32x16_bf16 v[112:127], v[80:83], a[52:55], v[112:127]
	ds_read_b64_tr_b16 v[72:73], v21 offset:30720
	ds_read_b64_tr_b16 v[74:75], v21 offset:31744
	v_permlane32_swap_b32 v224, v225
	v_mul_f32 v96, 0x3b124925, v224
	v_mfma_f32_32x32x16_bf16 v[128:143], v[84:87], a[52:55], v[128:143]
	ds_read_b64_tr_b16 v[76:77], v21 offset:31232
	ds_read_b64_tr_b16 v[78:79], v21 offset:32256
	v_mul_f32 v97, 0x3b124925, v225
	v_cvt_pk_bf16_f32 v68, -v96, -v96
	buffer_load_dwordx4 a[92:95], v4, s[28:31], s45 offen offset:3072 sc1
	s_waitcnt lgkmcnt(4) vmcnt(9)
	v_mfma_f32_32x32x16_bf16 v[112:127], v[88:91], a[56:59], v[112:127]
	ds_read_b64_tr_b16 v[80:81], v21 offset:32768
	ds_read_b64_tr_b16 v[82:83], v21 offset:33792
	v_fma_f32 v97, -v96, v96, v97
	v_and_b32 v98, s94, v68
	v_mfma_f32_32x32x16_bf16 v[128:143], v[92:95], a[56:59], v[128:143]
	ds_read_b64_tr_b16 v[84:85], v21 offset:33280
	ds_read_b64_tr_b16 v[86:87], v21 offset:34304
	v_max_f32 v97, 0, v97
	v_sub_f32 v98, -v96, v98
	buffer_load_dwordx4 a[96:99], v4, s[28:31], s46 offen offset:0 sc1
	s_waitcnt lgkmcnt(4) vmcnt(9)
	v_mfma_f32_32x32x16_bf16 v[112:127], v[72:75], a[60:63], v[112:127]
	ds_read_b64_tr_b16 v[88:89], v21 offset:34816
	ds_read_b64_tr_b16 v[90:91], v21 offset:35840
	v_add_f32 v99, 0x3727c5ac, v97
	v_mfma_f32_32x32x16_bf16 v[128:143], v[76:79], a[60:63], v[128:143]
	ds_read_b64_tr_b16 v[92:93], v21 offset:35328
	ds_read_b64_tr_b16 v[94:95], v21 offset:36352
	v_mov_b32 v71, 0
	v_rsq_f32 v12, v99
	buffer_load_dwordx4 a[100:103], v4, s[28:31], s46 offen offset:1024 sc1
	s_waitcnt lgkmcnt(4) vmcnt(9)
	v_mfma_f32_32x32x16_bf16 v[112:127], v[80:83], a[64:67], v[112:127]
	ds_read_b64_tr_b16 v[72:73], v21 offset:36864
	ds_read_b64_tr_b16 v[74:75], v21 offset:37888
	v_mul_f32 v97, v97, v12
	v_mul_f32 v97, v97, v12
	v_mfma_f32_32x32x16_bf16 v[128:143], v[84:87], a[64:67], v[128:143]
	ds_read_b64_tr_b16 v[76:77], v21 offset:37376
	ds_read_b64_tr_b16 v[78:79], v21 offset:38400
	v_add_f32 v97, 0x3727c5ac, v97
	v_rsq_f32 v97, v97
	buffer_load_dwordx4 a[104:107], v4, s[28:31], s46 offen offset:2048 sc1
	s_waitcnt lgkmcnt(4) vmcnt(9)
	v_mfma_f32_32x32x16_bf16 v[112:127], v[88:91], a[68:71], v[112:127]
	ds_read_b64_tr_b16 v[80:81], v21 offset:38912
	ds_read_b64_tr_b16 v[82:83], v21 offset:39936
	v_mul_f32 v96, v12, v97
	v_rcp_f32 v20, v96
	v_mfma_f32_32x32x16_bf16 v[128:143], v[92:95], a[68:71], v[128:143]
	ds_read_b64_tr_b16 v[84:85], v21 offset:39424
	ds_read_b64_tr_b16 v[86:87], v21 offset:40448
	v_mul_f32 v18, 0xc0135761, v96
	buffer_load_dwordx4 a[108:111], v4, s[28:31], s46 offen offset:3072 sc1
	s_waitcnt lgkmcnt(4) vmcnt(9)
	v_mfma_f32_32x32x16_bf16 v[112:127], v[72:75], a[72:75], v[112:127]
	ds_read_b64_tr_b16 v[88:89], v21 offset:40960
	ds_read_b64_tr_b16 v[90:91], v21 offset:41984
	v_mul_f32 v97, v96, v96
	v_cvt_pk_bf16_f32 v69, v98, v20
	v_mfma_f32_32x32x16_bf16 v[128:143], v[76:79], a[72:75], v[128:143]
	ds_read_b64_tr_b16 v[92:93], v21 offset:41472
	ds_read_b64_tr_b16 v[94:95], v21 offset:42496
	v_mul_f32 v97, v97, v96
	v_and_b32 v99, s94, v69
	s_add_u32 m0, s90, 57344
	s_nop 0
	buffer_load_dwordx4 v8, s[20:23], s56 offen  lds
	s_waitcnt lgkmcnt(4) vmcnt(9)
	v_mfma_f32_32x32x16_bf16 v[112:127], v[80:83], a[76:79], v[112:127]
	ds_read_b64_tr_b16 v[72:73], v21 offset:43008
	ds_read_b64_tr_b16 v[74:75], v21 offset:44032
	v_mul_f32 v19, 0xbdd2d3e8, v97
	v_sub_f32 v99, v20, v99
	v_mfma_f32_32x32x16_bf16 v[128:143], v[84:87], a[76:79], v[128:143]
	ds_read_b64_tr_b16 v[76:77], v21 offset:43520
	ds_read_b64_tr_b16 v[78:79], v21 offset:44544
	v_cvt_pk_bf16_f32 v70, v99, 0
	s_add_u32 m0, s90, 61440
	s_add_u32 s54, s56, 28672
	buffer_load_dwordx4 v8, s[20:23], s54 offen  lds
	s_waitcnt lgkmcnt(4) vmcnt(9)
	v_mfma_f32_32x32x16_bf16 v[112:127], v[88:91], a[80:83], v[112:127]
	ds_read_b64_tr_b16 v[80:81], v21 offset:45056
	ds_read_b64_tr_b16 v[82:83], v21 offset:46080
	s_lshr_b32 s41, s57, 3
	v_mfma_f32_32x32x16_bf16 v[128:143], v[92:95], a[80:83], v[128:143]
	ds_read_b64_tr_b16 v[84:85], v21 offset:45568
	ds_read_b64_tr_b16 v[86:87], v21 offset:46592
	s_add_u32 s41, s41, s68
	s_add_u32 s41, s41, 65536
	s_add_u32 m0, s90, 65536
	s_nop 0
	buffer_load_dwordx4 v8, s[20:23], s57 offen  lds
	s_waitcnt lgkmcnt(4) vmcnt(9)
	v_mfma_f32_32x32x16_bf16 v[112:127], v[72:75], a[84:87], v[112:127]
	ds_read_b64_tr_b16 v[88:89], v21 offset:47104
	ds_read_b64_tr_b16 v[90:91], v21 offset:48128
	s_lshr_b32 s42, s58, 3
	v_mfma_f32_32x32x16_bf16 v[128:143], v[76:79], a[84:87], v[128:143]
	ds_read_b64_tr_b16 v[92:93], v21 offset:47616
	ds_read_b64_tr_b16 v[94:95], v21 offset:48640
	s_add_u32 s42, s42, s68
	s_add_u32 s42, s42, 65536
	s_add_u32 m0, s90, 69632
	s_add_u32 s54, s57, 28672
	buffer_load_dwordx4 v8, s[20:23], s54 offen  lds
	s_waitcnt lgkmcnt(4) vmcnt(9)
	v_mfma_f32_32x32x16_bf16 v[112:127], v[80:83], a[88:91], v[112:127]
	ds_read_b64_tr_b16 v[72:73], v21 offset:49152
	ds_read_b64_tr_b16 v[74:75], v21 offset:50176
	s_lshr_b32 s43, s59, 3
	s_add_u32 s43, s43, s68
	v_mfma_f32_32x32x16_bf16 v[128:143], v[84:87], a[88:91], v[128:143]
	ds_read_b64_tr_b16 v[76:77], v21 offset:49664
	ds_read_b64_tr_b16 v[78:79], v21 offset:50688
	s_add_u32 s43, s43, 65536
	s_add_u32 m0, s90, 73728
	s_nop 0
	buffer_load_dwordx4 v8, s[20:23], s58 offen  lds
	s_waitcnt lgkmcnt(4) vmcnt(9)
	v_mfma_f32_32x32x16_bf16 v[112:127], v[88:91], a[92:95], v[112:127]
	ds_read_b64_tr_b16 v[80:81], v21 offset:51200
	ds_read_b64_tr_b16 v[82:83], v21 offset:52224
	s_lshr_b32 s44, s60, 3
	s_add_u32 s44, s44, s68
	v_mfma_f32_32x32x16_bf16 v[128:143], v[92:95], a[92:95], v[128:143]
	ds_read_b64_tr_b16 v[84:85], v21 offset:51712
	ds_read_b64_tr_b16 v[86:87], v21 offset:52736
	s_add_u32 s44, s44, 65536
	s_add_u32 m0, s90, 77824
	s_add_u32 s54, s58, 28672
	buffer_load_dwordx4 v8, s[20:23], s54 offen  lds
	s_waitcnt lgkmcnt(4) vmcnt(9)
	v_mfma_f32_32x32x16_bf16 v[112:127], v[72:75], a[96:99], v[112:127]
	ds_read_b64_tr_b16 v[88:89], v21 offset:53248
	ds_read_b64_tr_b16 v[90:91], v21 offset:54272
	s_lshr_b32 s45, s61, 3
	s_add_u32 s45, s45, s68
	v_mfma_f32_32x32x16_bf16 v[128:143], v[76:79], a[96:99], v[128:143]
	ds_read_b64_tr_b16 v[92:93], v21 offset:53760
	ds_read_b64_tr_b16 v[94:95], v21 offset:54784
	s_add_u32 s45, s45, 65536
	s_lshr_b32 s46, s75, 3
	s_add_u32 m0, s90, 81920
	s_nop 0
	buffer_load_dwordx4 v8, s[20:23], s59 offen  lds
	s_waitcnt lgkmcnt(4) vmcnt(9)
	v_mfma_f32_32x32x16_bf16 v[112:127], v[80:83], a[100:103], v[112:127]
	ds_read_b64_tr_b16 v[72:73], v21 offset:55296
	ds_read_b64_tr_b16 v[74:75], v21 offset:56320
	s_add_u32 s46, s46, s68
	v_mfma_f32_32x32x16_bf16 v[128:143], v[84:87], a[100:103], v[128:143]
	ds_read_b64_tr_b16 v[76:77], v21 offset:55808
	ds_read_b64_tr_b16 v[78:79], v21 offset:56832
	s_add_u32 s46, s46, 65536
	s_lshl_b32 s53, s62, 11
	s_waitcnt lgkmcnt(4) vmcnt(8)
	v_mfma_f32_32x32x16_bf16 v[112:127], v[88:91], a[104:107], v[112:127]
	s_add_u32 s53, s53, s68
	v_mfma_f32_32x32x16_bf16 v[128:143], v[92:95], a[104:107], v[128:143]
	v_mov_b32 v96, -1
	v_mov_b32 v97, -1
	s_waitcnt lgkmcnt(0) vmcnt(7)
	v_mfma_f32_32x32x16_bf16 v[112:127], v[72:75], a[108:111], v[112:127]
	v_mov_b32 v98, -1
	v_mov_b32 v99, -1
	v_mfma_f32_32x32x16_bf16 v[128:143], v[76:79], a[108:111], v[128:143]
	v_mfma_f32_32x32x16_bf16 v[112:127], v[52:55], v[68:71], v[112:127]
	v_mfma_f32_32x32x16_bf16 v[128:143], v[56:59], v[68:71], v[128:143]
	s_barrier
	ds_read_b64_tr_b16 v[72:73], v22 offset:20480
	ds_read_b64_tr_b16 v[74:75], v22 offset:21504
	ds_read_b64_tr_b16 v[76:77], v22 offset:20992
	ds_read_b64_tr_b16 v[78:79], v22 offset:22016
	ds_read_b64_tr_b16 v[80:81], v22 offset:22528
	ds_read_b64_tr_b16 v[82:83], v22 offset:23552
	ds_read_b64_tr_b16 v[84:85], v22 offset:23040
	ds_read_b64_tr_b16 v[86:87], v22 offset:24064
	buffer_load_dword v17, v16, s[28:31], s68 offen
	s_waitcnt lgkmcnt(4)
	v_mfma_f32_32x32x16_bf16 v[144:159], v[72:75], a[0:3], 0
	ds_read_b64_tr_b16 v[88:89], v22 offset:24576
	ds_read_b64_tr_b16 v[90:91], v22 offset:25600
	v_mul_f32 v104, v112, v112
	v_mul_f32 v105, v113, v113
	v_mul_f32 v106, v114, v114
	v_mul_f32 v107, v115, v115
	v_mfma_f32_32x32x16_bf16 v[160:175], v[76:79], a[0:3], 0
	ds_read_b64_tr_b16 v[92:93], v22 offset:25088
	ds_read_b64_tr_b16 v[94:95], v22 offset:26112
	v_fma_f32 v104, v104, v19, v18
	v_fma_f32 v105, v105, v19, v18
	v_fma_f32 v106, v106, v19, v18
	v_fma_f32 v107, v107, v19, v18
	s_add_u32 m0, s90, 0
	s_add_u32 s54, s59, 28672
	buffer_load_dwordx4 v8, s[20:23], s54 offen  lds
	s_waitcnt lgkmcnt(4)
	v_mfma_f32_32x32x16_bf16 v[144:159], v[80:83], a[4:7], v[144:159]
	ds_read_b64_tr_b16 v[72:73], v22 offset:26624
	ds_read_b64_tr_b16 v[74:75], v22 offset:27648
	v_mul_f32 v104, v104, v112
	v_mul_f32 v105, v105, v113
	v_mul_f32 v106, v106, v114
	v_mul_f32 v107, v107, v115
	v_exp_f32 v104, v104
	v_mfma_f32_32x32x16_bf16 v[160:175], v[84:87], a[4:7], v[160:175]
	ds_read_b64_tr_b16 v[76:77], v22 offset:27136
	ds_read_b64_tr_b16 v[78:79], v22 offset:28160
	v_exp_f32 v105, v105
	v_exp_f32 v106, v106
	v_exp_f32 v107, v107
	v_fma_f32 v104, v104, v20, v20
	s_add_u32 m0, s90, 4096
	s_nop 0
	buffer_load_dwordx4 v8, s[20:23], s60 offen  lds
	s_waitcnt lgkmcnt(4)
	v_mfma_f32_32x32x16_bf16 v[144:159], v[88:91], a[8:11], v[144:159]
	ds_read_b64_tr_b16 v[80:81], v22 offset:28672
	ds_read_b64_tr_b16 v[82:83], v22 offset:29696
	v_fma_f32 v105, v105, v20, v20
	v_fma_f32 v106, v106, v20, v20
	v_fma_f32 v107, v107, v20, v20
	v_rcp_f32 v104, v104
	v_rcp_f32 v105, v105
	v_mfma_f32_32x32x16_bf16 v[160:175], v[92:95], a[8:11], v[160:175]
	ds_read_b64_tr_b16 v[84:85], v22 offset:29184
	ds_read_b64_tr_b16 v[86:87], v22 offset:30208
	v_rcp_f32 v106, v106
	v_rcp_f32 v107, v107
	v_mul_f32 v112, v112, v104
	v_mul_f32 v113, v113, v105
	s_add_u32 m0, s90, 8192
	s_add_u32 s54, s60, 28672
	buffer_load_dwordx4 v8, s[20:23], s54 offen  lds
	s_waitcnt lgkmcnt(4)
	v_mfma_f32_32x32x16_bf16 v[144:159], v[72:75], a[12:15], v[144:159]
	ds_read_b64_tr_b16 v[88:89], v22 offset:30720
	ds_read_b64_tr_b16 v[90:91], v22 offset:31744
	v_mul_f32 v114, v114, v106
	v_mul_f32 v115, v115, v107
	v_cvt_pk_bf16_f32 v224, v112, v113
	v_cvt_pk_bf16_f32 v225, v114, v115
	v_mul_f32 v108, v116, v116
	v_mfma_f32_32x32x16_bf16 v[160:175], v[76:79], a[12:15], v[160:175]
	ds_read_b64_tr_b16 v[92:93], v22 offset:31232
	ds_read_b64_tr_b16 v[94:95], v22 offset:32256
	v_mul_f32 v109, v117, v117
	v_mul_f32 v110, v118, v118
	v_mul_f32 v111, v119, v119
	v_fma_f32 v108, v108, v19, v18
	s_add_u32 m0, s90, 12288
	s_nop 0
	buffer_load_dwordx4 v8, s[20:23], s61 offen  lds
	s_waitcnt lgkmcnt(4)
	v_mfma_f32_32x32x16_bf16 v[144:159], v[80:83], a[16:19], v[144:159]
	ds_read_b64_tr_b16 v[72:73], v22 offset:32768
	ds_read_b64_tr_b16 v[74:75], v22 offset:33792
	v_fma_f32 v109, v109, v19, v18
	v_fma_f32 v110, v110, v19, v18
	v_fma_f32 v111, v111, v19, v18
	v_mul_f32 v108, v108, v116
	v_mfma_f32_32x32x16_bf16 v[160:175], v[84:87], a[16:19], v[160:175]
	ds_read_b64_tr_b16 v[76:77], v22 offset:33280
	ds_read_b64_tr_b16 v[78:79], v22 offset:34304
	v_mul_f32 v109, v109, v117
	v_mul_f32 v110, v110, v118
	v_mul_f32 v111, v111, v119
	v_exp_f32 v108, v108
	v_exp_f32 v109, v109
	s_add_u32 m0, s90, 16384
	s_add_u32 s54, s61, 28672
	buffer_load_dwordx4 v8, s[20:23], s54 offen  lds
	s_waitcnt lgkmcnt(4)
	v_mfma_f32_32x32x16_bf16 v[144:159], v[88:91], a[20:23], v[144:159]
	ds_read_b64_tr_b16 v[80:81], v22 offset:34816
	ds_read_b64_tr_b16 v[82:83], v22 offset:35840
	v_exp_f32 v110, v110
	v_exp_f32 v111, v111
	v_fma_f32 v108, v108, v20, v20
	v_fma_f32 v109, v109, v20, v20
	v_mfma_f32_32x32x16_bf16 v[160:175], v[92:95], a[20:23], v[160:175]
	ds_read_b64_tr_b16 v[84:85], v22 offset:35328
	ds_read_b64_tr_b16 v[86:87], v22 offset:36352
	v_fma_f32 v110, v110, v20, v20
	v_fma_f32 v111, v111, v20, v20
	v_rcp_f32 v108, v108
	v_rcp_f32 v109, v109
	v_rcp_f32 v110, v110
	s_add_u32 m0, s90, 20480
	s_nop 0
	buffer_load_dwordx4 v8, s[20:23], s75 offen  lds
	s_waitcnt lgkmcnt(4)
	v_mfma_f32_32x32x16_bf16 v[144:159], v[72:75], a[24:27], v[144:159]
	ds_read_b64_tr_b16 v[88:89], v22 offset:36864
	ds_read_b64_tr_b16 v[90:91], v22 offset:37888
	v_rcp_f32 v111, v111
	v_mul_f32 v116, v116, v108
	v_mul_f32 v117, v117, v109
	v_mul_f32 v118, v118, v110
	v_mfma_f32_32x32x16_bf16 v[160:175], v[76:79], a[24:27], v[160:175]
	ds_read_b64_tr_b16 v[92:93], v22 offset:37376
	ds_read_b64_tr_b16 v[94:95], v22 offset:38400
	v_mul_f32 v119, v119, v111
	v_cvt_pk_bf16_f32 v226, v116, v117
	v_cvt_pk_bf16_f32 v227, v118, v119
	v_mul_f32 v104, v120, v120
	v_mul_f32 v105, v121, v121
	s_add_u32 m0, s90, 24576
	s_add_u32 s54, s75, 28672
	buffer_load_dwordx4 v8, s[20:23], s54 offen  lds
	s_waitcnt lgkmcnt(4)
	v_mfma_f32_32x32x16_bf16 v[144:159], v[80:83], a[28:31], v[144:159]
	ds_read_b64_tr_b16 v[72:73], v22 offset:38912
	ds_read_b64_tr_b16 v[74:75], v22 offset:39936
	v_mul_f32 v106, v122, v122
	v_mul_f32 v107, v123, v123
	v_fma_f32 v104, v104, v19, v18
	v_fma_f32 v105, v105, v19, v18
	v_mfma_f32_32x32x16_bf16 v[160:175], v[84:87], a[28:31], v[160:175]
	ds_read_b64_tr_b16 v[76:77], v22 offset:39424
	ds_read_b64_tr_b16 v[78:79], v22 offset:40448
	v_fma_f32 v106, v106, v19, v18
	v_fma_f32 v107, v107, v19, v18
	v_mul_f32 v104, v104, v120
	v_mul_f32 v105, v105, v121
	s_add_u32 m0, s90, 28672
	s_add_u32 s54, s56, 57344
	buffer_load_dwordx4 v8, s[20:23], s54 offen  lds
	s_waitcnt lgkmcnt(4)
	v_mfma_f32_32x32x16_bf16 v[144:159], v[88:91], a[32:35], v[144:159]
	ds_read_b64_tr_b16 v[80:81], v22 offset:40960
	ds_read_b64_tr_b16 v[82:83], v22 offset:41984
	v_mul_f32 v106, v106, v122
	v_mul_f32 v107, v107, v123
	v_exp_f32 v104, v104
	v_exp_f32 v105, v105
	v_exp_f32 v106, v106
	v_mfma_f32_32x32x16_bf16 v[160:175], v[92:95], a[32:35], v[160:175]
	ds_read_b64_tr_b16 v[84:85], v22 offset:41472
	ds_read_b64_tr_b16 v[86:87], v22 offset:42496
	v_exp_f32 v107, v107
	v_fma_f32 v104, v104, v20, v20
	v_fma_f32 v105, v105, v20, v20
	v_fma_f32 v106, v106, v20, v20
	s_add_u32 m0, s90, 32768
	s_add_u32 s54, s56, 86016
	buffer_load_dwordx4 v8, s[20:23], s54 offen  lds
	s_waitcnt lgkmcnt(4)
	v_mfma_f32_32x32x16_bf16 v[144:159], v[72:75], a[36:39], v[144:159]
	ds_read_b64_tr_b16 v[88:89], v22 offset:43008
	ds_read_b64_tr_b16 v[90:91], v22 offset:44032
	v_fma_f32 v107, v107, v20, v20
	v_rcp_f32 v104, v104
	v_rcp_f32 v105, v105
	v_rcp_f32 v106, v106
	v_rcp_f32 v107, v107
	v_mfma_f32_32x32x16_bf16 v[160:175], v[76:79], a[36:39], v[160:175]
	ds_read_b64_tr_b16 v[92:93], v22 offset:43520
	ds_read_b64_tr_b16 v[94:95], v22 offset:44544
	v_mul_f32 v120, v120, v104
	v_mul_f32 v121, v121, v105
	v_mul_f32 v122, v122, v106
	v_mul_f32 v123, v123, v107
	s_add_u32 m0, s90, 36864
	s_add_u32 s54, s57, 57344
	buffer_load_dwordx4 v8, s[20:23], s54 offen  lds
	s_waitcnt lgkmcnt(4)
	v_mfma_f32_32x32x16_bf16 v[144:159], v[80:83], a[40:43], v[144:159]
	ds_read_b64_tr_b16 v[72:73], v22 offset:45056
	ds_read_b64_tr_b16 v[74:75], v22 offset:46080
	v_cvt_pk_bf16_f32 v228, v120, v121
	v_cvt_pk_bf16_f32 v229, v122, v123
	v_mul_f32 v108, v124, v124
	v_mul_f32 v109, v125, v125
	v_mul_f32 v110, v126, v126
	v_mfma_f32_32x32x16_bf16 v[160:175], v[84:87], a[40:43], v[160:175]
	ds_read_b64_tr_b16 v[76:77], v22 offset:45568
	ds_read_b64_tr_b16 v[78:79], v22 offset:46592
	v_mul_f32 v111, v127, v127
	v_fma_f32 v108, v108, v19, v18
	v_fma_f32 v109, v109, v19, v18
	v_fma_f32 v110, v110, v19, v18
	s_add_u32 m0, s90, 40960
	s_add_u32 s54, s57, 86016
	buffer_load_dwordx4 v8, s[20:23], s54 offen  lds
	s_waitcnt lgkmcnt(4)
	v_mfma_f32_32x32x16_bf16 v[144:159], v[88:91], a[44:47], v[144:159]
	ds_read_b64_tr_b16 v[80:81], v22 offset:47104
	ds_read_b64_tr_b16 v[82:83], v22 offset:48128
	v_fma_f32 v111, v111, v19, v18
	v_mul_f32 v108, v108, v124
	v_mul_f32 v109, v109, v125
	v_mul_f32 v110, v110, v126
	v_mul_f32 v111, v111, v127
	v_mfma_f32_32x32x16_bf16 v[160:175], v[92:95], a[44:47], v[160:175]
	ds_read_b64_tr_b16 v[84:85], v22 offset:47616
	ds_read_b64_tr_b16 v[86:87], v22 offset:48640
	v_exp_f32 v108, v108
	v_exp_f32 v109, v109
	v_exp_f32 v110, v110
	v_exp_f32 v111, v111
	s_add_u32 m0, s90, 45056
	s_add_u32 s54, s58, 57344
	buffer_load_dwordx4 v8, s[20:23], s54 offen  lds
	s_waitcnt lgkmcnt(4)
	v_mfma_f32_32x32x16_bf16 v[144:159], v[72:75], a[48:51], v[144:159]
	ds_read_b64_tr_b16 v[88:89], v22 offset:49152
	ds_read_b64_tr_b16 v[90:91], v22 offset:50176
	v_fma_f32 v108, v108, v20, v20
	v_fma_f32 v109, v109, v20, v20
	v_fma_f32 v110, v110, v20, v20
	v_fma_f32 v111, v111, v20, v20
	v_mfma_f32_32x32x16_bf16 v[160:175], v[76:79], a[48:51], v[160:175]
	ds_read_b64_tr_b16 v[92:93], v22 offset:49664
	ds_read_b64_tr_b16 v[94:95], v22 offset:50688
	v_rcp_f32 v108, v108
	v_rcp_f32 v109, v109
	v_rcp_f32 v110, v110
	v_rcp_f32 v111, v111
	v_mul_f32 v124, v124, v108
	s_add_u32 m0, s90, 49152
	s_add_u32 s54, s58, 86016
	buffer_load_dwordx4 v8, s[20:23], s54 offen  lds
	s_waitcnt lgkmcnt(4)
	v_mfma_f32_32x32x16_bf16 v[144:159], v[80:83], a[52:55], v[144:159]
	ds_read_b64_tr_b16 v[72:73], v22 offset:51200
	ds_read_b64_tr_b16 v[74:75], v22 offset:52224
	v_mul_f32 v125, v125, v109
	v_mul_f32 v126, v126, v110
	v_mul_f32 v127, v127, v111
	v_cvt_pk_bf16_f32 v230, v124, v125
	v_mfma_f32_32x32x16_bf16 v[160:175], v[84:87], a[52:55], v[160:175]
	ds_read_b64_tr_b16 v[76:77], v22 offset:51712
	ds_read_b64_tr_b16 v[78:79], v22 offset:52736
	v_cvt_pk_bf16_f32 v231, v126, v127
	buffer_store_dwordx4 v[224:227], v4, s[28:31], s50 offen offset:0 sc1
	buffer_store_dwordx4 v[228:231], v4, s[28:31], s50 offen offset:1024 sc1
	v_mul_f32 v104, v128, v128
	v_mul_f32 v105, v129, v129
	s_add_u32 m0, s90, 53248
	s_add_u32 s54, s59, 57344
	buffer_load_dwordx4 v8, s[20:23], s54 offen  lds
	s_waitcnt lgkmcnt(4)
	v_mfma_f32_32x32x16_bf16 v[144:159], v[88:91], a[56:59], v[144:159]
	ds_read_b64_tr_b16 v[80:81], v22 offset:53248
	ds_read_b64_tr_b16 v[82:83], v22 offset:54272
	v_mul_f32 v106, v130, v130
	v_mul_f32 v107, v131, v131
	v_fma_f32 v104, v104, v19, v18
	v_fma_f32 v105, v105, v19, v18
	v_mfma_f32_32x32x16_bf16 v[160:175], v[92:95], a[56:59], v[160:175]
	ds_read_b64_tr_b16 v[84:85], v22 offset:53760
	ds_read_b64_tr_b16 v[86:87], v22 offset:54784
	v_fma_f32 v106, v106, v19, v18
	v_fma_f32 v107, v107, v19, v18
	v_mul_f32 v104, v104, v128
	v_mul_f32 v105, v105, v129
	v_mul_f32 v106, v106, v130
	s_barrier
	s_add_u32 m0, s90, 86016
	s_add_u32 s54, s59, 86016
	buffer_load_dwordx4 v8, s[20:23], s54 offen  lds
	s_waitcnt lgkmcnt(4)
	v_mfma_f32_32x32x16_bf16 v[144:159], v[72:75], a[60:63], v[144:159]
	ds_read_b64_tr_b16 v[88:89], v22 offset:55296
	ds_read_b64_tr_b16 v[90:91], v22 offset:56320
	v_mul_f32 v107, v107, v131
	v_exp_f32 v104, v104
	v_exp_f32 v105, v105
	v_exp_f32 v106, v106
	v_mfma_f32_32x32x16_bf16 v[160:175], v[76:79], a[60:63], v[160:175]
	ds_read_b64_tr_b16 v[92:93], v22 offset:55808
	ds_read_b64_tr_b16 v[94:95], v22 offset:56832
	v_exp_f32 v107, v107
	v_fma_f32 v104, v104, v20, v20
	v_fma_f32 v105, v105, v20, v20
	v_fma_f32 v106, v106, v20, v20
	s_add_u32 m0, s90, 90112
	s_add_u32 s54, s60, 57344
	buffer_load_dwordx4 v8, s[20:23], s54 offen  lds
	s_waitcnt lgkmcnt(4)
	v_mfma_f32_32x32x16_bf16 v[144:159], v[80:83], a[64:67], v[144:159]
	ds_read_b64_tr_b16 v[72:73], v22 offset:57344
	ds_read_b64_tr_b16 v[74:75], v22 offset:58368
	v_fma_f32 v107, v107, v20, v20
	v_rcp_f32 v104, v104
	v_rcp_f32 v105, v105
	v_rcp_f32 v106, v106
	v_rcp_f32 v107, v107
	v_mfma_f32_32x32x16_bf16 v[160:175], v[84:87], a[64:67], v[160:175]
	ds_read_b64_tr_b16 v[76:77], v22 offset:57856
	ds_read_b64_tr_b16 v[78:79], v22 offset:58880
	v_mul_f32 v128, v128, v104
	v_mul_f32 v129, v129, v105
	v_mul_f32 v130, v130, v106
	v_mul_f32 v131, v131, v107
	s_add_u32 m0, s90, 94208
	s_add_u32 s54, s60, 86016
	buffer_load_dwordx4 v8, s[20:23], s54 offen  lds
	s_waitcnt lgkmcnt(4)
	v_mfma_f32_32x32x16_bf16 v[144:159], v[88:91], a[68:71], v[144:159]
	ds_read_b64_tr_b16 v[80:81], v22 offset:59392
	ds_read_b64_tr_b16 v[82:83], v22 offset:60416
	v_cvt_pk_bf16_f32 v232, v128, v129
	v_cvt_pk_bf16_f32 v233, v130, v131
	v_mul_f32 v108, v132, v132
	v_mul_f32 v109, v133, v133
	v_mul_f32 v110, v134, v134
	v_mfma_f32_32x32x16_bf16 v[160:175], v[92:95], a[68:71], v[160:175]
	ds_read_b64_tr_b16 v[84:85], v22 offset:59904
	ds_read_b64_tr_b16 v[86:87], v22 offset:60928
	v_mul_f32 v111, v135, v135
	v_fma_f32 v108, v108, v19, v18
	v_fma_f32 v109, v109, v19, v18
	v_fma_f32 v110, v110, v19, v18
	s_add_u32 m0, s90, 98304
	s_add_u32 s54, s61, 57344
	buffer_load_dwordx4 v8, s[20:23], s54 offen  lds
	s_waitcnt lgkmcnt(4)
	v_mfma_f32_32x32x16_bf16 v[144:159], v[72:75], a[72:75], v[144:159]
	ds_read_b64_tr_b16 v[88:89], v22 offset:61440
	ds_read_b64_tr_b16 v[90:91], v22 offset:62464
	v_fma_f32 v111, v111, v19, v18
	v_mul_f32 v108, v108, v132
	v_mul_f32 v109, v109, v133
	v_mul_f32 v110, v110, v134
	v_mul_f32 v111, v111, v135
	v_mfma_f32_32x32x16_bf16 v[160:175], v[76:79], a[72:75], v[160:175]
	ds_read_b64_tr_b16 v[92:93], v22 offset:61952
	ds_read_b64_tr_b16 v[94:95], v22 offset:62976
	v_exp_f32 v108, v108
	v_exp_f32 v109, v109
	v_exp_f32 v110, v110
	v_exp_f32 v111, v111
	s_add_u32 m0, s90, 102400
	s_add_u32 s54, s61, 86016
	buffer_load_dwordx4 v8, s[20:23], s54 offen  lds
	s_waitcnt lgkmcnt(4)
	v_mfma_f32_32x32x16_bf16 v[144:159], v[80:83], a[76:79], v[144:159]
	ds_read_b64_tr_b16 v[72:73], v22 offset:63488
	ds_read_b64_tr_b16 v[74:75], v22 offset:64512
	v_fma_f32 v108, v108, v20, v20
	v_fma_f32 v109, v109, v20, v20
	v_fma_f32 v110, v110, v20, v20
	v_fma_f32 v111, v111, v20, v20
	v_rcp_f32 v108, v108
	v_mfma_f32_32x32x16_bf16 v[160:175], v[84:87], a[76:79], v[160:175]
	ds_read_b64_tr_b16 v[76:77], v22 offset:64000
	ds_read_b64_tr_b16 v[78:79], v22 offset:65024
	v_rcp_f32 v109, v109
	v_rcp_f32 v110, v110
	v_rcp_f32 v111, v111
	v_mul_f32 v132, v132, v108
	s_add_u32 m0, s90, 106496
	s_add_u32 s54, s75, 57344
	buffer_load_dwordx4 v8, s[20:23], s54 offen  lds
	s_waitcnt lgkmcnt(4)
	v_mfma_f32_32x32x16_bf16 v[144:159], v[88:91], a[80:83], v[144:159]
	ds_read_b64_tr_b16 v[80:81], v23 offset:0
	ds_read_b64_tr_b16 v[82:83], v23 offset:1024
	v_mul_f32 v133, v133, v109
	v_mul_f32 v134, v134, v110
	v_mul_f32 v135, v135, v111
	v_cvt_pk_bf16_f32 v234, v132, v133
	v_mfma_f32_32x32x16_bf16 v[160:175], v[92:95], a[80:83], v[160:175]
	ds_read_b64_tr_b16 v[84:85], v23 offset:512
	ds_read_b64_tr_b16 v[86:87], v23 offset:1536
	v_cvt_pk_bf16_f32 v235, v134, v135
	v_mul_f32 v104, v136, v136
	v_mul_f32 v105, v137, v137
	v_mul_f32 v106, v138, v138
	v_mul_f32 v107, v139, v139
	s_add_u32 m0, s90, 110592
	s_add_u32 s54, s75, 86016
	buffer_load_dwordx4 v8, s[20:23], s54 offen  lds
	s_waitcnt lgkmcnt(4)
	v_mfma_f32_32x32x16_bf16 v[144:159], v[72:75], a[84:87], v[144:159]
	ds_read_b64_tr_b16 v[88:89], v23 offset:2048
	ds_read_b64_tr_b16 v[90:91], v23 offset:3072
	v_fma_f32 v104, v104, v19, v18
	v_fma_f32 v105, v105, v19, v18
	v_fma_f32 v106, v106, v19, v18
	v_fma_f32 v107, v107, v19, v18
	v_mfma_f32_32x32x16_bf16 v[160:175], v[76:79], a[84:87], v[160:175]
	ds_read_b64_tr_b16 v[92:93], v23 offset:2560
	ds_read_b64_tr_b16 v[94:95], v23 offset:3584
	v_mul_f32 v104, v104, v136
	v_mul_f32 v105, v105, v137
	v_mul_f32 v106, v106, v138
	v_mul_f32 v107, v107, v139
	v_exp_f32 v104, v104
	s_waitcnt lgkmcnt(4)
	v_mfma_f32_32x32x16_bf16 v[144:159], v[80:83], a[88:91], v[144:159]
	ds_read_b64_tr_b16 v[72:73], v23 offset:4096
	ds_read_b64_tr_b16 v[74:75], v23 offset:5120
	v_exp_f32 v105, v105
	v_exp_f32 v106, v106
	v_exp_f32 v107, v107
	v_fma_f32 v104, v104, v20, v20
	v_mfma_f32_32x32x16_bf16 v[160:175], v[84:87], a[88:91], v[160:175]
	ds_read_b64_tr_b16 v[76:77], v23 offset:4608
	ds_read_b64_tr_b16 v[78:79], v23 offset:5632
	v_fma_f32 v105, v105, v20, v20
	v_fma_f32 v106, v106, v20, v20
	v_fma_f32 v107, v107, v20, v20
	v_rcp_f32 v104, v104
	v_rcp_f32 v105, v105
	s_waitcnt lgkmcnt(4)
	v_mfma_f32_32x32x16_bf16 v[144:159], v[88:91], a[92:95], v[144:159]
	ds_read_b64_tr_b16 v[80:81], v23 offset:6144
	ds_read_b64_tr_b16 v[82:83], v23 offset:7168
	v_rcp_f32 v106, v106
	v_rcp_f32 v107, v107
	v_mul_f32 v136, v136, v104
	v_mul_f32 v137, v137, v105
	v_mfma_f32_32x32x16_bf16 v[160:175], v[92:95], a[92:95], v[160:175]
	ds_read_b64_tr_b16 v[84:85], v23 offset:6656
	ds_read_b64_tr_b16 v[86:87], v23 offset:7680
	v_mul_f32 v138, v138, v106
	v_mul_f32 v139, v139, v107
	v_cvt_pk_bf16_f32 v236, v136, v137
	v_cvt_pk_bf16_f32 v237, v138, v139
	buffer_store_dwordx4 v[96:99], v4, s[28:31], s53 offen offset:0 sc1
	buffer_store_dwordx4 v[96:99], v4, s[28:31], s53 offen offset:1024 sc1
	s_waitcnt lgkmcnt(4)
	v_mfma_f32_32x32x16_bf16 v[144:159], v[72:75], a[96:99], v[144:159]
	ds_read_b64_tr_b16 v[88:89], v23 offset:8192
	ds_read_b64_tr_b16 v[90:91], v23 offset:9216
	v_mul_f32 v108, v140, v140
	v_mul_f32 v109, v141, v141
	v_mul_f32 v110, v142, v142
	v_mul_f32 v111, v143, v143
	v_fma_f32 v108, v108, v19, v18
	v_mfma_f32_32x32x16_bf16 v[160:175], v[76:79], a[96:99], v[160:175]
	ds_read_b64_tr_b16 v[92:93], v23 offset:8704
	ds_read_b64_tr_b16 v[94:95], v23 offset:9728
	v_fma_f32 v109, v109, v19, v18
	v_fma_f32 v110, v110, v19, v18
	v_fma_f32 v111, v111, v19, v18
	v_mul_f32 v108, v108, v140
	s_waitcnt lgkmcnt(4)
	v_mfma_f32_32x32x16_bf16 v[144:159], v[80:83], a[100:103], v[144:159]
	ds_read_b64_tr_b16 v[72:73], v23 offset:10240
	ds_read_b64_tr_b16 v[74:75], v23 offset:11264
	v_mul_f32 v109, v109, v141
	v_mul_f32 v110, v110, v142
	v_mul_f32 v111, v111, v143
	v_exp_f32 v108, v108
	v_exp_f32 v109, v109
	v_mfma_f32_32x32x16_bf16 v[160:175], v[84:87], a[100:103], v[160:175]
	ds_read_b64_tr_b16 v[76:77], v23 offset:10752
	ds_read_b64_tr_b16 v[78:79], v23 offset:11776
	v_exp_f32 v110, v110
	v_exp_f32 v111, v111
	v_fma_f32 v108, v108, v20, v20
	v_fma_f32 v109, v109, v20, v20
	s_waitcnt lgkmcnt(4)
	v_mfma_f32_32x32x16_bf16 v[144:159], v[88:91], a[104:107], v[144:159]
	v_fma_f32 v110, v110, v20, v20
	v_fma_f32 v111, v111, v20, v20
	v_rcp_f32 v108, v108
	v_rcp_f32 v109, v109
	v_rcp_f32 v110, v110
	v_mfma_f32_32x32x16_bf16 v[160:175], v[92:95], a[104:107], v[160:175]
	v_rcp_f32 v111, v111
	v_mul_f32 v140, v140, v108
	v_mul_f32 v141, v141, v109
	v_mul_f32 v142, v142, v110
	s_waitcnt lgkmcnt(0)
	v_mfma_f32_32x32x16_bf16 v[144:159], v[72:75], a[108:111], v[144:159]
	v_mul_f32 v143, v143, v111
	v_cvt_pk_bf16_f32 v238, v140, v141
	v_cvt_pk_bf16_f32 v239, v142, v143
	buffer_store_dwordx4 v[232:235], v4, s[28:31], s50 offen offset:2048 sc1
	buffer_store_dwordx4 v[236:239], v4, s[28:31], s50 offen offset:3072 sc1
	v_mfma_f32_32x32x16_bf16 v[160:175], v[76:79], a[108:111], v[160:175]
	v_mfma_f32_32x32x16_bf16 v[144:159], v[60:63], v[68:71], v[144:159]
	v_mfma_f32_32x32x16_bf16 v[160:175], v[64:67], v[68:71], v[160:175]
	s_nop 10
	v_pk_mul_f32 v[104:105], v[144:145], v[144:145]
	v_pk_mul_f32 v[106:107], v[146:147], v[146:147]
	v_pk_mul_f32 v[108:109], v[148:149], v[148:149]
	v_pk_mul_f32 v[110:111], v[150:151], v[150:151]
	v_pk_fma_f32 v[104:105], v[104:105], v[18:19], v[18:19] op_sel:[0,1,0] op_sel_hi:[1,1,0]
	v_pk_fma_f32 v[106:107], v[106:107], v[18:19], v[18:19] op_sel:[0,1,0] op_sel_hi:[1,1,0]
	v_pk_fma_f32 v[108:109], v[108:109], v[18:19], v[18:19] op_sel:[0,1,0] op_sel_hi:[1,1,0]
	v_pk_fma_f32 v[110:111], v[110:111], v[18:19], v[18:19] op_sel:[0,1,0] op_sel_hi:[1,1,0]
	v_pk_mul_f32 v[104:105], v[104:105], v[144:145]
	v_pk_mul_f32 v[106:107], v[106:107], v[146:147]
	v_pk_mul_f32 v[108:109], v[108:109], v[148:149]
	v_pk_mul_f32 v[110:111], v[110:111], v[150:151]
	v_exp_f32 v104, v104
	v_exp_f32 v105, v105
	v_exp_f32 v106, v106
	v_exp_f32 v107, v107
	v_exp_f32 v108, v108
	v_exp_f32 v109, v109
	v_exp_f32 v110, v110
	v_exp_f32 v111, v111
	v_pk_fma_f32 v[104:105], v[104:105], v[20:21], v[20:21] op_sel_hi:[1,0,0]
	v_pk_fma_f32 v[106:107], v[106:107], v[20:21], v[20:21] op_sel_hi:[1,0,0]
	v_pk_fma_f32 v[108:109], v[108:109], v[20:21], v[20:21] op_sel_hi:[1,0,0]
	v_pk_fma_f32 v[110:111], v[110:111], v[20:21], v[20:21] op_sel_hi:[1,0,0]
	v_rcp_f32 v104, v104
	v_rcp_f32 v105, v105
	v_rcp_f32 v106, v106
	v_rcp_f32 v107, v107
	v_rcp_f32 v108, v108
	v_rcp_f32 v109, v109
	v_rcp_f32 v110, v110
	v_rcp_f32 v111, v111
	v_pk_mul_f32 v[144:145], v[144:145], v[104:105]
	v_pk_mul_f32 v[146:147], v[146:147], v[106:107]
	v_pk_mul_f32 v[148:149], v[148:149], v[108:109]
	v_pk_mul_f32 v[150:151], v[150:151], v[110:111]
	v_cvt_pk_bf16_f32 v240, v144, v145
	v_cvt_pk_bf16_f32 v241, v146, v147
	v_cvt_pk_bf16_f32 v242, v148, v149
	v_cvt_pk_bf16_f32 v243, v150, v151
	s_waitcnt vmcnt(0)
	s_mov_b64 exec, 1
	buffer_store_dword v11, off, s[28:31], s74 offset:256 sc1
	s_mov_b64 exec, -1
	v_pk_mul_f32 v[104:105], v[152:153], v[152:153]
	v_pk_mul_f32 v[106:107], v[154:155], v[154:155]
	v_pk_mul_f32 v[108:109], v[156:157], v[156:157]
	v_pk_mul_f32 v[110:111], v[158:159], v[158:159]
	v_pk_fma_f32 v[104:105], v[104:105], v[18:19], v[18:19] op_sel:[0,1,0] op_sel_hi:[1,1,0]
	v_pk_fma_f32 v[106:107], v[106:107], v[18:19], v[18:19] op_sel:[0,1,0] op_sel_hi:[1,1,0]
	v_pk_fma_f32 v[108:109], v[108:109], v[18:19], v[18:19] op_sel:[0,1,0] op_sel_hi:[1,1,0]
	v_pk_fma_f32 v[110:111], v[110:111], v[18:19], v[18:19] op_sel:[0,1,0] op_sel_hi:[1,1,0]
	v_pk_mul_f32 v[104:105], v[104:105], v[152:153]
	v_pk_mul_f32 v[106:107], v[106:107], v[154:155]
	v_pk_mul_f32 v[108:109], v[108:109], v[156:157]
	v_pk_mul_f32 v[110:111], v[110:111], v[158:159]
	v_exp_f32 v104, v104
	v_exp_f32 v105, v105
	v_exp_f32 v106, v106
	v_exp_f32 v107, v107
	v_exp_f32 v108, v108
	v_exp_f32 v109, v109
	v_exp_f32 v110, v110
	v_exp_f32 v111, v111
	v_pk_fma_f32 v[104:105], v[104:105], v[20:21], v[20:21] op_sel_hi:[1,0,0]
	v_pk_fma_f32 v[106:107], v[106:107], v[20:21], v[20:21] op_sel_hi:[1,0,0]
	v_pk_fma_f32 v[108:109], v[108:109], v[20:21], v[20:21] op_sel_hi:[1,0,0]
	v_pk_fma_f32 v[110:111], v[110:111], v[20:21], v[20:21] op_sel_hi:[1,0,0]
	v_rcp_f32 v104, v104
	v_rcp_f32 v105, v105
	v_rcp_f32 v106, v106
	v_rcp_f32 v107, v107
	v_rcp_f32 v108, v108
	v_rcp_f32 v109, v109
	v_rcp_f32 v110, v110
	v_rcp_f32 v111, v111
	v_pk_mul_f32 v[152:153], v[152:153], v[104:105]
	v_pk_mul_f32 v[154:155], v[154:155], v[106:107]
	v_pk_mul_f32 v[156:157], v[156:157], v[108:109]
	v_pk_mul_f32 v[158:159], v[158:159], v[110:111]
	v_cvt_pk_bf16_f32 v244, v152, v153
	v_cvt_pk_bf16_f32 v245, v154, v155
	v_cvt_pk_bf16_f32 v246, v156, v157
	v_cvt_pk_bf16_f32 v247, v158, v159
Lpoll_87:
	buffer_load_dword v14, v15, s[28:31], s73 offen offset:256 sc1
	s_waitcnt vmcnt(0)
	v_cmp_ne_u32 vcc, s65, v14
	s_nop 0
	s_cbranch_vccz Lpdone_88
	s_sub_u32 s67, s67, 1
	s_cbranch_scc0 Lpoll_87
	s_mov_b32 s67, 0
Lpdone_88:
	buffer_load_dwordx4 a[0:3], v4, s[28:31], s41 offen offset:0 sc1
	buffer_load_dwordx4 a[4:7], v4, s[28:31], s41 offen offset:1024 sc1
	buffer_load_dwordx4 a[8:11], v4, s[28:31], s41 offen offset:2048 sc1
	buffer_load_dwordx4 a[12:15], v4, s[28:31], s41 offen offset:3072 sc1
	buffer_load_dwordx4 a[16:19], v4, s[28:31], s42 offen offset:0 sc1
	buffer_load_dwordx4 a[20:23], v4, s[28:31], s42 offen offset:1024 sc1
	buffer_load_dwordx4 a[24:27], v4, s[28:31], s42 offen offset:2048 sc1
	buffer_load_dwordx4 a[28:31], v4, s[28:31], s42 offen offset:3072 sc1
	buffer_store_dwordx4 v[240:243], v4, s[28:31], s51 offen offset:0 sc1
	buffer_store_dwordx4 v[244:247], v4, s[28:31], s51 offen offset:1024 sc1
	v_pk_mul_f32 v[104:105], v[160:161], v[160:161]
	v_pk_mul_f32 v[106:107], v[162:163], v[162:163]
	v_pk_mul_f32 v[108:109], v[164:165], v[164:165]
	v_pk_mul_f32 v[110:111], v[166:167], v[166:167]
	v_pk_fma_f32 v[104:105], v[104:105], v[18:19], v[18:19] op_sel:[0,1,0] op_sel_hi:[1,1,0]
	v_pk_fma_f32 v[106:107], v[106:107], v[18:19], v[18:19] op_sel:[0,1,0] op_sel_hi:[1,1,0]
	v_pk_fma_f32 v[108:109], v[108:109], v[18:19], v[18:19] op_sel:[0,1,0] op_sel_hi:[1,1,0]
	v_pk_fma_f32 v[110:111], v[110:111], v[18:19], v[18:19] op_sel:[0,1,0] op_sel_hi:[1,1,0]
	v_pk_mul_f32 v[104:105], v[104:105], v[160:161]
	v_pk_mul_f32 v[106:107], v[106:107], v[162:163]
	v_pk_mul_f32 v[108:109], v[108:109], v[164:165]
	v_pk_mul_f32 v[110:111], v[110:111], v[166:167]
	v_exp_f32 v104, v104
	v_exp_f32 v105, v105
	v_exp_f32 v106, v106
	v_exp_f32 v107, v107
	v_exp_f32 v108, v108
	v_exp_f32 v109, v109
	v_exp_f32 v110, v110
	v_exp_f32 v111, v111
	buffer_load_dwordx4 a[32:35], v4, s[28:31], s43 offen offset:0 sc1
	v_pk_fma_f32 v[104:105], v[104:105], v[20:21], v[20:21] op_sel_hi:[1,0,0]
	v_pk_fma_f32 v[106:107], v[106:107], v[20:21], v[20:21] op_sel_hi:[1,0,0]
	v_pk_fma_f32 v[108:109], v[108:109], v[20:21], v[20:21] op_sel_hi:[1,0,0]
	v_pk_fma_f32 v[110:111], v[110:111], v[20:21], v[20:21] op_sel_hi:[1,0,0]
	v_rcp_f32 v104, v104
	v_rcp_f32 v105, v105
	buffer_load_dwordx4 a[36:39], v4, s[28:31], s43 offen offset:1024 sc1
	v_rcp_f32 v106, v106
	v_rcp_f32 v107, v107
	v_rcp_f32 v108, v108
	v_rcp_f32 v109, v109
	v_rcp_f32 v110, v110
	v_rcp_f32 v111, v111
	v_pk_mul_f32 v[160:161], v[160:161], v[104:105]
	buffer_load_dwordx4 a[40:43], v4, s[28:31], s43 offen offset:2048 sc1
	v_pk_mul_f32 v[162:163], v[162:163], v[106:107]
	v_pk_mul_f32 v[164:165], v[164:165], v[108:109]
	v_pk_mul_f32 v[166:167], v[166:167], v[110:111]
	v_cvt_pk_bf16_f32 v248, v160, v161
	v_cvt_pk_bf16_f32 v249, v162, v163
	v_cvt_pk_bf16_f32 v250, v164, v165
	v_cvt_pk_bf16_f32 v251, v166, v167
	buffer_load_dwordx4 a[44:47], v4, s[28:31], s43 offen offset:3072 sc1
	v_pk_mul_f32 v[104:105], v[168:169], v[168:169]
	v_pk_mul_f32 v[106:107], v[170:171], v[170:171]
	v_pk_mul_f32 v[108:109], v[172:173], v[172:173]
	v_pk_mul_f32 v[110:111], v[174:175], v[174:175]
	v_pk_fma_f32 v[104:105], v[104:105], v[18:19], v[18:19] op_sel:[0,1,0] op_sel_hi:[1,1,0]
	v_pk_fma_f32 v[106:107], v[106:107], v[18:19], v[18:19] op_sel:[0,1,0] op_sel_hi:[1,1,0]
	buffer_load_dwordx4 a[48:51], v4, s[28:31], s44 offen offset:0 sc1
	v_pk_fma_f32 v[108:109], v[108:109], v[18:19], v[18:19] op_sel:[0,1,0] op_sel_hi:[1,1,0]
	v_pk_fma_f32 v[110:111], v[110:111], v[18:19], v[18:19] op_sel:[0,1,0] op_sel_hi:[1,1,0]
	v_pk_mul_f32 v[104:105], v[104:105], v[168:169]
	v_pk_mul_f32 v[106:107], v[106:107], v[170:171]
	v_pk_mul_f32 v[108:109], v[108:109], v[172:173]
	v_pk_mul_f32 v[110:111], v[110:111], v[174:175]
	v_exp_f32 v104, v104
	buffer_load_dwordx4 a[52:55], v4, s[28:31], s44 offen offset:1024 sc1
	v_exp_f32 v105, v105
	v_exp_f32 v106, v106
	v_exp_f32 v107, v107
	v_exp_f32 v108, v108
	v_exp_f32 v109, v109
	v_exp_f32 v110, v110
	v_exp_f32 v111, v111
	buffer_load_dwordx4 a[56:59], v4, s[28:31], s44 offen offset:2048 sc1
	v_pk_fma_f32 v[104:105], v[104:105], v[20:21], v[20:21] op_sel_hi:[1,0,0]
	v_pk_fma_f32 v[106:107], v[106:107], v[20:21], v[20:21] op_sel_hi:[1,0,0]
	v_pk_fma_f32 v[108:109], v[108:109], v[20:21], v[20:21] op_sel_hi:[1,0,0]
	v_pk_fma_f32 v[110:111], v[110:111], v[20:21], v[20:21] op_sel_hi:[1,0,0]
	v_rcp_f32 v104, v104
	v_rcp_f32 v105, v105
	buffer_load_dwordx4 a[60:63], v4, s[28:31], s44 offen offset:3072 sc1
	v_rcp_f32 v106, v106
	v_rcp_f32 v107, v107
	v_rcp_f32 v108, v108
	v_rcp_f32 v109, v109
	v_rcp_f32 v110, v110
	v_rcp_f32 v111, v111
	v_pk_mul_f32 v[168:169], v[168:169], v[104:105]
	buffer_load_dwordx4 a[64:67], v4, s[28:31], s45 offen offset:0 sc1
	v_pk_mul_f32 v[170:171], v[170:171], v[106:107]
	v_pk_mul_f32 v[172:173], v[172:173], v[108:109]
	v_pk_mul_f32 v[174:175], v[174:175], v[110:111]
	v_cvt_pk_bf16_f32 v252, v168, v169
	v_cvt_pk_bf16_f32 v253, v170, v171
	v_cvt_pk_bf16_f32 v254, v172, v173
	v_cvt_pk_bf16_f32 v255, v174, v175
	buffer_store_dwordx4 v[248:251], v4, s[28:31], s51 offen offset:2048 sc1
	buffer_store_dwordx4 v[252:255], v4, s[28:31], s51 offen offset:3072 sc1
	v_mfma_f32_32x32x16_bf16 v[24:39], a[240:243], a[248:251], v[24:39]
	v_mfma_f32_32x32x16_bf16 v[24:39], a[244:247], a[252:255], v[24:39]
	s_barrier
	ds_read_b64_tr_b16 v[72:73], v21 offset:57344
	ds_read_b64_tr_b16 v[74:75], v21 offset:58368
	ds_read_b64_tr_b16 v[76:77], v21 offset:57856
	ds_read_b64_tr_b16 v[78:79], v21 offset:58880
	ds_read_b64_tr_b16 v[80:81], v21 offset:59392
	ds_read_b64_tr_b16 v[82:83], v21 offset:60416
	ds_read_b64_tr_b16 v[84:85], v21 offset:59904
	ds_read_b64_tr_b16 v[86:87], v21 offset:60928
	buffer_load_dwordx4 a[68:71], v4, s[28:31], s45 offen offset:1024 sc1
	s_waitcnt lgkmcnt(4)
	v_mfma_f32_32x32x16_bf16 v[176:191], v[72:75], v[224:227], 0
	ds_read_b64_tr_b16 v[88:89], v21 offset:61440
	ds_read_b64_tr_b16 v[90:91], v21 offset:62464
	v_mfma_f32_32x32x16_bf16 v[24:39], v[76:79], v[224:227], v[24:39]
	ds_read_b64_tr_b16 v[92:93], v21 offset:61952
	ds_read_b64_tr_b16 v[94:95], v21 offset:62976
	buffer_load_dwordx4 a[72:75], v4, s[28:31], s45 offen offset:2048 sc1
	s_waitcnt lgkmcnt(4)
	v_mfma_f32_32x32x16_bf16 v[176:191], v[80:83], v[228:231], v[176:191]
	ds_read_b64_tr_b16 v[72:73], v21 offset:63488
	ds_read_b64_tr_b16 v[74:75], v21 offset:64512
	v_mfma_f32_32x32x16_bf16 v[24:39], v[84:87], v[228:231], v[24:39]
	ds_read_b64_tr_b16 v[76:77], v21 offset:64000
	ds_read_b64_tr_b16 v[78:79], v21 offset:65024
	buffer_load_dwordx4 a[76:79], v4, s[28:31], s45 offen offset:3072 sc1
	s_waitcnt lgkmcnt(4)
	v_mfma_f32_32x32x16_bf16 v[176:191], v[88:91], v[232:235], v[176:191]
	ds_read_b64_tr_b16 v[80:81], v22 offset:0
	ds_read_b64_tr_b16 v[82:83], v22 offset:1024
	v_mfma_f32_32x32x16_bf16 v[24:39], v[92:95], v[232:235], v[24:39]
	ds_read_b64_tr_b16 v[84:85], v22 offset:512
	ds_read_b64_tr_b16 v[86:87], v22 offset:1536
	buffer_load_dwordx4 a[80:83], v4, s[28:31], s46 offen offset:0 sc1
	s_waitcnt lgkmcnt(4)
	v_mfma_f32_32x32x16_bf16 v[176:191], v[72:75], v[236:239], v[176:191]
	ds_read_b64_tr_b16 v[88:89], v22 offset:2048
	ds_read_b64_tr_b16 v[90:91], v22 offset:3072
	v_mfma_f32_32x32x16_bf16 v[24:39], v[76:79], v[236:239], v[24:39]
	ds_read_b64_tr_b16 v[92:93], v22 offset:2560
	ds_read_b64_tr_b16 v[94:95], v22 offset:3584
	buffer_load_dwordx4 a[84:87], v4, s[28:31], s46 offen offset:1024 sc1
	s_waitcnt lgkmcnt(4) vmcnt(25)
	v_mfma_f32_32x32x16_bf16 v[176:191], v[80:83], a[0:3], v[176:191]
	ds_read_b64_tr_b16 v[72:73], v22 offset:4096
	ds_read_b64_tr_b16 v[74:75], v22 offset:5120
	v_mfma_f32_32x32x16_bf16 v[24:39], v[84:87], a[0:3], v[24:39]
	ds_read_b64_tr_b16 v[76:77], v22 offset:4608
	ds_read_b64_tr_b16 v[78:79], v22 offset:5632
	buffer_load_dwordx4 a[88:91], v4, s[28:31], s46 offen offset:2048 sc1
	s_waitcnt lgkmcnt(4) vmcnt(25)
	v_mfma_f32_32x32x16_bf16 v[176:191], v[88:91], a[4:7], v[176:191]
	ds_read_b64_tr_b16 v[80:81], v22 offset:6144
	ds_read_b64_tr_b16 v[82:83], v22 offset:7168
	v_mfma_f32_32x32x16_bf16 v[24:39], v[92:95], a[4:7], v[24:39]
	ds_read_b64_tr_b16 v[84:85], v22 offset:6656
	ds_read_b64_tr_b16 v[86:87], v22 offset:7680
	buffer_load_dwordx4 a[92:95], v4, s[28:31], s46 offen offset:3072 sc1
	s_waitcnt lgkmcnt(4) vmcnt(25)
	v_mfma_f32_32x32x16_bf16 v[176:191], v[72:75], a[8:11], v[176:191]
	ds_read_b64_tr_b16 v[88:89], v22 offset:8192
	ds_read_b64_tr_b16 v[90:91], v22 offset:9216
	v_mfma_f32_32x32x16_bf16 v[24:39], v[76:79], a[8:11], v[24:39]
	ds_read_b64_tr_b16 v[92:93], v22 offset:8704
	ds_read_b64_tr_b16 v[94:95], v22 offset:9728
	s_waitcnt lgkmcnt(4) vmcnt(24)
	v_mfma_f32_32x32x16_bf16 v[176:191], v[80:83], a[12:15], v[176:191]
	ds_read_b64_tr_b16 v[72:73], v22 offset:10240
	ds_read_b64_tr_b16 v[74:75], v22 offset:11264
	v_mfma_f32_32x32x16_bf16 v[24:39], v[84:87], a[12:15], v[24:39]
	ds_read_b64_tr_b16 v[76:77], v22 offset:10752
	ds_read_b64_tr_b16 v[78:79], v22 offset:11776
	s_waitcnt lgkmcnt(4) vmcnt(23)
	v_mfma_f32_32x32x16_bf16 v[176:191], v[88:91], a[16:19], v[176:191]
	ds_read_b64_tr_b16 v[80:81], v22 offset:12288
	ds_read_b64_tr_b16 v[82:83], v22 offset:13312
	v_mfma_f32_32x32x16_bf16 v[24:39], v[92:95], a[16:19], v[24:39]
	ds_read_b64_tr_b16 v[84:85], v22 offset:12800
	ds_read_b64_tr_b16 v[86:87], v22 offset:13824
	s_waitcnt lgkmcnt(4) vmcnt(22)
	v_mfma_f32_32x32x16_bf16 v[176:191], v[72:75], a[20:23], v[176:191]
	ds_read_b64_tr_b16 v[88:89], v22 offset:14336
	ds_read_b64_tr_b16 v[90:91], v22 offset:15360
	v_mfma_f32_32x32x16_bf16 v[24:39], v[76:79], a[20:23], v[24:39]
	ds_read_b64_tr_b16 v[92:93], v22 offset:14848
	ds_read_b64_tr_b16 v[94:95], v22 offset:15872
	s_waitcnt lgkmcnt(4) vmcnt(21)
	v_mfma_f32_32x32x16_bf16 v[176:191], v[80:83], a[24:27], v[176:191]
	ds_read_b64_tr_b16 v[72:73], v22 offset:16384
	ds_read_b64_tr_b16 v[74:75], v22 offset:17408
	v_mfma_f32_32x32x16_bf16 v[24:39], v[84:87], a[24:27], v[24:39]
	ds_read_b64_tr_b16 v[76:77], v22 offset:16896
	ds_read_b64_tr_b16 v[78:79], v22 offset:17920
	s_waitcnt lgkmcnt(4) vmcnt(20)
	v_mfma_f32_32x32x16_bf16 v[176:191], v[88:91], a[28:31], v[176:191]
	ds_read_b64_tr_b16 v[80:81], v22 offset:18432
	ds_read_b64_tr_b16 v[82:83], v22 offset:19456
	v_mfma_f32_32x32x16_bf16 v[24:39], v[92:95], a[28:31], v[24:39]
	ds_read_b64_tr_b16 v[84:85], v22 offset:18944
	ds_read_b64_tr_b16 v[86:87], v22 offset:19968
	s_waitcnt vmcnt(7)
	s_mov_b64 exec, 1
	buffer_store_dword v11, off, s[28:31], s74 offset:384 sc1
	s_mov_b64 exec, -1
	s_waitcnt lgkmcnt(4)
	v_mfma_f32_32x32x16_bf16 v[176:191], v[72:75], a[32:35], v[176:191]
	ds_read_b64_tr_b16 v[88:89], v21 offset:0
	ds_read_b64_tr_b16 v[90:91], v21 offset:1024
	v_mfma_f32_32x32x16_bf16 v[24:39], v[76:79], a[32:35], v[24:39]
	ds_read_b64_tr_b16 v[92:93], v21 offset:512
	ds_read_b64_tr_b16 v[94:95], v21 offset:1536
	s_waitcnt lgkmcnt(4)
	v_mfma_f32_32x32x16_bf16 v[176:191], v[80:83], a[36:39], v[176:191]
	ds_read_b64_tr_b16 v[72:73], v21 offset:2048
	ds_read_b64_tr_b16 v[74:75], v21 offset:3072
	v_mfma_f32_32x32x16_bf16 v[24:39], v[84:87], a[36:39], v[24:39]
	ds_read_b64_tr_b16 v[76:77], v21 offset:2560
	ds_read_b64_tr_b16 v[78:79], v21 offset:3584
	s_waitcnt lgkmcnt(4)
	v_mfma_f32_32x32x16_bf16 v[176:191], v[88:91], a[40:43], v[176:191]
	ds_read_b64_tr_b16 v[80:81], v21 offset:4096
	ds_read_b64_tr_b16 v[82:83], v21 offset:5120
	v_mfma_f32_32x32x16_bf16 v[24:39], v[92:95], a[40:43], v[24:39]
	ds_read_b64_tr_b16 v[84:85], v21 offset:4608
	ds_read_b64_tr_b16 v[86:87], v21 offset:5632
	s_waitcnt lgkmcnt(4)
	v_mfma_f32_32x32x16_bf16 v[176:191], v[72:75], a[44:47], v[176:191]
	ds_read_b64_tr_b16 v[88:89], v21 offset:6144
	ds_read_b64_tr_b16 v[90:91], v21 offset:7168
	v_mfma_f32_32x32x16_bf16 v[24:39], v[76:79], a[44:47], v[24:39]
	ds_read_b64_tr_b16 v[92:93], v21 offset:6656
	ds_read_b64_tr_b16 v[94:95], v21 offset:7680
	s_waitcnt lgkmcnt(4)
	v_mfma_f32_32x32x16_bf16 v[176:191], v[80:83], a[48:51], v[176:191]
	ds_read_b64_tr_b16 v[72:73], v21 offset:8192
	ds_read_b64_tr_b16 v[74:75], v21 offset:9216
	v_mfma_f32_32x32x16_bf16 v[24:39], v[84:87], a[48:51], v[24:39]
	ds_read_b64_tr_b16 v[76:77], v21 offset:8704
	ds_read_b64_tr_b16 v[78:79], v21 offset:9728
	s_waitcnt lgkmcnt(4)
	v_mfma_f32_32x32x16_bf16 v[176:191], v[88:91], a[52:55], v[176:191]
	ds_read_b64_tr_b16 v[80:81], v21 offset:10240
	ds_read_b64_tr_b16 v[82:83], v21 offset:11264
	v_mfma_f32_32x32x16_bf16 v[24:39], v[92:95], a[52:55], v[24:39]
	ds_read_b64_tr_b16 v[84:85], v21 offset:10752
	ds_read_b64_tr_b16 v[86:87], v21 offset:11776
	s_waitcnt lgkmcnt(4)
	v_mfma_f32_32x32x16_bf16 v[176:191], v[72:75], a[56:59], v[176:191]
	ds_read_b64_tr_b16 v[88:89], v21 offset:12288
	ds_read_b64_tr_b16 v[90:91], v21 offset:13312
	v_mfma_f32_32x32x16_bf16 v[24:39], v[76:79], a[56:59], v[24:39]
	ds_read_b64_tr_b16 v[92:93], v21 offset:12800
	ds_read_b64_tr_b16 v[94:95], v21 offset:13824
	buffer_load_dword v14, v15, s[28:31], s73 offen offset:384 sc1
	s_waitcnt lgkmcnt(4)
	v_mfma_f32_32x32x16_bf16 v[176:191], v[80:83], a[60:63], v[176:191]
	ds_read_b64_tr_b16 v[72:73], v21 offset:14336
	ds_read_b64_tr_b16 v[74:75], v21 offset:15360
	v_mfma_f32_32x32x16_bf16 v[24:39], v[84:87], a[60:63], v[24:39]
	ds_read_b64_tr_b16 v[76:77], v21 offset:14848
	ds_read_b64_tr_b16 v[78:79], v21 offset:15872
	s_waitcnt lgkmcnt(4)
	v_mfma_f32_32x32x16_bf16 v[176:191], v[88:91], a[64:67], v[176:191]
	ds_read_b64_tr_b16 v[80:81], v21 offset:16384
	ds_read_b64_tr_b16 v[82:83], v21 offset:17408
	v_mfma_f32_32x32x16_bf16 v[24:39], v[92:95], a[64:67], v[24:39]
	ds_read_b64_tr_b16 v[84:85], v21 offset:16896
	ds_read_b64_tr_b16 v[86:87], v21 offset:17920
	s_waitcnt lgkmcnt(4) vmcnt(8)
	v_mfma_f32_32x32x16_bf16 v[176:191], v[72:75], a[68:71], v[176:191]
	ds_read_b64_tr_b16 v[88:89], v21 offset:18432
	ds_read_b64_tr_b16 v[90:91], v21 offset:19456
	v_mfma_f32_32x32x16_bf16 v[24:39], v[76:79], a[68:71], v[24:39]
	ds_read_b64_tr_b16 v[92:93], v21 offset:18944
	ds_read_b64_tr_b16 v[94:95], v21 offset:19968
	s_waitcnt lgkmcnt(4) vmcnt(7)
	v_mfma_f32_32x32x16_bf16 v[176:191], v[80:83], a[72:75], v[176:191]
	ds_read_b64_tr_b16 v[72:73], v21 offset:20480
	ds_read_b64_tr_b16 v[74:75], v21 offset:21504
	v_mfma_f32_32x32x16_bf16 v[24:39], v[84:87], a[72:75], v[24:39]
	ds_read_b64_tr_b16 v[76:77], v21 offset:20992
	ds_read_b64_tr_b16 v[78:79], v21 offset:22016
	s_waitcnt vmcnt(0)
	v_cmp_ne_u32 vcc, s65, v14
	s_nop 0
	s_cbranch_vccnz Lh1slow_89
Lh1ok_90:
	s_add_u32 s41, s41, 4096
	buffer_load_dwordx4 a[96:99], v4, s[28:31], s41 offen offset:0 sc1
	buffer_load_dwordx4 a[100:103], v4, s[28:31], s41 offen offset:1024 sc1
	buffer_load_dwordx4 a[104:107], v4, s[28:31], s41 offen offset:2048 sc1
	buffer_load_dwordx4 a[108:111], v4, s[28:31], s41 offen offset:3072 sc1
	s_waitcnt lgkmcnt(4)
	v_mfma_f32_32x32x16_bf16 v[176:191], v[88:91], a[76:79], v[176:191]
	ds_read_b64_tr_b16 v[80:81], v21 offset:22528
	ds_read_b64_tr_b16 v[82:83], v21 offset:23552
	v_mfma_f32_32x32x16_bf16 v[24:39], v[92:95], a[76:79], v[24:39]
	ds_read_b64_tr_b16 v[84:85], v21 offset:23040
	ds_read_b64_tr_b16 v[86:87], v21 offset:24064
	s_add_u32 s42, s42, 4096
	buffer_load_dwordx4 a[112:115], v4, s[28:31], s42 offen offset:0 sc1
	s_waitcnt lgkmcnt(4)
	v_mfma_f32_32x32x16_bf16 v[176:191], v[72:75], a[80:83], v[176:191]
	ds_read_b64_tr_b16 v[88:89], v21 offset:24576
	ds_read_b64_tr_b16 v[90:91], v21 offset:25600
	v_mfma_f32_32x32x16_bf16 v[24:39], v[76:79], a[80:83], v[24:39]
	ds_read_b64_tr_b16 v[92:93], v21 offset:25088
	ds_read_b64_tr_b16 v[94:95], v21 offset:26112
	buffer_load_dwordx4 a[116:119], v4, s[28:31], s42 offen offset:1024 sc1
	s_waitcnt lgkmcnt(4)
	v_mfma_f32_32x32x16_bf16 v[176:191], v[80:83], a[84:87], v[176:191]
	ds_read_b64_tr_b16 v[72:73], v21 offset:26624
	ds_read_b64_tr_b16 v[74:75], v21 offset:27648
	v_mfma_f32_32x32x16_bf16 v[24:39], v[84:87], a[84:87], v[24:39]
	ds_read_b64_tr_b16 v[76:77], v21 offset:27136
	ds_read_b64_tr_b16 v[78:79], v21 offset:28160
	buffer_load_dwordx4 a[120:123], v4, s[28:31], s42 offen offset:2048 sc1
	s_waitcnt lgkmcnt(4)
	v_mfma_f32_32x32x16_bf16 v[176:191], v[88:91], a[88:91], v[176:191]
	ds_read_b64_tr_b16 v[80:81], v21 offset:28672
	ds_read_b64_tr_b16 v[82:83], v21 offset:29696
	v_mfma_f32_32x32x16_bf16 v[24:39], v[92:95], a[88:91], v[24:39]
	ds_read_b64_tr_b16 v[84:85], v21 offset:29184
	ds_read_b64_tr_b16 v[86:87], v21 offset:30208
	buffer_load_dwordx4 a[124:127], v4, s[28:31], s42 offen offset:3072 sc1
	s_waitcnt lgkmcnt(4)
	v_mfma_f32_32x32x16_bf16 v[176:191], v[72:75], a[92:95], v[176:191]
	ds_read_b64_tr_b16 v[88:89], v21 offset:30720
	ds_read_b64_tr_b16 v[90:91], v21 offset:31744
	v_mfma_f32_32x32x16_bf16 v[24:39], v[76:79], a[92:95], v[24:39]
	ds_read_b64_tr_b16 v[92:93], v21 offset:31232
	ds_read_b64_tr_b16 v[94:95], v21 offset:32256
	s_add_u32 s43, s43, 4096
	buffer_load_dwordx4 a[0:3], v4, s[28:31], s43 offen offset:0 sc1
	s_waitcnt lgkmcnt(4)
	v_mfma_f32_32x32x16_bf16 v[176:191], v[80:83], v[240:243], v[176:191]
	ds_read_b64_tr_b16 v[72:73], v21 offset:32768
	ds_read_b64_tr_b16 v[74:75], v21 offset:33792
	v_mfma_f32_32x32x16_bf16 v[24:39], v[84:87], v[240:243], v[24:39]
	ds_read_b64_tr_b16 v[76:77], v21 offset:33280
	ds_read_b64_tr_b16 v[78:79], v21 offset:34304
	buffer_load_dwordx4 a[4:7], v4, s[28:31], s43 offen offset:1024 sc1
	s_waitcnt lgkmcnt(4)
	v_mfma_f32_32x32x16_bf16 v[176:191], v[88:91], v[244:247], v[176:191]
	ds_read_b64_tr_b16 v[80:81], v21 offset:34816
	ds_read_b64_tr_b16 v[82:83], v21 offset:35840
	v_mfma_f32_32x32x16_bf16 v[24:39], v[92:95], v[244:247], v[24:39]
	ds_read_b64_tr_b16 v[84:85], v21 offset:35328
	ds_read_b64_tr_b16 v[86:87], v21 offset:36352
	buffer_load_dwordx4 a[8:11], v4, s[28:31], s43 offen offset:2048 sc1
	s_waitcnt lgkmcnt(4)
	v_mfma_f32_32x32x16_bf16 v[176:191], v[72:75], v[248:251], v[176:191]
	ds_read_b64_tr_b16 v[88:89], v21 offset:36864
	ds_read_b64_tr_b16 v[90:91], v21 offset:37888
	v_mfma_f32_32x32x16_bf16 v[24:39], v[76:79], v[248:251], v[24:39]
	ds_read_b64_tr_b16 v[92:93], v21 offset:37376
	ds_read_b64_tr_b16 v[94:95], v21 offset:38400
	buffer_load_dwordx4 a[12:15], v4, s[28:31], s43 offen offset:3072 sc1
	s_waitcnt lgkmcnt(4)
	v_mfma_f32_32x32x16_bf16 v[176:191], v[80:83], v[252:255], v[176:191]
	ds_read_b64_tr_b16 v[72:73], v21 offset:38912
	ds_read_b64_tr_b16 v[74:75], v21 offset:39936
	v_mfma_f32_32x32x16_bf16 v[24:39], v[84:87], v[252:255], v[24:39]
	ds_read_b64_tr_b16 v[76:77], v21 offset:39424
	ds_read_b64_tr_b16 v[78:79], v21 offset:40448
	s_add_u32 s44, s44, 4096
	buffer_load_dwordx4 a[16:19], v4, s[28:31], s44 offen offset:0 sc1
	s_waitcnt lgkmcnt(4) vmcnt(12)
	v_mfma_f32_32x32x16_bf16 v[176:191], v[88:91], a[96:99], v[176:191]
	ds_read_b64_tr_b16 v[80:81], v21 offset:40960
	ds_read_b64_tr_b16 v[82:83], v21 offset:41984
	v_mfma_f32_32x32x16_bf16 v[24:39], v[92:95], a[96:99], v[24:39]
	ds_read_b64_tr_b16 v[84:85], v21 offset:41472
	ds_read_b64_tr_b16 v[86:87], v21 offset:42496
	buffer_load_dwordx4 a[20:23], v4, s[28:31], s44 offen offset:1024 sc1
	s_waitcnt lgkmcnt(4) vmcnt(12)
	v_mfma_f32_32x32x16_bf16 v[176:191], v[72:75], a[100:103], v[176:191]
	ds_read_b64_tr_b16 v[88:89], v21 offset:43008
	ds_read_b64_tr_b16 v[90:91], v21 offset:44032
	v_mfma_f32_32x32x16_bf16 v[24:39], v[76:79], a[100:103], v[24:39]
	ds_read_b64_tr_b16 v[92:93], v21 offset:43520
	ds_read_b64_tr_b16 v[94:95], v21 offset:44544
	buffer_load_dwordx4 a[24:27], v4, s[28:31], s44 offen offset:2048 sc1
	s_waitcnt lgkmcnt(4) vmcnt(12)
	v_mfma_f32_32x32x16_bf16 v[176:191], v[80:83], a[104:107], v[176:191]
	ds_read_b64_tr_b16 v[72:73], v21 offset:45056
	ds_read_b64_tr_b16 v[74:75], v21 offset:46080
	v_mfma_f32_32x32x16_bf16 v[24:39], v[84:87], a[104:107], v[24:39]
	ds_read_b64_tr_b16 v[76:77], v21 offset:45568
	ds_read_b64_tr_b16 v[78:79], v21 offset:46592
	buffer_load_dwordx4 a[28:31], v4, s[28:31], s44 offen offset:3072 sc1
	s_waitcnt lgkmcnt(4) vmcnt(12)
	v_mfma_f32_32x32x16_bf16 v[176:191], v[88:91], a[108:111], v[176:191]
	ds_read_b64_tr_b16 v[80:81], v21 offset:47104
	ds_read_b64_tr_b16 v[82:83], v21 offset:48128
	v_mfma_f32_32x32x16_bf16 v[24:39], v[92:95], a[108:111], v[24:39]
	ds_read_b64_tr_b16 v[84:85], v21 offset:47616
	ds_read_b64_tr_b16 v[86:87], v21 offset:48640
	s_add_u32 s45, s45, 4096
	buffer_load_dwordx4 a[32:35], v4, s[28:31], s45 offen offset:0 sc1
	s_waitcnt lgkmcnt(4) vmcnt(12)
	v_mfma_f32_32x32x16_bf16 v[176:191], v[72:75], a[112:115], v[176:191]
	ds_read_b64_tr_b16 v[88:89], v21 offset:49152
	ds_read_b64_tr_b16 v[90:91], v21 offset:50176
	v_mfma_f32_32x32x16_bf16 v[24:39], v[76:79], a[112:115], v[24:39]
	ds_read_b64_tr_b16 v[92:93], v21 offset:49664
	ds_read_b64_tr_b16 v[94:95], v21 offset:50688
	buffer_load_dwordx4 a[36:39], v4, s[28:31], s45 offen offset:1024 sc1
	s_waitcnt lgkmcnt(4) vmcnt(12)
	v_mfma_f32_32x32x16_bf16 v[176:191], v[80:83], a[116:119], v[176:191]
	ds_read_b64_tr_b16 v[72:73], v21 offset:51200
	ds_read_b64_tr_b16 v[74:75], v21 offset:52224
	v_mfma_f32_32x32x16_bf16 v[24:39], v[84:87], a[116:119], v[24:39]
	ds_read_b64_tr_b16 v[76:77], v21 offset:51712
	ds_read_b64_tr_b16 v[78:79], v21 offset:52736
	buffer_load_dwordx4 a[40:43], v4, s[28:31], s45 offen offset:2048 sc1
	s_waitcnt lgkmcnt(4) vmcnt(12)
	v_mfma_f32_32x32x16_bf16 v[176:191], v[88:91], a[120:123], v[176:191]
	ds_read_b64_tr_b16 v[80:81], v21 offset:53248
	ds_read_b64_tr_b16 v[82:83], v21 offset:54272
	v_mfma_f32_32x32x16_bf16 v[24:39], v[92:95], a[120:123], v[24:39]
	ds_read_b64_tr_b16 v[84:85], v21 offset:53760
	ds_read_b64_tr_b16 v[86:87], v21 offset:54784
	buffer_load_dwordx4 a[44:47], v4, s[28:31], s45 offen offset:3072 sc1
	s_waitcnt lgkmcnt(4) vmcnt(12)
	v_mfma_f32_32x32x16_bf16 v[176:191], v[72:75], a[124:127], v[176:191]
	ds_read_b64_tr_b16 v[88:89], v21 offset:55296
	ds_read_b64_tr_b16 v[90:91], v21 offset:56320
	v_mfma_f32_32x32x16_bf16 v[24:39], v[76:79], a[124:127], v[24:39]
	ds_read_b64_tr_b16 v[92:93], v21 offset:55808
	ds_read_b64_tr_b16 v[94:95], v21 offset:56832
	s_add_u32 s46, s46, 4096
	buffer_load_dwordx4 a[48:51], v4, s[28:31], s46 offen offset:0 sc1
	s_waitcnt lgkmcnt(4) vmcnt(12)
	v_mfma_f32_32x32x16_bf16 v[176:191], v[80:83], a[0:3], v[176:191]
	ds_read_b64_tr_b16 v[72:73], v22 offset:20480
	ds_read_b64_tr_b16 v[74:75], v22 offset:21504
	v_mfma_f32_32x32x16_bf16 v[24:39], v[84:87], a[0:3], v[24:39]
	ds_read_b64_tr_b16 v[76:77], v22 offset:20992
	ds_read_b64_tr_b16 v[78:79], v22 offset:22016
	buffer_load_dwordx4 a[52:55], v4, s[28:31], s46 offen offset:1024 sc1
	s_waitcnt lgkmcnt(4) vmcnt(12)
	v_mfma_f32_32x32x16_bf16 v[176:191], v[88:91], a[4:7], v[176:191]
	ds_read_b64_tr_b16 v[80:81], v22 offset:22528
	ds_read_b64_tr_b16 v[82:83], v22 offset:23552
	v_mfma_f32_32x32x16_bf16 v[24:39], v[92:95], a[4:7], v[24:39]
	ds_read_b64_tr_b16 v[84:85], v22 offset:23040
	ds_read_b64_tr_b16 v[86:87], v22 offset:24064
	buffer_load_dwordx4 a[56:59], v4, s[28:31], s46 offen offset:2048 sc1
	s_waitcnt lgkmcnt(4) vmcnt(12)
	v_mfma_f32_32x32x16_bf16 v[176:191], v[72:75], a[8:11], v[176:191]
	ds_read_b64_tr_b16 v[88:89], v22 offset:24576
	ds_read_b64_tr_b16 v[90:91], v22 offset:25600
	v_mfma_f32_32x32x16_bf16 v[24:39], v[76:79], a[8:11], v[24:39]
	ds_read_b64_tr_b16 v[92:93], v22 offset:25088
	ds_read_b64_tr_b16 v[94:95], v22 offset:26112
	buffer_load_dwordx4 a[60:63], v4, s[28:31], s46 offen offset:3072 sc1
	s_waitcnt lgkmcnt(4) vmcnt(12)
	v_mfma_f32_32x32x16_bf16 v[176:191], v[80:83], a[12:15], v[176:191]
	ds_read_b64_tr_b16 v[72:73], v22 offset:26624
	ds_read_b64_tr_b16 v[74:75], v22 offset:27648
	v_mfma_f32_32x32x16_bf16 v[24:39], v[84:87], a[12:15], v[24:39]
	ds_read_b64_tr_b16 v[76:77], v22 offset:27136
	ds_read_b64_tr_b16 v[78:79], v22 offset:28160
	s_waitcnt lgkmcnt(4) vmcnt(11)
	v_mfma_f32_32x32x16_bf16 v[176:191], v[88:91], a[16:19], v[176:191]
	ds_read_b64_tr_b16 v[80:81], v22 offset:28672
	ds_read_b64_tr_b16 v[82:83], v22 offset:29696
	v_mfma_f32_32x32x16_bf16 v[24:39], v[92:95], a[16:19], v[24:39]
	ds_read_b64_tr_b16 v[84:85], v22 offset:29184
	ds_read_b64_tr_b16 v[86:87], v22 offset:30208
	s_waitcnt lgkmcnt(4) vmcnt(10)
	v_mfma_f32_32x32x16_bf16 v[176:191], v[72:75], a[20:23], v[176:191]
	ds_read_b64_tr_b16 v[88:89], v22 offset:30720
	ds_read_b64_tr_b16 v[90:91], v22 offset:31744
	v_mfma_f32_32x32x16_bf16 v[24:39], v[76:79], a[20:23], v[24:39]
	ds_read_b64_tr_b16 v[92:93], v22 offset:31232
	ds_read_b64_tr_b16 v[94:95], v22 offset:32256
	s_waitcnt lgkmcnt(4) vmcnt(9)
	v_mfma_f32_32x32x16_bf16 v[176:191], v[80:83], a[24:27], v[176:191]
	ds_read_b64_tr_b16 v[72:73], v22 offset:32768
	ds_read_b64_tr_b16 v[74:75], v22 offset:33792
	v_mfma_f32_32x32x16_bf16 v[24:39], v[84:87], a[24:27], v[24:39]
	ds_read_b64_tr_b16 v[76:77], v22 offset:34816
	ds_read_b64_tr_b16 v[78:79], v22 offset:35840
	s_waitcnt lgkmcnt(4) vmcnt(8)
	v_mfma_f32_32x32x16_bf16 v[176:191], v[88:91], a[28:31], v[176:191]
	ds_read_b64_tr_b16 v[80:81], v22 offset:36864
	ds_read_b64_tr_b16 v[82:83], v22 offset:37888
	v_mfma_f32_32x32x16_bf16 v[24:39], v[92:95], a[28:31], v[24:39]
	ds_read_b64_tr_b16 v[84:85], v22 offset:38912
	ds_read_b64_tr_b16 v[86:87], v22 offset:39936
	s_waitcnt lgkmcnt(4) vmcnt(7)
	v_mfma_f32_32x32x16_bf16 v[176:191], v[72:75], a[32:35], v[176:191]
	ds_read_b64_tr_b16 v[88:89], v22 offset:40960
	ds_read_b64_tr_b16 v[90:91], v22 offset:41984
	s_waitcnt vmcnt(6)
	v_mfma_f32_32x32x16_bf16 v[176:191], v[76:79], a[36:39], v[176:191]
	ds_read_b64_tr_b16 v[92:93], v22 offset:43008
	ds_read_b64_tr_b16 v[94:95], v22 offset:44032
	s_waitcnt lgkmcnt(4) vmcnt(5)
	v_mfma_f32_32x32x16_bf16 v[176:191], v[80:83], a[40:43], v[176:191]
	ds_read_b64_tr_b16 v[72:73], v22 offset:45056
	ds_read_b64_tr_b16 v[74:75], v22 offset:46080
	s_waitcnt vmcnt(4)
	v_mfma_f32_32x32x16_bf16 v[176:191], v[84:87], a[44:47], v[176:191]
	ds_read_b64_tr_b16 v[76:77], v22 offset:47104
	ds_read_b64_tr_b16 v[78:79], v22 offset:48128
	s_waitcnt lgkmcnt(4) vmcnt(3)
	v_mfma_f32_32x32x16_bf16 v[176:191], v[88:91], a[48:51], v[176:191]
	ds_read_b64_tr_b16 v[80:81], v22 offset:33280
	ds_read_b64_tr_b16 v[82:83], v22 offset:34304
	s_waitcnt vmcnt(2)
	v_mfma_f32_32x32x16_bf16 v[176:191], v[92:95], a[52:55], v[176:191]
	ds_read_b64_tr_b16 v[84:85], v22 offset:35328
	ds_read_b64_tr_b16 v[86:87], v22 offset:36352
	s_waitcnt lgkmcnt(4) vmcnt(1)
	v_mfma_f32_32x32x16_bf16 v[176:191], v[72:75], a[56:59], v[176:191]
	ds_read_b64_tr_b16 v[88:89], v22 offset:37376
	ds_read_b64_tr_b16 v[90:91], v22 offset:38400
	s_waitcnt vmcnt(0)
	v_mfma_f32_32x32x16_bf16 v[176:191], v[76:79], a[60:63], v[176:191]
	ds_read_b64_tr_b16 v[92:93], v22 offset:39424
	ds_read_b64_tr_b16 v[94:95], v22 offset:40448
	s_waitcnt lgkmcnt(4)
	v_mfma_f32_32x32x16_bf16 v[24:39], v[80:83], a[32:35], v[24:39]
	ds_read_b64_tr_b16 v[72:73], v22 offset:41472
	ds_read_b64_tr_b16 v[74:75], v22 offset:42496
	v_mfma_f32_32x32x16_bf16 v[24:39], v[84:87], a[36:39], v[24:39]
	ds_read_b64_tr_b16 v[76:77], v22 offset:43520
	ds_read_b64_tr_b16 v[78:79], v22 offset:44544
	s_waitcnt lgkmcnt(4)
	v_mfma_f32_32x32x16_bf16 v[24:39], v[88:91], a[40:43], v[24:39]
	ds_read_b64_tr_b16 v[80:81], v22 offset:45568
	ds_read_b64_tr_b16 v[82:83], v22 offset:46592
	v_cvt_pk_bf16_f32 v96, v176, v177
	v_cvt_pk_bf16_f32 v97, v178, v179
	v_cvt_pk_bf16_f32 v98, v180, v181
	v_cvt_pk_bf16_f32 v99, v182, v183
	buffer_store_dwordx4 v[96:99], v4, s[28:31], s53 offen offset:0 sc1
	v_cvt_pk_bf16_f32 v100, v184, v185
	v_mfma_f32_32x32x16_bf16 v[24:39], v[92:95], a[44:47], v[24:39]
	ds_read_b64_tr_b16 v[84:85], v22 offset:47616
	ds_read_b64_tr_b16 v[86:87], v22 offset:48640
	v_cvt_pk_bf16_f32 v101, v186, v187
	v_cvt_pk_bf16_f32 v102, v188, v189
	v_cvt_pk_bf16_f32 v103, v190, v191
	buffer_store_dwordx4 v[100:103], v4, s[28:31], s53 offen offset:1024 sc1
	s_xor_b32 s48, s53, 2048
	s_xor_b32 s49, s74, 4
	s_waitcnt lgkmcnt(4)
	v_mfma_f32_32x32x16_bf16 v[24:39], v[72:75], a[48:51], v[24:39]
	v_mov_b32 v104, 0
	v_mfma_f32_32x32x16_bf16 v[24:39], v[76:79], a[52:55], v[24:39]
	s_waitcnt lgkmcnt(0)
	v_mfma_f32_32x32x16_bf16 v[24:39], v[80:83], a[56:59], v[24:39]
	v_mfma_f32_32x32x16_bf16 v[24:39], v[84:87], a[60:63], v[24:39]
	s_cmp_lg_u32 s66, 0
	s_cbranch_scc1 L_tail_slow1
L_tail_slow0:
	buffer_load_dwordx4 v[232:235], v4, s[28:31], s48 offen offset:0 sc1
	buffer_load_dwordx4 v[236:239], v4, s[28:31], s48 offen offset:1024 sc1
	v_add_u32 v106, s90, v4
	v_add_u32 v107, 57344, v106
	s_barrier
	s_waitcnt vmcnt(1)
	v_max3_u32 v105, v232, v233, v234
	s_waitcnt vmcnt(0)
	v_max3_u32 v108, v235, v236, v237
	v_max3_u32 v105, v105, v238, v239
	v_max_u32 v105, v105, v108
	v_cmp_eq_u32 vcc, -1, v105
	s_mov_b64 exec, 1
	buffer_store_dword v11, off, s[28:31], s74 offset:512 sc1
	s_mov_b64 exec, -1
	s_cbranch_vccnz Lpslow_93
Lpok_94:
	v_mfma_f32_32x32x16_bf16 v[24:39], a[240:243], v[232:235], v[24:39]
	v_mfma_f32_32x32x16_bf16 v[24:39], a[244:247], v[236:239], v[24:39]
	s_lshl_b32 s53, s62, 11
	s_add_u32 s53, s53, s68
	s_add_u32 s53, s53, 32768
	s_lshl_b32 s49, s62, 8
	s_add_u32 s49, s49, s68
	s_add_u32 s49, s49, 61440
	s_nop 5
	v_cvt_pk_bf16_f32 v224, v24, v25
	v_cvt_pk_bf16_f32 v225, v26, v27
	v_cvt_pk_bf16_f32 v226, v28, v29
	v_cvt_pk_bf16_f32 v227, v30, v31
	buffer_store_dwordx4 v[224:227], v4, s[28:31], s53 offen sc1
	v_cvt_pk_bf16_f32 v228, v32, v33
	v_cvt_pk_bf16_f32 v229, v34, v35
	v_cvt_pk_bf16_f32 v230, v36, v37
	v_cvt_pk_bf16_f32 v231, v38, v39
	buffer_store_dwordx4 v[228:231], v4, s[28:31], s53 offen offset:1024 sc1
	v_pk_add_f32 v[96:97], v[24:25], v[26:27]
	v_pk_mul_f32 v[98:99], v[24:25], v[24:25]
	v_pk_fma_f32 v[98:99], v[26:27], v[26:27], v[98:99]
	v_pk_fma_f32 v[98:99], v[28:29], v[28:29], v[98:99]
	v_pk_add_f32 v[96:97], v[96:97], v[28:29]
	v_pk_fma_f32 v[98:99], v[30:31], v[30:31], v[98:99]
	v_pk_add_f32 v[96:97], v[96:97], v[30:31]
	v_pk_fma_f32 v[98:99], v[32:33], v[32:33], v[98:99]
	v_pk_add_f32 v[96:97], v[96:97], v[32:33]
	v_pk_fma_f32 v[98:99], v[34:35], v[34:35], v[98:99]
	v_pk_add_f32 v[96:97], v[96:97], v[34:35]
	v_pk_fma_f32 v[98:99], v[36:37], v[36:37], v[98:99]
	v_pk_add_f32 v[96:97], v[96:97], v[36:37]
	v_pk_fma_f32 v[98:99], v[38:39], v[38:39], v[98:99]
	v_pk_add_f32 v[96:97], v[96:97], v[38:39]
	v_add_f32 v96, v96, v97
	v_add_f32 v97, v98, v99
	s_nop 1
	v_permlane32_swap_b32 v96, v97
	v_add_f32 v96, v96, v97
	buffer_store_dword v96, v2, s[28:31], s49 offen sc1
	ds_write_b128 v106, a[128:131] offset:0
	ds_write_b128 v106, a[132:135] offset:4096
	ds_write_b128 v106, a[136:139] offset:8192
	ds_write_b128 v106, a[140:143] offset:12288
	ds_write_b128 v106, a[144:147] offset:16384
	ds_write_b128 v106, a[148:151] offset:20480
	s_waitcnt vmcnt(0)
	s_mov_b64 exec, 1
	buffer_store_dword v11, off, s[28:31], s74 offset:640 sc1
	s_mov_b64 exec, -1
	ds_write_b128 v106, a[152:155] offset:24576
	ds_write_b128 v106, a[156:159] offset:28672
	ds_write_b128 v106, a[160:163] offset:32768
	ds_write_b128 v106, a[164:167] offset:36864
	ds_write_b128 v106, a[168:171] offset:40960
	ds_write_b128 v106, a[172:175] offset:45056
	ds_write_b128 v106, a[176:179] offset:49152
	ds_write_b128 v106, a[180:183] offset:53248
L_second_slow:
	s_add_u32 s48, s68, 32768
	s_add_u32 s40, s48, s76
	s_add_u32 s41, s48, s77
	s_add_u32 s42, s48, s78
	s_add_u32 s43, s48, s79
	s_add_u32 s44, s48, s80
	s_add_u32 s45, s48, s81
	s_add_u32 s46, s48, s82
	s_add_u32 s52, s68, 61440
Lpoll_96:
	buffer_load_dword v14, v6, s[28:31], s73 offen offset:640 sc1
	s_waitcnt vmcnt(0)
	v_cmp_ne_u32 vcc, s65, v14
	s_nop 0
	s_cbranch_vccz Lpdone_97
	s_sub_u32 s67, s67, 1
	s_cbranch_scc0 Lpoll_96
	s_mov_b32 s67, 0
Lpdone_97:
	s_add_u32 s69, s69, 524288
	s_mov_b32 s66, 1
	s_add_u32 s73, s73, 0x400
	s_add_u32 s74, s74, 0x400
	buffer_load_dwordx4 a[0:3], v4, s[28:31], s40 offen offset:0 sc1
	buffer_load_dwordx4 a[4:7], v4, s[28:31], s40 offen offset:1024 sc1
	buffer_load_dwordx4 a[8:11], v4, s[28:31], s40 offen offset:2048 sc1
	buffer_load_dwordx4 a[12:15], v4, s[28:31], s40 offen offset:3072 sc1
	buffer_load_dwordx4 v[224:227], v4, s[28:31], s52 offen offset:0 sc1
	buffer_load_dwordx4 v[228:231], v4, s[28:31], s52 offen offset:1024 sc1
	buffer_load_dwordx4 v[232:235], v4, s[28:31], s52 offen offset:2048 sc1
	buffer_load_dwordx4 v[236:239], v4, s[28:31], s52 offen offset:3072 sc1
	buffer_load_dwordx4 a[16:19], v4, s[28:31], s41 offen offset:0 sc1
	buffer_load_dwordx4 a[20:23], v4, s[28:31], s41 offen offset:1024 sc1
	buffer_load_dwordx4 a[24:27], v4, s[28:31], s41 offen offset:2048 sc1
	buffer_load_dwordx4 a[28:31], v4, s[28:31], s41 offen offset:3072 sc1
	buffer_load_dwordx4 a[32:35], v4, s[28:31], s42 offen offset:0 sc1
	s_waitcnt lgkmcnt(0)
	s_barrier
	v_add_u32 v106, s90, v4
	v_add_u32 v107, 57344, v106
	ds_read_b64_tr_b16 v[72:73], v21 offset:0
	ds_read_b64_tr_b16 v[74:75], v21 offset:512
	ds_read_b64_tr_b16 v[76:77], v21 offset:28672
	ds_read_b64_tr_b16 v[78:79], v21 offset:29184
	ds_read_b64_tr_b16 v[80:81], v21 offset:1024
	ds_read_b64_tr_b16 v[82:83], v21 offset:1536
	ds_read_b64_tr_b16 v[84:85], v21 offset:29696
	ds_read_b64_tr_b16 v[86:87], v21 offset:30208
	buffer_load_dwordx4 a[36:39], v4, s[28:31], s42 offen offset:1024 sc1
	s_waitcnt lgkmcnt(4) vmcnt(13)
	v_mfma_f32_32x32x16_bf16 v[112:127], a[0:3], v[72:75], 0
	ds_read_b64_tr_b16 v[88:89], v21 offset:2048
	ds_read_b64_tr_b16 v[90:91], v21 offset:2560
	v_mfma_f32_32x32x16_bf16 v[128:143], a[0:3], v[76:79], 0
	ds_read_b64_tr_b16 v[92:93], v21 offset:30720
	ds_read_b64_tr_b16 v[94:95], v21 offset:31232
	ds_write_b128 v107, a[184:187] offset:0
	buffer_load_dwordx4 a[40:43], v4, s[28:31], s42 offen offset:2048 sc1
	s_waitcnt lgkmcnt(5) vmcnt(13)
	v_mfma_f32_32x32x16_bf16 v[112:127], a[4:7], v[80:83], v[112:127]
	ds_read_b64_tr_b16 v[72:73], v21 offset:3072
	ds_read_b64_tr_b16 v[74:75], v21 offset:3584
	v_mfma_f32_32x32x16_bf16 v[128:143], a[4:7], v[84:87], v[128:143]
	ds_read_b64_tr_b16 v[76:77], v21 offset:31744
	ds_read_b64_tr_b16 v[78:79], v21 offset:32256
	ds_write_b128 v107, a[188:191] offset:4096
	buffer_load_dwordx4 a[44:47], v4, s[28:31], s42 offen offset:3072 sc1
	s_waitcnt lgkmcnt(6) vmcnt(13)
	v_mfma_f32_32x32x16_bf16 v[112:127], a[8:11], v[88:91], v[112:127]
	ds_read_b64_tr_b16 v[80:81], v21 offset:4096
	ds_read_b64_tr_b16 v[82:83], v21 offset:4608
	v_mfma_f32_32x32x16_bf16 v[128:143], a[8:11], v[92:95], v[128:143]
	ds_read_b64_tr_b16 v[84:85], v21 offset:32768
	ds_read_b64_tr_b16 v[86:87], v21 offset:33280
	ds_write_b128 v107, a[192:195] offset:8192
	buffer_load_dwordx4 a[48:51], v4, s[28:31], s43 offen offset:0 sc1
	s_waitcnt lgkmcnt(6) vmcnt(13)
	v_mfma_f32_32x32x16_bf16 v[112:127], a[12:15], v[72:75], v[112:127]
	ds_read_b64_tr_b16 v[88:89], v21 offset:5120
	ds_read_b64_tr_b16 v[90:91], v21 offset:5632
	v_mfma_f32_32x32x16_bf16 v[128:143], a[12:15], v[76:79], v[128:143]
	ds_read_b64_tr_b16 v[92:93], v21 offset:33792
	ds_read_b64_tr_b16 v[94:95], v21 offset:34304
	ds_write_b128 v107, a[196:199] offset:12288
	buffer_load_dwordx4 a[52:55], v4, s[28:31], s43 offen offset:1024 sc1
	s_waitcnt lgkmcnt(6) vmcnt(9)
	v_mfma_f32_32x32x16_bf16 v[112:127], a[16:19], v[80:83], v[112:127]
	ds_read_b64_tr_b16 v[72:73], v21 offset:6144
	ds_read_b64_tr_b16 v[74:75], v21 offset:6656
	v_mfma_f32_32x32x16_bf16 v[128:143], a[16:19], v[84:87], v[128:143]
	ds_read_b64_tr_b16 v[76:77], v21 offset:34816
	ds_read_b64_tr_b16 v[78:79], v21 offset:35328
	ds_write_b128 v107, a[200:203] offset:16384
	buffer_load_dwordx4 a[56:59], v4, s[28:31], s43 offen offset:2048 sc1
	s_waitcnt lgkmcnt(6) vmcnt(9)
	v_mfma_f32_32x32x16_bf16 v[112:127], a[20:23], v[88:91], v[112:127]
	ds_read_b64_tr_b16 v[80:81], v21 offset:7168
	ds_read_b64_tr_b16 v[82:83], v21 offset:7680
	v_mfma_f32_32x32x16_bf16 v[128:143], a[20:23], v[92:95], v[128:143]
	ds_read_b64_tr_b16 v[84:85], v21 offset:35840
	ds_read_b64_tr_b16 v[86:87], v21 offset:36352
	ds_write_b128 v107, a[204:207] offset:20480
	buffer_load_dwordx4 a[60:63], v4, s[28:31], s43 offen offset:3072 sc1
	s_waitcnt lgkmcnt(6) vmcnt(9)
	v_mfma_f32_32x32x16_bf16 v[112:127], a[24:27], v[72:75], v[112:127]
	ds_read_b64_tr_b16 v[88:89], v21 offset:8192
	ds_read_b64_tr_b16 v[90:91], v21 offset:8704
	v_mfma_f32_32x32x16_bf16 v[128:143], a[24:27], v[76:79], v[128:143]
	ds_read_b64_tr_b16 v[92:93], v21 offset:36864
	ds_read_b64_tr_b16 v[94:95], v21 offset:37376
	ds_write_b128 v107, a[208:211] offset:24576
	buffer_load_dwordx4 a[64:67], v4, s[28:31], s44 offen offset:0 sc1
	s_waitcnt lgkmcnt(6) vmcnt(9)
	v_mfma_f32_32x32x16_bf16 v[112:127], a[28:31], v[80:83], v[112:127]
	ds_read_b64_tr_b16 v[72:73], v21 offset:9216
	ds_read_b64_tr_b16 v[74:75], v21 offset:9728
	v_cndmask_b32 v236, v236, 0, s[84:85]
	v_mfma_f32_32x32x16_bf16 v[128:143], a[28:31], v[84:87], v[128:143]
	ds_read_b64_tr_b16 v[76:77], v21 offset:37888
	ds_read_b64_tr_b16 v[78:79], v21 offset:38400
	v_cndmask_b32 v237, v237, 0, s[84:85]
	v_cndmask_b32 v238, v238, 0, s[84:85]
	buffer_load_dwordx4 a[68:71], v4, s[28:31], s44 offen offset:1024 sc1
	s_waitcnt lgkmcnt(5) vmcnt(9)
	v_mfma_f32_32x32x16_bf16 v[112:127], a[32:35], v[88:91], v[112:127]
	ds_read_b64_tr_b16 v[80:81], v21 offset:10240
	ds_read_b64_tr_b16 v[82:83], v21 offset:10752
	v_cndmask_b32 v239, v239, 0, s[84:85]
	v_mfma_f32_32x32x16_bf16 v[128:143], a[32:35], v[92:95], v[128:143]
	ds_read_b64_tr_b16 v[84:85], v21 offset:38912
	ds_read_b64_tr_b16 v[86:87], v21 offset:39424
	v_add_f32 v224, v224, v228
	v_add_f32 v225, v225, v229
	buffer_load_dwordx4 a[72:75], v4, s[28:31], s44 offen offset:2048 sc1
	s_waitcnt lgkmcnt(4) vmcnt(9)
	v_mfma_f32_32x32x16_bf16 v[112:127], a[36:39], v[72:75], v[112:127]
	ds_read_b64_tr_b16 v[88:89], v21 offset:11264
	ds_read_b64_tr_b16 v[90:91], v21 offset:11776
	v_add_f32 v226, v226, v230
	v_mfma_f32_32x32x16_bf16 v[128:143], a[36:39], v[76:79], v[128:143]
	ds_read_b64_tr_b16 v[92:93], v21 offset:39936
	ds_read_b64_tr_b16 v[94:95], v21 offset:40448
	v_add_f32 v227, v227, v231
	v_add_f32 v232, v232, v236
	buffer_load_dwordx4 a[76:79], v4, s[28:31], s44 offen offset:3072 sc1
	s_waitcnt lgkmcnt(4) vmcnt(9)
	v_mfma_f32_32x32x16_bf16 v[112:127], a[40:43], v[80:83], v[112:127]
	ds_read_b64_tr_b16 v[72:73], v21 offset:12288
	ds_read_b64_tr_b16 v[74:75], v21 offset:12800
	v_add_f32 v233, v233, v237
	v_mfma_f32_32x32x16_bf16 v[128:143], a[40:43], v[84:87], v[128:143]
	ds_read_b64_tr_b16 v[76:77], v21 offset:40960
	ds_read_b64_tr_b16 v[78:79], v21 offset:41472
	v_add_f32 v234, v234, v238
	v_add_f32 v235, v235, v239
	buffer_load_dwordx4 a[80:83], v4, s[28:31], s45 offen offset:0 sc1
	s_waitcnt lgkmcnt(4) vmcnt(9)
	v_mfma_f32_32x32x16_bf16 v[112:127], a[44:47], v[88:91], v[112:127]
	ds_read_b64_tr_b16 v[80:81], v21 offset:13312
	ds_read_b64_tr_b16 v[82:83], v21 offset:13824
	v_add_f32 v224, v224, v232
	v_mfma_f32_32x32x16_bf16 v[128:143], a[44:47], v[92:95], v[128:143]
	ds_read_b64_tr_b16 v[84:85], v21 offset:41984
	ds_read_b64_tr_b16 v[86:87], v21 offset:42496
	v_add_f32 v225, v225, v233
	v_add_f32 v226, v226, v234
	buffer_load_dwordx4 a[84:87], v4, s[28:31], s45 offen offset:1024 sc1
	s_waitcnt lgkmcnt(4) vmcnt(9)
	v_mfma_f32_32x32x16_bf16 v[112:127], a[48:51], v[72:75], v[112:127]
	ds_read_b64_tr_b16 v[88:89], v21 offset:14336
	ds_read_b64_tr_b16 v[90:91], v21 offset:14848
	v_add_f32 v227, v227, v235
	v_mfma_f32_32x32x16_bf16 v[128:143], a[48:51], v[76:79], v[128:143]
	ds_read_b64_tr_b16 v[92:93], v21 offset:43008
	ds_read_b64_tr_b16 v[94:95], v21 offset:43520
	s_lshl_b32 s48, s64, 12
	s_add_u32 s48, s48, 143360
	buffer_load_dwordx4 a[88:91], v4, s[28:31], s45 offen offset:2048 sc1
	s_waitcnt lgkmcnt(4) vmcnt(9)
	v_mfma_f32_32x32x16_bf16 v[112:127], a[52:55], v[80:83], v[112:127]
	ds_read_b64_tr_b16 v[72:73], v21 offset:15360
	ds_read_b64_tr_b16 v[74:75], v21 offset:15872
	v_add_u32 v100, s48, v2
	v_mfma_f32_32x32x16_bf16 v[128:143], a[52:55], v[84:87], v[128:143]
	ds_read_b64_tr_b16 v[76:77], v21 offset:44032
	ds_read_b64_tr_b16 v[78:79], v21 offset:44544
	ds_write_b128 v9, v[224:227]
	ds_read_b32 v228, v100 offset:0
	buffer_load_dwordx4 a[92:95], v4, s[28:31], s45 offen offset:3072 sc1
	s_waitcnt lgkmcnt(6) vmcnt(9)
	v_mfma_f32_32x32x16_bf16 v[112:127], a[56:59], v[88:91], v[112:127]
	ds_read_b64_tr_b16 v[80:81], v21 offset:16384
	ds_read_b64_tr_b16 v[82:83], v21 offset:16896
	ds_read_b32 v229, v100 offset:256
	v_mfma_f32_32x32x16_bf16 v[128:143], a[56:59], v[92:95], v[128:143]
	ds_read_b64_tr_b16 v[84:85], v21 offset:45056
	ds_read_b64_tr_b16 v[86:87], v21 offset:45568
	ds_read_b32 v230, v100 offset:512
	ds_read_b32 v231, v100 offset:768
	buffer_load_dwordx4 a[96:99], v4, s[28:31], s46 offen offset:0 sc1
	s_waitcnt lgkmcnt(9) vmcnt(9)
	v_mfma_f32_32x32x16_bf16 v[112:127], a[60:63], v[72:75], v[112:127]
	ds_read_b64_tr_b16 v[88:89], v21 offset:17408
	ds_read_b64_tr_b16 v[90:91], v21 offset:17920
	s_waitcnt lgkmcnt(6)
	v_add_f32 v228, v228, v229
	v_mfma_f32_32x32x16_bf16 v[128:143], a[60:63], v[76:79], v[128:143]
	ds_read_b64_tr_b16 v[92:93], v21 offset:46080
	ds_read_b64_tr_b16 v[94:95], v21 offset:46592
	s_waitcnt lgkmcnt(4)
	v_add_f32 v230, v230, v231
	v_add_f32 v224, v228, v230
	buffer_load_dwordx4 a[100:103], v4, s[28:31], s46 offen offset:1024 sc1
	s_waitcnt vmcnt(9)
	v_mfma_f32_32x32x16_bf16 v[112:127], a[64:67], v[80:83], v[112:127]
	ds_read_b64_tr_b16 v[72:73], v21 offset:18432
	ds_read_b64_tr_b16 v[74:75], v21 offset:18944
	v_mov_b32 v225, v224
	v_mfma_f32_32x32x16_bf16 v[128:143], a[64:67], v[84:87], v[128:143]
	ds_read_b64_tr_b16 v[76:77], v21 offset:47104
	ds_read_b64_tr_b16 v[78:79], v21 offset:47616
	v_permlane32_swap_b32 v224, v225
	v_mul_f32 v96, 0x3b124925, v224
	buffer_load_dwordx4 a[104:107], v4, s[28:31], s46 offen offset:2048 sc1
	s_waitcnt lgkmcnt(4) vmcnt(9)
	v_mfma_f32_32x32x16_bf16 v[112:127], a[68:71], v[88:91], v[112:127]
	ds_read_b64_tr_b16 v[80:81], v21 offset:19456
	ds_read_b64_tr_b16 v[82:83], v21 offset:19968
	v_mul_f32 v97, 0x3b124925, v225
	v_mfma_f32_32x32x16_bf16 v[128:143], a[68:71], v[92:95], v[128:143]
	ds_read_b64_tr_b16 v[84:85], v21 offset:48128
	ds_read_b64_tr_b16 v[86:87], v21 offset:48640
	v_cvt_pk_bf16_f32 v68, -v96, -v96
	v_fma_f32 v97, -v96, v96, v97
	buffer_load_dwordx4 a[108:111], v4, s[28:31], s46 offen offset:3072 sc1
	s_waitcnt lgkmcnt(4) vmcnt(9)
	v_mfma_f32_32x32x16_bf16 v[112:127], a[72:75], v[72:75], v[112:127]
	ds_read_b64_tr_b16 v[88:89], v21 offset:20480
	ds_read_b64_tr_b16 v[90:91], v21 offset:20992
	v_and_b32 v98, s94, v68
	v_mfma_f32_32x32x16_bf16 v[128:143], a[72:75], v[76:79], v[128:143]
	ds_read_b64_tr_b16 v[92:93], v21 offset:49152
	ds_read_b64_tr_b16 v[94:95], v21 offset:49664
	v_max_f32 v97, 0, v97
	v_sub_f32 v98, -v96, v98
	s_add_u32 m0, s90, 86016
	s_mov_b32 s54, 128
	buffer_load_dwordx4 v7, s[16:19], s54 offen lds
	s_waitcnt lgkmcnt(4) vmcnt(9)
	v_mfma_f32_32x32x16_bf16 v[112:127], a[76:79], v[80:83], v[112:127]
	ds_read_b64_tr_b16 v[72:73], v21 offset:21504
	ds_read_b64_tr_b16 v[74:75], v21 offset:22016
	v_add_f32 v99, 0x3727c5ac, v97
	v_mfma_f32_32x32x16_bf16 v[128:143], a[76:79], v[84:87], v[128:143]
	ds_read_b64_tr_b16 v[76:77], v21 offset:50176
	ds_read_b64_tr_b16 v[78:79], v21 offset:50688
	v_mov_b32 v71, 0
	v_rsq_f32 v12, v99
	s_add_u32 m0, s90, 90112
	s_mov_b32 s54, 114816
	buffer_load_dwordx4 v7, s[16:19], s54 offen lds
	s_waitcnt lgkmcnt(4) vmcnt(9)
	v_mfma_f32_32x32x16_bf16 v[112:127], a[80:83], v[88:91], v[112:127]
	ds_read_b64_tr_b16 v[80:81], v21 offset:22528
	ds_read_b64_tr_b16 v[82:83], v21 offset:23040
	v_cvt_pk_bf16_f32 v69, v98, 0
	v_mfma_f32_32x32x16_bf16 v[128:143], a[80:83], v[92:95], v[128:143]
	ds_read_b64_tr_b16 v[84:85], v21 offset:51200
	ds_read_b64_tr_b16 v[86:87], v21 offset:51712
	v_mov_b32 v70, 0
	s_lshr_b32 s48, s90, 3
	s_add_u32 m0, s90, 94208
	s_mov_b32 s54, 229504
	buffer_load_dwordx4 v7, s[16:19], s54 offen lds
	s_waitcnt lgkmcnt(4) vmcnt(9)
	v_mfma_f32_32x32x16_bf16 v[112:127], a[84:87], v[72:75], v[112:127]
	ds_read_b64_tr_b16 v[88:89], v21 offset:23552
	ds_read_b64_tr_b16 v[90:91], v21 offset:24064
	s_add_u32 s48, s48, 161792
	v_mfma_f32_32x32x16_bf16 v[128:143], a[84:87], v[76:79], v[128:143]
	ds_read_b64_tr_b16 v[92:93], v21 offset:52224
	ds_read_b64_tr_b16 v[94:95], v21 offset:52736
	v_and_b32 v100, 0x7c, v2
	v_add_u32 v100, s48, v100
	s_add_u32 m0, s90, 98304
	s_mov_b32 s54, 344192
	buffer_load_dwordx4 v7, s[16:19], s54 offen lds
	s_waitcnt lgkmcnt(4) vmcnt(9)
	v_mfma_f32_32x32x16_bf16 v[112:127], a[88:91], v[80:83], v[112:127]
	ds_read_b64_tr_b16 v[72:73], v21 offset:24576
	ds_read_b64_tr_b16 v[74:75], v21 offset:25088
	ds_write_b32 v100, v12
	v_mfma_f32_32x32x16_bf16 v[128:143], a[88:91], v[84:87], v[128:143]
	ds_read_b64_tr_b16 v[76:77], v21 offset:53248
	ds_read_b64_tr_b16 v[78:79], v21 offset:53760
	v_lshrrev_b32 v101, 5, v1
	v_lshlrev_b32 v101, 4, v101
	s_add_u32 m0, s90, 102400
	s_mov_b32 s54, 458880
	buffer_load_dwordx4 v7, s[16:19], s54 offen lds
	s_waitcnt lgkmcnt(5) vmcnt(9)
	v_mfma_f32_32x32x16_bf16 v[112:127], a[92:95], v[88:91], v[112:127]
	ds_read_b64_tr_b16 v[80:81], v21 offset:25600
	ds_read_b64_tr_b16 v[82:83], v21 offset:26112
	v_add_u32 v101, s48, v101
	v_mfma_f32_32x32x16_bf16 v[128:143], a[92:95], v[92:95], v[128:143]
	ds_read_b64_tr_b16 v[84:85], v21 offset:54272
	ds_read_b64_tr_b16 v[86:87], v21 offset:54784
	ds_read_b128 v[176:179], v101 offset:0
	ds_read_b128 v[180:183], v101 offset:32
	s_add_u32 m0, s90, 106496
	s_mov_b32 s54, 573568
	buffer_load_dwordx4 v7, s[16:19], s54 offen lds
	s_waitcnt lgkmcnt(6) vmcnt(9)
	v_mfma_f32_32x32x16_bf16 v[112:127], a[96:99], v[72:75], v[112:127]
	ds_read_b64_tr_b16 v[88:89], v21 offset:26624
	ds_read_b64_tr_b16 v[90:91], v21 offset:27136
	ds_read_b128 v[184:187], v101 offset:64
	v_mfma_f32_32x32x16_bf16 v[128:143], a[96:99], v[76:79], v[128:143]
	ds_read_b64_tr_b16 v[92:93], v21 offset:55296
	ds_read_b64_tr_b16 v[94:95], v21 offset:55808
	ds_read_b128 v[188:191], v101 offset:96
	s_add_u32 m0, s90, 110592
	s_mov_b32 s54, 688256
	buffer_load_dwordx4 v7, s[16:19], s54 offen lds
	s_waitcnt lgkmcnt(8) vmcnt(9)
	v_mfma_f32_32x32x16_bf16 v[112:127], a[100:103], v[80:83], v[112:127]
	ds_read_b64_tr_b16 v[72:73], v21 offset:27648
	ds_read_b64_tr_b16 v[74:75], v21 offset:28160
	v_mfma_f32_32x32x16_bf16 v[128:143], a[100:103], v[84:87], v[128:143]
	ds_read_b64_tr_b16 v[76:77], v21 offset:56320
	ds_read_b64_tr_b16 v[78:79], v21 offset:56832
	s_add_u32 m0, s90, 114688
	s_mov_b32 s54, 802944
	buffer_load_dwordx4 v7, s[16:19], s54 offen lds
	s_waitcnt lgkmcnt(5) vmcnt(9)
	v_mfma_f32_32x32x16_bf16 v[112:127], a[104:107], v[88:91], v[112:127]
	v_mfma_f32_32x32x16_bf16 v[128:143], a[104:107], v[92:95], v[128:143]
	s_add_u32 m0, s90, 118784
	s_mov_b32 s54, 917632
	buffer_load_dwordx4 v7, s[16:19], s54 offen lds
	s_waitcnt lgkmcnt(0) vmcnt(9)
	v_mfma_f32_32x32x16_bf16 v[112:127], a[108:111], v[72:75], v[112:127]
	v_mfma_f32_32x32x16_bf16 v[128:143], a[108:111], v[76:79], v[128:143]
	v_mfma_f32_32x32x16_bf16 v[112:127], v[68:71], v[40:43], v[112:127]
	v_mfma_f32_32x32x16_bf16 v[128:143], v[68:71], v[44:47], v[128:143]
	s_mov_b32 exec_lo, 65535
	s_mov_b32 exec_hi, 0xfffc
	buffer_load_dword v17, v16, s[28:31], s68 offen
	s_mov_b64 exec, -1
	v_mov_b32 v96, 0x3f803f80
	s_lshl_b32 s52, s63, 9
	s_add_u32 s52, s52, s69
	s_nop 3
	v_pk_fma_f32 v[112:113], v[112:113], v[176:177], s[92:93] op_sel_hi:[1,1,0]
	v_pk_fma_f32 v[114:115], v[114:115], v[178:179], s[92:93] op_sel_hi:[1,1,0]
	v_pk_fma_f32 v[116:117], v[116:117], v[180:181], s[92:93] op_sel_hi:[1,1,0]
	v_pk_fma_f32 v[118:119], v[118:119], v[182:183], s[92:93] op_sel_hi:[1,1,0]
	v_pk_mul_f32 v[104:105], v[112:113], s[92:93] op_sel:[0,1] op_sel_hi:[1,1]
	v_pk_mul_f32 v[106:107], v[114:115], s[92:93] op_sel:[0,1] op_sel_hi:[1,1]
	v_pk_mul_f32 v[108:109], v[116:117], s[92:93] op_sel:[0,1] op_sel_hi:[1,1]
	v_pk_mul_f32 v[110:111], v[118:119], s[92:93] op_sel:[0,1] op_sel_hi:[1,1]
	v_exp_f32 v104, v104 clamp
	v_exp_f32 v105, v105 clamp
	v_exp_f32 v106, v106 clamp
	v_exp_f32 v107, v107 clamp
	v_exp_f32 v108, v108 clamp
	v_exp_f32 v109, v109 clamp
	v_exp_f32 v110, v110 clamp
	v_exp_f32 v111, v111 clamp
	v_max_f32 v112, s92, v112
	v_max_f32 v113, s92, v113
	v_max_f32 v114, s92, v114
	v_max_f32 v115, s92, v115
	v_max_f32 v116, s92, v116
	v_max_f32 v117, s92, v117
	v_max_f32 v118, s92, v118
	v_max_f32 v119, s92, v119
	v_pk_add_f32 v[112:113], v[112:113], v[104:105]
	v_pk_add_f32 v[114:115], v[114:115], v[106:107]
	v_pk_add_f32 v[116:117], v[116:117], v[108:109]
	v_pk_add_f32 v[118:119], v[118:119], v[110:111]
	v_cvt_pk_bf16_f32 v224, v112, v113
	v_cvt_pk_bf16_f32 v225, v114, v115
	v_cvt_pk_bf16_f32 v226, v116, v117
	v_cvt_pk_bf16_f32 v227, v118, v119
	v_pk_fma_f32 v[120:121], v[120:121], v[184:185], s[92:93] op_sel_hi:[1,1,0]
	v_pk_fma_f32 v[122:123], v[122:123], v[186:187], s[92:93] op_sel_hi:[1,1,0]
	v_pk_fma_f32 v[124:125], v[124:125], v[188:189], s[92:93] op_sel_hi:[1,1,0]
	v_pk_fma_f32 v[126:127], v[126:127], v[190:191], s[92:93] op_sel_hi:[1,1,0]
	v_pk_mul_f32 v[104:105], v[120:121], s[92:93] op_sel:[0,1] op_sel_hi:[1,1]
	v_pk_mul_f32 v[106:107], v[122:123], s[92:93] op_sel:[0,1] op_sel_hi:[1,1]
	v_pk_mul_f32 v[108:109], v[124:125], s[92:93] op_sel:[0,1] op_sel_hi:[1,1]
	v_pk_mul_f32 v[110:111], v[126:127], s[92:93] op_sel:[0,1] op_sel_hi:[1,1]
	v_exp_f32 v104, v104 clamp
	v_exp_f32 v105, v105 clamp
	v_exp_f32 v106, v106 clamp
	v_exp_f32 v107, v107 clamp
	v_exp_f32 v108, v108 clamp
	v_exp_f32 v109, v109 clamp
	v_exp_f32 v110, v110 clamp
	v_exp_f32 v111, v111 clamp
	v_max_f32 v120, s92, v120
	v_max_f32 v121, s92, v121
	v_max_f32 v122, s92, v122
	v_max_f32 v123, s92, v123
	v_max_f32 v124, s92, v124
	v_max_f32 v125, s92, v125
	v_max_f32 v126, s92, v126
	v_max_f32 v127, s92, v127
	v_pk_add_f32 v[120:121], v[120:121], v[104:105]
	v_pk_add_f32 v[122:123], v[122:123], v[106:107]
	v_pk_add_f32 v[124:125], v[124:125], v[108:109]
	v_pk_add_f32 v[126:127], v[126:127], v[110:111]
	v_cvt_pk_bf16_f32 v228, v120, v121
	v_cvt_pk_bf16_f32 v229, v122, v123
	v_cvt_pk_bf16_f32 v230, v124, v125
	v_cvt_pk_bf16_f32 v231, v126, v127
	v_pk_mul_f32 v[128:129], v[128:129], v[176:177]
	v_pk_mul_f32 v[130:131], v[130:131], v[178:179]
	v_pk_mul_f32 v[132:133], v[132:133], v[180:181]
	v_pk_mul_f32 v[134:135], v[134:135], v[182:183]
	v_pk_mul_f32 v[136:137], v[136:137], v[184:185]
	v_pk_mul_f32 v[138:139], v[138:139], v[186:187]
	v_pk_mul_f32 v[140:141], v[140:141], v[188:189]
	v_pk_mul_f32 v[142:143], v[142:143], v[190:191]
	v_cvt_pk_bf16_f32 v232, v128, v129
	v_cvt_pk_bf16_f32 v233, v130, v131
	v_cvt_pk_bf16_f32 v234, v132, v133
	v_cvt_pk_bf16_f32 v235, v134, v135
	v_cvt_pk_bf16_f32 v236, v136, v137
	v_cvt_pk_bf16_f32 v237, v138, v139
	v_cvt_pk_bf16_f32 v238, v140, v141
	v_cvt_pk_bf16_f32 v239, v142, v143
	v_cndmask_b32 v224, v224, 0, s[86:87]
	v_cndmask_b32 v225, v225, 0, s[86:87]
	v_cndmask_b32 v226, v226, 0, s[86:87]
	v_cndmask_b32 v227, v227, 0, s[86:87]
	v_cndmask_b32 v228, v228, 0, s[86:87]
	v_cndmask_b32 v229, v229, 0, s[86:87]
	v_cndmask_b32 v230, v230, 0, s[86:87]
	v_cndmask_b32 v231, v231, 0, s[86:87]
	v_cndmask_b32 v232, v232, v96, s[86:87]
	v_cndmask_b32 v233, v233, v96, s[86:87]
	v_cndmask_b32 v234, v234, v96, s[86:87]
	v_cndmask_b32 v235, v235, v96, s[86:87]
	v_cndmask_b32 v236, v236, v96, s[86:87]
	v_cndmask_b32 v237, v237, v96, s[86:87]
	v_cndmask_b32 v238, v238, v96, s[86:87]
	v_cndmask_b32 v239, v239, v96, s[86:87]
	v_mfma_f32_32x32x16_bf16 v[160:175], v[224:227], v[232:235], 0
	s_nop 0
	v_mfma_f32_32x32x16_bf16 v[160:175], v[228:231], v[236:239], v[160:175]
	s_nop 11
	ds_write_b128 v9, v[160:163] offset:0
	ds_write_b128 v9, v[164:167] offset:1024
	ds_write_b128 v9, v[168:171] offset:2048
	ds_write_b128 v9, v[172:175] offset:3072
	s_waitcnt lgkmcnt(0)
	s_barrier
	ds_read_b128 v[112:115], v10 offset:0
	ds_read_b128 v[116:119], v10 offset:4096
	ds_read_b128 v[120:123], v10 offset:8192
	ds_read_b128 v[124:127], v10 offset:12288
	ds_read_b64_tr_b16 v[72:73], v21 offset:57344
	ds_read_b64_tr_b16 v[74:75], v21 offset:57856
	ds_read_b64_tr_b16 v[76:77], v21 offset:58368
	ds_read_b64_tr_b16 v[78:79], v21 offset:58880
	ds_read_b64_tr_b16 v[80:81], v21 offset:59392
	ds_read_b64_tr_b16 v[82:83], v21 offset:59904
	ds_read_b64_tr_b16 v[84:85], v21 offset:60416
	ds_read_b64_tr_b16 v[86:87], v21 offset:60928
	s_waitcnt lgkmcnt(10)
	v_pk_add_f32 v[112:113], v[112:113], v[116:117]
	v_pk_add_f32 v[114:115], v[114:115], v[118:119]
	s_waitcnt lgkmcnt(8)
	v_pk_add_f32 v[120:121], v[120:121], v[124:125]
	v_pk_add_f32 v[122:123], v[122:123], v[126:127]
	v_pk_add_f32 v[112:113], v[112:113], v[120:121]
	v_pk_add_f32 v[114:115], v[114:115], v[122:123]
	v_cvt_pk_bf16_f32 v96, v112, v113
	v_cvt_pk_bf16_f32 v97, v114, v115
	buffer_store_dwordx2 v[96:97], v3, s[28:31], s52 offen sc1
	s_waitcnt lgkmcnt(4)
	v_mfma_f32_32x32x16_bf16 v[144:159], v[72:75], a[0:3], 0
	ds_read_b64_tr_b16 v[88:89], v21 offset:61440
	ds_read_b64_tr_b16 v[90:91], v21 offset:61952
	v_and_b32 v180, 31, v1
	v_mov_b32 v181, 0x3f80
	s_add_u32 m0, s90, 122880
	s_mov_b32 s54, 1032320
	buffer_load_dwordx4 v7, s[16:19], s54 offen lds
	v_mfma_f32_32x32x16_bf16 v[144:159], v[76:79], a[4:7], v[144:159]
	ds_read_b64_tr_b16 v[92:93], v21 offset:62464
	ds_read_b64_tr_b16 v[94:95], v21 offset:62976
	v_subrev_u32 v182, 0, v180
	v_cmp_gt_u32 vcc, 2, v182
	s_waitcnt lgkmcnt(4)
	v_mfma_f32_32x32x16_bf16 v[144:159], v[80:83], a[8:11], v[144:159]
	ds_read_b64_tr_b16 v[72:73], v21 offset:63488
	ds_read_b64_tr_b16 v[74:75], v21 offset:64000
	v_lshlrev_b32 v183, 4, v182
	v_lshlrev_b32 v183, v183, v181
	v_mfma_f32_32x32x16_bf16 v[144:159], v[84:87], a[12:15], v[144:159]
	ds_read_b64_tr_b16 v[76:77], v21 offset:64512
	ds_read_b64_tr_b16 v[78:79], v21 offset:65024
	v_cndmask_b32 v176, 0, v183, vcc
	v_subrev_u32 v182, 2, v180
	s_add_u32 m0, s90, 126976
	s_mov_b32 s54, 1147008
	buffer_load_dwordx4 v7, s[16:19], s54 offen lds
	s_waitcnt lgkmcnt(4)
	v_mfma_f32_32x32x16_bf16 v[144:159], v[88:91], a[16:19], v[144:159]
	ds_read_b64_tr_b16 v[80:81], v22 offset:0
	ds_read_b64_tr_b16 v[82:83], v22 offset:512
	v_cmp_gt_u32 vcc, 2, v182
	v_lshlrev_b32 v183, 4, v182
	v_mfma_f32_32x32x16_bf16 v[144:159], v[92:95], a[20:23], v[144:159]
	ds_read_b64_tr_b16 v[84:85], v22 offset:1024
	ds_read_b64_tr_b16 v[86:87], v22 offset:1536
	v_lshlrev_b32 v183, v183, v181
	v_cndmask_b32 v177, 0, v183, vcc
	s_add_u32 m0, s90, 131072
	s_mov_b32 s54, 1261696
	buffer_load_dwordx4 v7, s[16:19], s54 offen lds
	s_waitcnt lgkmcnt(4)
	v_mfma_f32_32x32x16_bf16 v[144:159], v[72:75], a[24:27], v[144:159]
	ds_read_b64_tr_b16 v[88:89], v22 offset:2048
	ds_read_b64_tr_b16 v[90:91], v22 offset:2560
	v_subrev_u32 v182, 4, v180
	v_cmp_gt_u32 vcc, 2, v182
	v_mfma_f32_32x32x16_bf16 v[144:159], v[76:79], a[28:31], v[144:159]
	ds_read_b64_tr_b16 v[92:93], v22 offset:3072
	ds_read_b64_tr_b16 v[94:95], v22 offset:3584
	v_lshlrev_b32 v183, 4, v182
	v_lshlrev_b32 v183, v183, v181
	s_add_u32 m0, s90, 135168
	s_mov_b32 s54, 1376384
	buffer_load_dwordx4 v7, s[16:19], s54 offen lds
	s_waitcnt lgkmcnt(4)
	v_mfma_f32_32x32x16_bf16 v[144:159], v[80:83], a[32:35], v[144:159]
	ds_read_b64_tr_b16 v[72:73], v22 offset:4096
	ds_read_b64_tr_b16 v[74:75], v22 offset:4608
	v_cndmask_b32 v178, 0, v183, vcc
	v_subrev_u32 v182, 6, v180
	v_mfma_f32_32x32x16_bf16 v[144:159], v[84:87], a[36:39], v[144:159]
	ds_read_b64_tr_b16 v[76:77], v22 offset:5120
	ds_read_b64_tr_b16 v[78:79], v22 offset:5632
	v_cmp_gt_u32 vcc, 2, v182
	v_lshlrev_b32 v183, 4, v182
	s_add_u32 m0, s90, 139264
	s_mov_b32 s54, 1491072
	buffer_load_dwordx4 v7, s[16:19], s54 offen lds
	s_waitcnt lgkmcnt(4)
	v_mfma_f32_32x32x16_bf16 v[144:159], v[88:91], a[40:43], v[144:159]
	ds_read_b64_tr_b16 v[80:81], v22 offset:6144
	ds_read_b64_tr_b16 v[82:83], v22 offset:6656
	v_lshlrev_b32 v183, v183, v181
	v_cndmask_b32 v179, 0, v183, vcc
	v_mfma_f32_32x32x16_bf16 v[144:159], v[92:95], a[44:47], v[144:159]
	ds_read_b64_tr_b16 v[84:85], v22 offset:7168
	ds_read_b64_tr_b16 v[86:87], v22 offset:7680
	s_waitcnt lgkmcnt(4)
	v_mfma_f32_32x32x16_bf16 v[144:159], v[72:75], a[48:51], v[144:159]
	ds_read_b64_tr_b16 v[88:89], v22 offset:8192
	ds_read_b64_tr_b16 v[90:91], v22 offset:8704
	s_add_u32 m0, s90, 0
	s_mov_b32 s54, 0
	buffer_load_dwordx4 v7, s[16:19], s54 offen lds
	v_mfma_f32_32x32x16_bf16 v[144:159], v[76:79], a[52:55], v[144:159]
	ds_read_b64_tr_b16 v[92:93], v22 offset:9216
	ds_read_b64_tr_b16 v[94:95], v22 offset:9728
	s_waitcnt lgkmcnt(4)
	v_mfma_f32_32x32x16_bf16 v[144:159], v[80:83], a[56:59], v[144:159]
	ds_read_b64_tr_b16 v[72:73], v22 offset:10240
	ds_read_b64_tr_b16 v[74:75], v22 offset:10752
	s_add_u32 m0, s90, 4096
	s_mov_b32 s54, 114688
	buffer_load_dwordx4 v7, s[16:19], s54 offen lds
	v_mfma_f32_32x32x16_bf16 v[144:159], v[84:87], a[60:63], v[144:159]
	ds_read_b64_tr_b16 v[76:77], v22 offset:11264
	ds_read_b64_tr_b16 v[78:79], v22 offset:11776
	s_waitcnt lgkmcnt(4)
	v_mfma_f32_32x32x16_bf16 v[144:159], v[88:91], a[64:67], v[144:159]
	ds_read_b64_tr_b16 v[80:81], v22 offset:12288
	ds_read_b64_tr_b16 v[82:83], v22 offset:12800
	s_add_u32 m0, s90, 8192
	s_mov_b32 s54, 229376
	buffer_load_dwordx4 v7, s[16:19], s54 offen lds
	v_mfma_f32_32x32x16_bf16 v[144:159], v[92:95], a[68:71], v[144:159]
	ds_read_b64_tr_b16 v[84:85], v22 offset:13312
	ds_read_b64_tr_b16 v[86:87], v22 offset:13824
	s_waitcnt lgkmcnt(4)
	v_mfma_f32_32x32x16_bf16 v[144:159], v[72:75], a[72:75], v[144:159]
	ds_read_b64_tr_b16 v[88:89], v22 offset:14336
	ds_read_b64_tr_b16 v[90:91], v22 offset:14848
	s_add_u32 m0, s90, 12288
	s_mov_b32 s54, 344064
	buffer_load_dwordx4 v7, s[16:19], s54 offen lds
	v_mfma_f32_32x32x16_bf16 v[144:159], v[76:79], a[76:79], v[144:159]
	ds_read_b64_tr_b16 v[92:93], v22 offset:15360
	ds_read_b64_tr_b16 v[94:95], v22 offset:15872
	s_waitcnt lgkmcnt(4)
	v_mfma_f32_32x32x16_bf16 v[144:159], v[80:83], a[80:83], v[144:159]
	ds_read_b64_tr_b16 v[72:73], v22 offset:16384
	ds_read_b64_tr_b16 v[74:75], v22 offset:16896
	v_mfma_f32_32x32x16_bf16 v[144:159], v[84:87], a[84:87], v[144:159]
	ds_read_b64_tr_b16 v[76:77], v22 offset:17408
	ds_read_b64_tr_b16 v[78:79], v22 offset:17920
	s_add_u32 m0, s90, 16384
	s_mov_b32 s54, 458752
	buffer_load_dwordx4 v7, s[16:19], s54 offen lds
	s_waitcnt lgkmcnt(4)
	v_mfma_f32_32x32x16_bf16 v[144:159], v[88:91], a[88:91], v[144:159]
	ds_read_b64_tr_b16 v[80:81], v22 offset:18432
	ds_read_b64_tr_b16 v[82:83], v22 offset:18944
	v_mfma_f32_32x32x16_bf16 v[144:159], v[92:95], a[92:95], v[144:159]
	ds_read_b64_tr_b16 v[84:85], v22 offset:19456
	ds_read_b64_tr_b16 v[86:87], v22 offset:19968
	s_add_u32 m0, s90, 20480
	s_mov_b32 s54, 573440
	buffer_load_dwordx4 v7, s[16:19], s54 offen lds
	s_waitcnt lgkmcnt(4)
	v_mfma_f32_32x32x16_bf16 v[144:159], v[72:75], a[96:99], v[144:159]
	v_mfma_f32_32x32x16_bf16 v[144:159], v[76:79], a[100:103], v[144:159]
	s_add_u32 m0, s90, 24576
	s_mov_b32 s54, 688128
	buffer_load_dwordx4 v7, s[16:19], s54 offen lds
	s_waitcnt lgkmcnt(0)
	v_mfma_f32_32x32x16_bf16 v[144:159], v[80:83], a[104:107], v[144:159]
	v_mfma_f32_32x32x16_bf16 v[144:159], v[84:87], a[108:111], v[144:159]
	s_add_u32 s48, s69, 4096
	buffer_load_dwordx4 v[192:195], v4, s[28:31], s69 offen offset:0 sc1
	buffer_load_dwordx4 v[196:199], v4, s[28:31], s69 offen offset:1024 sc1
	buffer_load_dwordx4 v[200:203], v4, s[28:31], s69 offen offset:2048 sc1
	buffer_load_dwordx4 v[204:207], v4, s[28:31], s69 offen offset:3072 sc1
	buffer_load_dwordx4 v[208:211], v4, s[28:31], s48 offen offset:0 sc1
	buffer_load_dwordx4 v[212:215], v4, s[28:31], s48 offen offset:1024 sc1
	buffer_load_dwordx4 v[216:219], v4, s[28:31], s48 offen offset:2048 sc1
	buffer_load_dwordx4 v[220:223], v4, s[28:31], s48 offen offset:3072 sc1
	s_barrier
	v_add_u32 v244, s90, v4
	v_add_u32 v244, 57344, v244
	v_mfma_f32_32x32x16_bf16 v[144:159], v[48:51], v[68:71], v[144:159]
	s_lshr_b32 s48, s64, 1
	s_lshl_b32 s48, s48, 10
	s_and_b32 s49, s64, 1
	s_lshl_b32 s49, s49, 3
	s_add_u32 s48, s48, s49
	s_add_u32 s48, s48, 159744
	v_and_b32 v242, 31, v1
	v_lshrrev_b32 v243, 5, v1
	v_lshlrev_b32 v242, 5, v242
	v_lshl_add_u32 v242, v243, 4, v242
	v_add_u32 v242, s48, v242
	v_add_u32 v243, 159744, v4
	s_lshl_b32 s49, s63, 7
	s_add_u32 s49, s49, s70
	s_lshl_b32 s50, s62, 11
	s_add_u32 s50, s50, s68
	ds_write_b128 v244, a[212:215] offset:0
	s_add_u32 m0, s90, 28672
	s_mov_b32 s54, 802816
	buffer_load_dwordx4 v7, s[16:19], s54 offen lds
	v_pk_fma_f32 v[144:145], v[144:145], v[12:13], s[92:93] op_sel_hi:[1,0,0]
	v_pk_fma_f32 v[146:147], v[146:147], v[12:13], s[92:93] op_sel_hi:[1,0,0]
	v_pk_fma_f32 v[148:149], v[148:149], v[12:13], s[92:93] op_sel_hi:[1,0,0]
	v_pk_fma_f32 v[150:151], v[150:151], v[12:13], s[92:93] op_sel_hi:[1,0,0]
	v_pk_mul_f32 v[104:105], v[144:145], s[92:93] op_sel:[0,1] op_sel_hi:[1,1]
	v_pk_mul_f32 v[106:107], v[146:147], s[92:93] op_sel:[0,1] op_sel_hi:[1,1]
	v_pk_mul_f32 v[108:109], v[148:149], s[92:93] op_sel:[0,1] op_sel_hi:[1,1]
	v_pk_mul_f32 v[110:111], v[150:151], s[92:93] op_sel:[0,1] op_sel_hi:[1,1]
	v_exp_f32 v104, v104 clamp
	ds_write_b128 v244, a[216:219] offset:4096
	s_add_u32 m0, s90, 32768
	s_mov_b32 s54, 917504
	buffer_load_dwordx4 v7, s[16:19], s54 offen lds
	v_exp_f32 v105, v105 clamp
	v_exp_f32 v106, v106 clamp
	v_exp_f32 v107, v107 clamp
	v_exp_f32 v108, v108 clamp
	v_exp_f32 v109, v109 clamp
	v_exp_f32 v110, v110 clamp
	v_exp_f32 v111, v111 clamp
	v_max_f32 v144, s92, v144
	v_max_f32 v145, s92, v145
	ds_write_b128 v244, a[220:223] offset:8192
	s_add_u32 m0, s90, 36864
	s_mov_b32 s54, 1032192
	buffer_load_dwordx4 v7, s[16:19], s54 offen lds
	v_max_f32 v146, s92, v146
	v_max_f32 v147, s92, v147
	v_max_f32 v148, s92, v148
	v_max_f32 v149, s92, v149
	v_max_f32 v150, s92, v150
	v_max_f32 v151, s92, v151
	v_pk_add_f32 v[144:145], v[144:145], v[104:105]
	v_pk_add_f32 v[146:147], v[146:147], v[106:107]
	v_pk_add_f32 v[148:149], v[148:149], v[108:109]
	ds_write_b128 v244, a[224:227] offset:12288
	s_add_u32 m0, s90, 40960
	s_mov_b32 s54, 1146880
	buffer_load_dwordx4 v7, s[16:19], s54 offen lds
	v_pk_add_f32 v[150:151], v[150:151], v[110:111]
	v_cvt_pk_bf16_f32 v248, v144, v145
	v_cvt_pk_bf16_f32 v249, v146, v147
	v_cvt_pk_bf16_f32 v250, v148, v149
	v_cvt_pk_bf16_f32 v251, v150, v151
	v_pk_fma_f32 v[152:153], v[152:153], v[12:13], s[92:93] op_sel_hi:[1,0,0]
	v_pk_fma_f32 v[154:155], v[154:155], v[12:13], s[92:93] op_sel_hi:[1,0,0]
	v_pk_fma_f32 v[156:157], v[156:157], v[12:13], s[92:93] op_sel_hi:[1,0,0]
	v_pk_fma_f32 v[158:159], v[158:159], v[12:13], s[92:93] op_sel_hi:[1,0,0]
	ds_write_b128 v244, a[228:231] offset:16384
	s_add_u32 m0, s90, 45056
	s_mov_b32 s54, 1261568
	buffer_load_dwordx4 v7, s[16:19], s54 offen lds
	v_pk_mul_f32 v[104:105], v[152:153], s[92:93] op_sel:[0,1] op_sel_hi:[1,1]
	v_pk_mul_f32 v[106:107], v[154:155], s[92:93] op_sel:[0,1] op_sel_hi:[1,1]
	v_pk_mul_f32 v[108:109], v[156:157], s[92:93] op_sel:[0,1] op_sel_hi:[1,1]
	v_pk_mul_f32 v[110:111], v[158:159], s[92:93] op_sel:[0,1] op_sel_hi:[1,1]
	v_exp_f32 v104, v104 clamp
	v_exp_f32 v105, v105 clamp
	v_exp_f32 v106, v106 clamp
	v_exp_f32 v107, v107 clamp
	v_exp_f32 v108, v108 clamp
	ds_write_b128 v244, a[232:235] offset:20480
	s_add_u32 m0, s90, 49152
	s_mov_b32 s54, 1376256
	buffer_load_dwordx4 v7, s[16:19], s54 offen lds
	v_exp_f32 v109, v109 clamp
	v_exp_f32 v110, v110 clamp
	v_exp_f32 v111, v111 clamp
	v_max_f32 v152, s92, v152
	v_max_f32 v153, s92, v153
	v_max_f32 v154, s92, v154
	v_max_f32 v155, s92, v155
	v_max_f32 v156, s92, v156
	v_max_f32 v157, s92, v157
	ds_write_b128 v244, a[236:239] offset:24576
	s_add_u32 m0, s90, 53248
	s_mov_b32 s54, 1490944
	buffer_load_dwordx4 v7, s[16:19], s54 offen lds
	v_max_f32 v158, s92, v158
	v_max_f32 v159, s92, v159
	v_pk_add_f32 v[152:153], v[152:153], v[104:105]
	v_pk_add_f32 v[154:155], v[154:155], v[106:107]
	v_pk_add_f32 v[156:157], v[156:157], v[108:109]
	v_pk_add_f32 v[158:159], v[158:159], v[110:111]
	v_cvt_pk_bf16_f32 v252, v152, v153
	v_cvt_pk_bf16_f32 v253, v154, v155
	v_cvt_pk_bf16_f32 v254, v156, v157
	v_cvt_pk_bf16_f32 v255, v158, v159
	s_waitcnt vmcnt(14)
	v_mfma_f32_32x32x16_bf16 v[112:127], v[176:179], v[192:195], 0
	s_waitcnt vmcnt(13)
	v_mfma_f32_32x32x16_bf16 v[112:127], v[176:179], v[196:199], v[112:127]
	s_waitcnt vmcnt(12)
	v_mfma_f32_32x32x16_bf16 v[112:127], v[176:179], v[200:203], v[112:127]
	s_waitcnt vmcnt(11)
	v_mfma_f32_32x32x16_bf16 v[112:127], v[176:179], v[204:207], v[112:127]
	s_waitcnt vmcnt(10)
	v_mfma_f32_32x32x16_bf16 v[112:127], v[176:179], v[208:211], v[112:127]
	s_waitcnt vmcnt(9)
	v_mfma_f32_32x32x16_bf16 v[112:127], v[176:179], v[212:215], v[112:127]
	s_waitcnt vmcnt(8)
	v_mfma_f32_32x32x16_bf16 v[112:127], v[176:179], v[216:219], v[112:127]
	s_waitcnt vmcnt(7)
	v_mfma_f32_32x32x16_bf16 v[112:127], v[176:179], v[220:223], v[112:127]
	s_nop 11
	v_cmp_u_f32 vcc, v112, v112
	s_nop 0
	s_cbranch_vccnz Lkvretry_98
Lkvok_99:
	s_nop 9
	v_cvt_pk_bf16_f32 v96, v112, v113
	v_cvt_pk_bf16_f32 v97, v114, v115
	ds_write_b64 v242, v[96:97]
	s_waitcnt lgkmcnt(0)
	s_barrier
	ds_read_b128 v[72:75], v243
	ds_read_b128 v[76:79], v243 offset:1024
	s_waitcnt lgkmcnt(1)
	v_mfma_f32_32x32x16_bf16 v[128:143], v[72:75], v[248:251], 0
	s_waitcnt lgkmcnt(0)
	v_mfma_f32_32x32x16_bf16 v[128:143], v[76:79], v[252:255], v[128:143]
	s_mov_b32 s40, s68
	s_add_u32 s41, s68, 4096
	s_add_u32 s42, s68, 8192
	s_add_u32 s43, s68, 12288
	s_add_u32 s44, s68, 16384
	s_add_u32 s45, s68, 20480
	s_add_u32 s46, s68, 24576
	s_add_u32 s47, s68, 28672
	s_nop 3
	v_add_f32 v96, s92, v140
	v_mov_b32 v97, v96
	s_nop 1
	v_permlane32_swap_b32 v96, v97
	v_rcp_f32 v97, v97
	s_nop 0
	v_cndmask_b32 v96, v97, 0, s[84:85]
	v_pk_mul_f32 v[128:129], v[128:129], v[96:97] op_sel:[0,1] op_sel_hi:[1,1]
	v_pk_mul_f32 v[130:131], v[130:131], v[96:97] op_sel:[0,1] op_sel_hi:[1,1]
	v_pk_mul_f32 v[132:133], v[132:133], v[96:97] op_sel:[0,1] op_sel_hi:[1,1]
	v_pk_mul_f32 v[134:135], v[134:135], v[96:97] op_sel:[0,1] op_sel_hi:[1,1]
	v_cvt_pk_bf16_f32 v224, v128, v129
	v_cvt_pk_bf16_f32 v225, v130, v131
	v_cvt_pk_bf16_f32 v226, v132, v133
	v_cvt_pk_bf16_f32 v227, v134, v135
	buffer_store_dwordx4 v[224:227], v4, s[28:31], s50 offen offset:0 sc1
	v_pk_mul_f32 v[136:137], v[136:137], v[96:97] op_sel:[0,1] op_sel_hi:[1,1]
	v_pk_mul_f32 v[138:139], v[138:139], v[96:97] op_sel:[0,1] op_sel_hi:[1,1]
	v_pk_mul_f32 v[140:141], v[140:141], v[96:97] op_sel_hi:[1,0]
	v_pk_mul_f32 v[142:143], v[142:143], v[96:97] op_sel_hi:[1,0]
	v_cvt_pk_bf16_f32 v228, v136, v137
	v_cvt_pk_bf16_f32 v229, v138, v139
	v_cvt_pk_bf16_f32 v230, v140, v141
	v_cvt_pk_bf16_f32 v231, v142, v143
	buffer_store_dwordx4 v[228:231], v4, s[28:31], s50 offen offset:1024 sc1
	s_waitcnt vmcnt(0)
	s_mov_b64 exec, 1
	buffer_store_dword v11, off, s[28:31], s74 offset:0 sc1
	s_mov_b64 exec, -1
	s_cmp_ge_u32 s62, 14
	s_cbranch_scc1 L_idle_slow1
Lpoll_103:
	buffer_load_dword v14, v5, s[28:31], s73 offen offset:0 sc1
	s_waitcnt vmcnt(0)
	v_cmp_ne_u32 vcc, s65, v14
	s_nop 0
	s_cbranch_vccz Lpdone_104
	s_sub_u32 s67, s67, 1
	s_cbranch_scc0 Lpoll_103
	s_mov_b32 s67, 0
Lpdone_104:
	buffer_load_dwordx4 a[0:3], v4, s[28:31], s40 offen offset:0 sc1
	buffer_load_dwordx4 a[4:7], v4, s[28:31], s40 offen offset:1024 sc1
	buffer_load_dwordx4 a[8:11], v4, s[28:31], s40 offen offset:2048 sc1
	buffer_load_dwordx4 a[12:15], v4, s[28:31], s40 offen offset:3072 sc1
	buffer_load_dwordx4 a[16:19], v4, s[28:31], s41 offen offset:0 sc1
	buffer_load_dwordx4 a[20:23], v4, s[28:31], s41 offen offset:1024 sc1
	buffer_load_dwordx4 a[24:27], v4, s[28:31], s41 offen offset:2048 sc1
	buffer_load_dwordx4 a[28:31], v4, s[28:31], s41 offen offset:3072 sc1
	buffer_load_dwordx4 a[32:35], v4, s[28:31], s42 offen offset:0 sc1
	buffer_load_dwordx4 a[36:39], v4, s[28:31], s42 offen offset:1024 sc1
	ds_read_b64_tr_b16 v[72:73], v21 offset:57344
	ds_read_b64_tr_b16 v[74:75], v21 offset:57856
	ds_read_b64_tr_b16 v[76:77], v21 offset:58368
	ds_read_b64_tr_b16 v[78:79], v21 offset:58880
	ds_read_b64_tr_b16 v[80:81], v21 offset:59136
	ds_read_b64_tr_b16 v[82:83], v21 offset:59648
	ds_read_b64_tr_b16 v[84:85], v21 offset:60160
	ds_read_b64_tr_b16 v[86:87], v21 offset:60672
	buffer_load_dwordx4 a[40:43], v4, s[28:31], s42 offen offset:2048 sc1
	s_waitcnt lgkmcnt(4) vmcnt(10)
	v_mfma_f32_32x32x16_bf16 v[24:39], v[72:75], a[0:3], v[24:39]
	ds_read_b64_tr_b16 v[88:89], v21 offset:60928
	ds_read_b64_tr_b16 v[90:91], v21 offset:61440
	buffer_load_dwordx4 a[44:47], v4, s[28:31], s42 offen offset:3072 sc1
	s_waitcnt vmcnt(10)
	v_mfma_f32_32x32x16_bf16 v[24:39], v[76:79], a[4:7], v[24:39]
	ds_read_b64_tr_b16 v[92:93], v21 offset:61952
	ds_read_b64_tr_b16 v[94:95], v21 offset:62464
	buffer_load_dwordx4 a[48:51], v4, s[28:31], s43 offen offset:0 sc1
	s_waitcnt lgkmcnt(4) vmcnt(10)
	v_mfma_f32_32x32x16_bf16 v[24:39], v[80:83], a[8:11], v[24:39]
	ds_read_b64_tr_b16 v[72:73], v21 offset:62720
	ds_read_b64_tr_b16 v[74:75], v21 offset:63232
	buffer_load_dwordx4 a[52:55], v4, s[28:31], s43 offen offset:1024 sc1
	s_waitcnt vmcnt(10)
	v_mfma_f32_32x32x16_bf16 v[24:39], v[84:87], a[12:15], v[24:39]
	ds_read_b64_tr_b16 v[76:77], v21 offset:63744
	ds_read_b64_tr_b16 v[78:79], v21 offset:64256
	buffer_load_dwordx4 a[56:59], v4, s[28:31], s43 offen offset:2048 sc1
	s_waitcnt lgkmcnt(4) vmcnt(10)
	v_mfma_f32_32x32x16_bf16 v[24:39], v[88:91], a[16:19], v[24:39]
	ds_read_b64_tr_b16 v[80:81], v21 offset:64512
	ds_read_b64_tr_b16 v[82:83], v21 offset:65024
	buffer_load_dwordx4 a[60:63], v4, s[28:31], s43 offen offset:3072 sc1
	s_waitcnt vmcnt(10)
	v_mfma_f32_32x32x16_bf16 v[24:39], v[92:95], a[20:23], v[24:39]
	ds_read_b64_tr_b16 v[84:85], v22 offset:0
	ds_read_b64_tr_b16 v[86:87], v22 offset:512
	buffer_load_dwordx4 a[64:67], v4, s[28:31], s44 offen offset:0 sc1
	s_waitcnt lgkmcnt(4) vmcnt(10)
	v_mfma_f32_32x32x16_bf16 v[24:39], v[72:75], a[24:27], v[24:39]
	ds_read_b64_tr_b16 v[88:89], v22 offset:768
	ds_read_b64_tr_b16 v[90:91], v22 offset:1280
	buffer_load_dwordx4 a[68:71], v4, s[28:31], s44 offen offset:1024 sc1
	s_waitcnt vmcnt(10)
	v_mfma_f32_32x32x16_bf16 v[24:39], v[76:79], a[28:31], v[24:39]
	ds_read_b64_tr_b16 v[92:93], v22 offset:1792
	ds_read_b64_tr_b16 v[94:95], v22 offset:2304
	buffer_load_dwordx4 a[72:75], v4, s[28:31], s44 offen offset:2048 sc1
	s_waitcnt lgkmcnt(4) vmcnt(10)
	v_mfma_f32_32x32x16_bf16 v[24:39], v[80:83], a[32:35], v[24:39]
	ds_read_b64_tr_b16 v[72:73], v22 offset:2560
	ds_read_b64_tr_b16 v[74:75], v22 offset:3072
	buffer_load_dwordx4 a[76:79], v4, s[28:31], s44 offen offset:3072 sc1
	s_waitcnt vmcnt(10)
	v_mfma_f32_32x32x16_bf16 v[24:39], v[84:87], a[36:39], v[24:39]
	ds_read_b64_tr_b16 v[76:77], v22 offset:3584
	ds_read_b64_tr_b16 v[78:79], v22 offset:4096
	buffer_load_dwordx4 a[80:83], v4, s[28:31], s45 offen offset:0 sc1
	s_waitcnt lgkmcnt(4) vmcnt(10)
	v_mfma_f32_32x32x16_bf16 v[24:39], v[88:91], a[40:43], v[24:39]
	ds_read_b64_tr_b16 v[80:81], v22 offset:4352
	ds_read_b64_tr_b16 v[82:83], v22 offset:4864
	buffer_load_dwordx4 a[84:87], v4, s[28:31], s45 offen offset:1024 sc1
	s_waitcnt vmcnt(10)
	v_mfma_f32_32x32x16_bf16 v[24:39], v[92:95], a[44:47], v[24:39]
	ds_read_b64_tr_b16 v[84:85], v22 offset:5376
	ds_read_b64_tr_b16 v[86:87], v22 offset:5888
	buffer_load_dwordx4 a[88:91], v4, s[28:31], s45 offen offset:2048 sc1
	s_waitcnt lgkmcnt(4) vmcnt(10)
	v_mfma_f32_32x32x16_bf16 v[24:39], v[72:75], a[48:51], v[24:39]
	ds_read_b64_tr_b16 v[88:89], v22 offset:6144
	ds_read_b64_tr_b16 v[90:91], v22 offset:6656
	buffer_load_dwordx4 a[92:95], v4, s[28:31], s45 offen offset:3072 sc1
	s_waitcnt vmcnt(10)
	v_mfma_f32_32x32x16_bf16 v[24:39], v[76:79], a[52:55], v[24:39]
	ds_read_b64_tr_b16 v[92:93], v22 offset:7168
	ds_read_b64_tr_b16 v[94:95], v22 offset:7680
	buffer_load_dwordx4 a[96:99], v4, s[28:31], s46 offen offset:0 sc1
	s_waitcnt lgkmcnt(4) vmcnt(10)
	v_mfma_f32_32x32x16_bf16 v[24:39], v[80:83], a[56:59], v[24:39]
	ds_read_b64_tr_b16 v[72:73], v22 offset:7936
	ds_read_b64_tr_b16 v[74:75], v22 offset:8448
	buffer_load_dwordx4 a[100:103], v4, s[28:31], s46 offen offset:1024 sc1
	s_waitcnt vmcnt(10)
	v_mfma_f32_32x32x16_bf16 v[24:39], v[84:87], a[60:63], v[24:39]
	ds_read_b64_tr_b16 v[76:77], v22 offset:8960
	ds_read_b64_tr_b16 v[78:79], v22 offset:9472
	buffer_load_dwordx4 a[104:107], v4, s[28:31], s46 offen offset:2048 sc1
	s_waitcnt lgkmcnt(4) vmcnt(10)
	v_mfma_f32_32x32x16_bf16 v[24:39], v[88:91], a[64:67], v[24:39]
	ds_read_b64_tr_b16 v[80:81], v22 offset:9728
	ds_read_b64_tr_b16 v[82:83], v22 offset:10240
	buffer_load_dwordx4 a[108:111], v4, s[28:31], s46 offen offset:3072 sc1
	s_waitcnt vmcnt(10)
	v_mfma_f32_32x32x16_bf16 v[24:39], v[92:95], a[68:71], v[24:39]
	ds_read_b64_tr_b16 v[84:85], v22 offset:10752
	ds_read_b64_tr_b16 v[86:87], v22 offset:11264
	buffer_load_dwordx4 a[112:115], v4, s[28:31], s47 offen offset:0 sc1
	s_waitcnt lgkmcnt(4) vmcnt(10)
	v_mfma_f32_32x32x16_bf16 v[24:39], v[72:75], a[72:75], v[24:39]
	ds_read_b64_tr_b16 v[88:89], v22 offset:11520
	ds_read_b64_tr_b16 v[90:91], v22 offset:12032
	buffer_load_dwordx4 a[116:119], v4, s[28:31], s47 offen offset:1024 sc1
	s_waitcnt vmcnt(10)
	v_mfma_f32_32x32x16_bf16 v[24:39], v[76:79], a[76:79], v[24:39]
	ds_read_b64_tr_b16 v[92:93], v22 offset:12544
	ds_read_b64_tr_b16 v[94:95], v22 offset:13056
	buffer_load_dwordx4 a[120:123], v4, s[28:31], s47 offen offset:2048 sc1
	s_waitcnt lgkmcnt(4) vmcnt(10)
	v_mfma_f32_32x32x16_bf16 v[24:39], v[80:83], a[80:83], v[24:39]
	ds_read_b64_tr_b16 v[72:73], v22 offset:13312
	ds_read_b64_tr_b16 v[74:75], v22 offset:13824
	buffer_load_dwordx4 a[124:127], v4, s[28:31], s47 offen offset:3072 sc1
	s_waitcnt vmcnt(10)
	v_mfma_f32_32x32x16_bf16 v[24:39], v[84:87], a[84:87], v[24:39]
	ds_read_b64_tr_b16 v[76:77], v22 offset:14336
	ds_read_b64_tr_b16 v[78:79], v22 offset:14848
	s_waitcnt lgkmcnt(4) vmcnt(9)
	v_mfma_f32_32x32x16_bf16 v[24:39], v[88:91], a[88:91], v[24:39]
	ds_read_b64_tr_b16 v[80:81], v22 offset:15104
	ds_read_b64_tr_b16 v[82:83], v22 offset:15616
	s_waitcnt vmcnt(8)
	v_mfma_f32_32x32x16_bf16 v[24:39], v[92:95], a[92:95], v[24:39]
	ds_read_b64_tr_b16 v[84:85], v22 offset:16128
	ds_read_b64_tr_b16 v[86:87], v22 offset:16640
	s_waitcnt lgkmcnt(4) vmcnt(7)
	v_mfma_f32_32x32x16_bf16 v[24:39], v[72:75], a[96:99], v[24:39]
	ds_read_b64_tr_b16 v[88:89], v22 offset:16896
	ds_read_b64_tr_b16 v[90:91], v22 offset:17408
	s_waitcnt vmcnt(6)
	v_mfma_f32_32x32x16_bf16 v[24:39], v[76:79], a[100:103], v[24:39]
	ds_read_b64_tr_b16 v[92:93], v22 offset:17920
	ds_read_b64_tr_b16 v[94:95], v22 offset:18432
	s_waitcnt lgkmcnt(4) vmcnt(5)
	v_mfma_f32_32x32x16_bf16 v[24:39], v[80:83], a[104:107], v[24:39]
	ds_read_b64_tr_b16 v[72:73], v22 offset:18688
	ds_read_b64_tr_b16 v[74:75], v22 offset:19200
	s_waitcnt vmcnt(4)
	v_mfma_f32_32x32x16_bf16 v[24:39], v[84:87], a[108:111], v[24:39]
	ds_read_b64_tr_b16 v[76:77], v22 offset:19712
	ds_read_b64_tr_b16 v[78:79], v22 offset:20224
	s_waitcnt lgkmcnt(4) vmcnt(3)
	v_mfma_f32_32x32x16_bf16 v[24:39], v[88:91], a[112:115], v[24:39]
	s_waitcnt vmcnt(2)
	v_mfma_f32_32x32x16_bf16 v[24:39], v[92:95], a[116:119], v[24:39]
	s_waitcnt lgkmcnt(0) vmcnt(1)
	v_mfma_f32_32x32x16_bf16 v[24:39], v[72:75], a[120:123], v[24:39]
	s_waitcnt vmcnt(0)
	v_mfma_f32_32x32x16_bf16 v[24:39], v[76:79], a[124:127], v[24:39]
	s_lshl_b32 s53, s62, 11
	s_add_u32 s53, s53, s68
	s_add_u32 s53, s53, 32768
	s_lshl_b32 s49, s62, 8
	s_add_u32 s49, s49, s68
	s_add_u32 s49, s49, 61440
	s_add_u32 s48, s68, 32768
	s_add_u32 s40, s48, 0
	s_add_u32 s41, s48, 4096
	s_add_u32 s42, s48, 8192
	s_add_u32 s43, s48, 12288
	s_add_u32 s44, s48, 16384
	s_add_u32 s45, s48, 20480
	s_add_u32 s46, s48, 24576
	s_add_u32 s52, s68, 61440
	v_cvt_pk_bf16_f32 v224, v24, v25
	v_cvt_pk_bf16_f32 v225, v26, v27
	v_cvt_pk_bf16_f32 v226, v28, v29
	v_cvt_pk_bf16_f32 v227, v30, v31
	buffer_store_dwordx4 v[224:227], v4, s[28:31], s53 offen sc1
	v_cvt_pk_bf16_f32 v228, v32, v33
	v_cvt_pk_bf16_f32 v229, v34, v35
	v_cvt_pk_bf16_f32 v230, v36, v37
	v_cvt_pk_bf16_f32 v231, v38, v39
	buffer_store_dwordx4 v[228:231], v4, s[28:31], s53 offen offset:1024 sc1
	v_pk_add_f32 v[96:97], v[24:25], v[26:27]
	v_pk_mul_f32 v[98:99], v[24:25], v[24:25]
	v_pk_fma_f32 v[98:99], v[26:27], v[26:27], v[98:99]
	v_pk_fma_f32 v[98:99], v[28:29], v[28:29], v[98:99]
	v_pk_add_f32 v[96:97], v[96:97], v[28:29]
	v_pk_fma_f32 v[98:99], v[30:31], v[30:31], v[98:99]
	v_pk_add_f32 v[96:97], v[96:97], v[30:31]
	v_pk_fma_f32 v[98:99], v[32:33], v[32:33], v[98:99]
	v_pk_add_f32 v[96:97], v[96:97], v[32:33]
	v_pk_fma_f32 v[98:99], v[34:35], v[34:35], v[98:99]
	v_pk_add_f32 v[96:97], v[96:97], v[34:35]
	v_pk_fma_f32 v[98:99], v[36:37], v[36:37], v[98:99]
	v_pk_add_f32 v[96:97], v[96:97], v[36:37]
	v_pk_fma_f32 v[98:99], v[38:39], v[38:39], v[98:99]
	v_pk_add_f32 v[96:97], v[96:97], v[38:39]
	v_add_f32 v96, v96, v97
	v_add_f32 v97, v98, v99
	s_nop 1
	v_permlane32_swap_b32 v96, v97
	v_add_f32 v96, v96, v97
	buffer_store_dword v96, v2, s[28:31], s49 offen sc1
	s_lshr_b32 s50, s56, 3
	s_add_u32 s50, s50, s68
	s_add_u32 s50, s50, 65536
	s_add_u32 s51, s50, 4096
	s_waitcnt vmcnt(0)
	s_mov_b64 exec, 1
	buffer_store_dword v11, off, s[28:31], s74 offset:128 sc1
	s_mov_b64 exec, -1
	s_cmp_lg_u32 s2, 0
	s_cbranch_scc1 Lep_105
	s_mov_b64 exec, 1
	buffer_store_dword v11, off, s[28:31], 0 offset:0
	s_mov_b64 exec, -1
Lep_105:
	s_branch L_mlp_slow
L_tail_slow1:
	buffer_load_dwordx4 v[232:235], v4, s[28:31], s48 offen offset:0 sc1
	buffer_load_dwordx4 v[236:239], v4, s[28:31], s48 offen offset:1024 sc1
	v_and_b32 v98, 31, v1
	v_lshrrev_b32 v99, 5, v1
	v_mul_u32_u24 v98, 896, v98
	v_lshl_add_u32 v98, v99, 4, v98
	s_lshl_b32 s50, s62, 6
	s_add_u32 s50, s50, s96
	s_lshl_b32 s3, s64, 12
	s_add_u32 s3, s3, 143360
	s_add_u32 s51, s50, 14336
	v_and_b32 v100, 31, v1
	v_bfe_u32 v101, v1, 1, 2
	v_xor_b32 v101, v101, v99
	v_lshlrev_b32 v100, 6, v100
	v_lshl_add_u32 v100, v101, 4, v100
	v_add_u32 v100, s3, v100
	v_xor_b32 v101, 32, v100
	v_bfe_u32 v102, v1, 3, 2
	v_lshlrev_b32 v102, 4, v102
	v_xor_b32 v102, v102, v4
	v_add_u32 v102, s3, v102
	v_lshrrev_b32 v103, 2, v1
	v_mul_u32_u24 v103, 896, v103
	v_and_b32 v106, 48, v4
	v_add_u32 v103, v103, v106
	s_waitcnt vmcnt(1)
	v_max3_u32 v105, v232, v233, v234
	s_waitcnt vmcnt(0)
	v_max3_u32 v108, v235, v236, v237
	v_max3_u32 v105, v105, v238, v239
	v_max_u32 v105, v105, v108
	v_cmp_eq_u32 vcc, -1, v105
	s_mov_b64 exec, 1
	buffer_store_dword v11, off, s[28:31], s74 offset:512 sc1
	s_mov_b64 exec, -1
	s_cbranch_vccnz Lpslow_106
Lpok_107:
	v_mfma_f32_32x32x16_bf16 v[24:39], a[240:243], v[232:235], v[24:39]
	v_mfma_f32_32x32x16_bf16 v[24:39], a[244:247], v[236:239], v[24:39]
	s_nop 11
	v_cvt_pk_bf16_f32 v224, v24, v25
	v_cvt_pk_bf16_f32 v225, v26, v27
	v_cvt_pk_bf16_f32 v226, v28, v29
	v_cvt_pk_bf16_f32 v227, v30, v31
	v_cvt_pk_bf16_f32 v228, v32, v33
	v_cvt_pk_bf16_f32 v229, v34, v35
	v_cvt_pk_bf16_f32 v230, v36, v37
	v_cvt_pk_bf16_f32 v231, v38, v39
	v_permlane32_swap_b32 v224, v226
	v_permlane32_swap_b32 v225, v227
	ds_write_b128 v100, v[224:227]
	v_permlane32_swap_b32 v228, v230
	v_permlane32_swap_b32 v229, v231
	ds_write_b128 v101, v[228:231]
	ds_read_b128 v[232:235], v102
	ds_read_b128 v[236:239], v102 offset:1024
	s_waitcnt lgkmcnt(1)
	buffer_store_dwordx4 v[232:235], v103, s[24:27], s50 offen
	s_waitcnt lgkmcnt(0)
	buffer_store_dwordx4 v[236:239], v103, s[24:27], s51 offen
	s_branch L_done
L_idle_slow0:
	s_and_b32 s50, s63, 1
	s_lshl_b32 s50, s50, 1
	s_add_u32 s50, s50, s71
	s_lshl_b32 s50, s50, 2
	s_add_u32 s50, s50, s64
	v_lshlrev_b32 v98, 3, v4
	s_lshl_b32 s48, s71, 14
	s_add_u32 s48, s48, s68
	s_add_u32 s48, s48, 32768
	s_mov_b32 s49, 2
Lpf_109:
	buffer_load_dword v17, v98, s[28:31], s48 offen
	s_add_u32 s48, s48, 8192
	s_sub_u32 s49, s49, 1
	s_cmp_lg_u32 s49, 0
	s_cbranch_scc1 Lpf_109
	v_mov_b32 v102, v98
	v_and_b32 v102, 1920, v102
	v_add_u32 v102, 2048, v102
	s_mul_i32 s48, s71, 100352
	s_add_u32 s48, s48, s68
	s_add_u32 s48, s48, 65536
	s_mov_b32 s49, 7
Lpf_110:
	buffer_load_dword v17, v102, s[28:31], s48 offen
	s_add_u32 s48, s48, 14336
	s_sub_u32 s49, s49, 1
	s_cmp_lg_u32 s49, 0
	s_cbranch_scc1 Lpf_110
	v_and_b32 v99, 31, v1
	v_min_u32 v99, 27, v99
	v_lshlrev_b32 v99, 7, v99
	v_lshrrev_b32 v100, 5, v1
	v_mul_u32_u24 v100, 114688, v100
	v_add_u32 v99, v99, v100
	s_mul_i32 s48, s50, 3584
	s_add_u32 s48, s48, 57344
	s_mov_b32 s49, 7
Lpf_111:
	buffer_load_dword v17, v99, s[20:23], s48 offen
	s_add_u32 s48, s48, 229376
	s_sub_u32 s49, s49, 1
	s_cmp_lg_u32 s49, 0
	s_cbranch_scc1 Lpf_111
	s_waitcnt vmcnt(0)
	s_barrier
	v_add_u32 v106, s90, v4
	v_add_u32 v107, 57344, v106
	ds_write_b128 v106, a[128:131] offset:0
	ds_write_b128 v106, a[132:135] offset:4096
	ds_write_b128 v106, a[136:139] offset:8192
	ds_write_b128 v106, a[140:143] offset:12288
	ds_write_b128 v106, a[144:147] offset:16384
	ds_write_b128 v106, a[148:151] offset:20480
	ds_write_b128 v106, a[152:155] offset:24576
	ds_write_b128 v106, a[156:159] offset:28672
	ds_write_b128 v106, a[160:163] offset:32768
	ds_write_b128 v106, a[164:167] offset:36864
	ds_write_b128 v106, a[168:171] offset:40960
	ds_write_b128 v106, a[172:175] offset:45056
	ds_write_b128 v106, a[176:179] offset:49152
	ds_write_b128 v106, a[180:183] offset:53248
Lpoll_112:
	s_sleep 8
	buffer_load_dword v14, v6, s[28:31], s73 offen offset:256 sc1
	s_waitcnt vmcnt(0)
	v_cmp_ne_u32 vcc, s65, v14
	s_nop 0
	s_cbranch_vccz Lpdone_113
	s_sub_u32 s67, s67, 1
	s_cbranch_scc0 Lpoll_112
	s_mov_b32 s67, 0
Lpdone_113:
	s_mov_b32 s18, 1605632
	s_lshl_b32 s48, s50, 13
	s_mov_b32 s49, 7
Lpf_114:
	buffer_load_dword v17, v98, s[16:19], s48 offen
	s_add_u32 s48, s48, 131072
	buffer_load_dword v17, v98, s[16:19], s48 offen
	s_add_u32 s48, s48, 131072
	buffer_load_dword v14, v6, s[28:31], s73 offen offset:512 sc1
	s_waitcnt vmcnt(0)
	v_cmp_eq_u32 vcc, s65, v14
	s_nop 0
	s_cbranch_vccnz Lpfe_115
	s_sub_u32 s49, s49, 1
	s_cmp_lg_u32 s49, 0
	s_cbranch_scc1 Lpf_114
Lpfe_115:
	s_mov_b32 s18, 0
	s_waitcnt vmcnt(0)
Lpoll_116:
	s_sleep 2
	buffer_load_dword v14, v6, s[28:31], s73 offen offset:512 sc1
	s_waitcnt vmcnt(0)
	v_cmp_ne_u32 vcc, s65, v14
	s_nop 0
	s_cbranch_vccz Lpdone_117
	s_sub_u32 s67, s67, 1
	s_cbranch_scc0 Lpoll_116
	s_mov_b32 s67, 0
Lpdone_117:
	s_branch L_second_slow
L_idle_slow1:
	s_and_b32 s50, s63, 1
	s_lshl_b32 s50, s50, 1
	s_add_u32 s50, s50, s71
	s_lshl_b32 s50, s50, 2
	s_add_u32 s50, s50, s64
	v_lshlrev_b32 v98, 3, v4
	s_lshl_b32 s48, s71, 14
	s_add_u32 s48, s48, s68
	s_add_u32 s48, s48, 32768
	s_mov_b32 s49, 2
Lpf_118:
	buffer_load_dword v17, v98, s[28:31], s48 offen
	s_add_u32 s48, s48, 8192
	s_sub_u32 s49, s49, 1
	s_cmp_lg_u32 s49, 0
	s_cbranch_scc1 Lpf_118
	v_mov_b32 v102, v98
	v_and_b32 v102, 1920, v102
	v_add_u32 v102, 2048, v102
	s_mul_i32 s48, s71, 100352
	s_add_u32 s48, s48, s68
	s_add_u32 s48, s48, 65536
	s_mov_b32 s49, 7
Lpf_119:
	buffer_load_dword v17, v102, s[28:31], s48 offen
	s_add_u32 s48, s48, 14336
	s_sub_u32 s49, s49, 1
	s_cmp_lg_u32 s49, 0
	s_cbranch_scc1 Lpf_119
	v_and_b32 v99, 31, v1
	v_min_u32 v99, 27, v99
	v_lshlrev_b32 v99, 7, v99
	v_lshrrev_b32 v100, 5, v1
	v_mul_u32_u24 v100, 114688, v100
	v_add_u32 v99, v99, v100
	s_mul_i32 s48, s50, 3584
	s_add_u32 s48, s48, 57344
	s_mov_b32 s49, 7
Lpf_120:
	buffer_load_dword v17, v99, s[20:23], s48 offen
	s_add_u32 s48, s48, 229376
	s_sub_u32 s49, s49, 1
	s_cmp_lg_u32 s49, 0
	s_cbranch_scc1 Lpf_120
	s_branch L_done
Lkvretry_77:
	s_mov_b64 exec, 1
	buffer_store_dword v11, off, s[28:31], s49 offset:4 sc1
	s_mov_b64 exec, -1
Lkvretry_79:
	s_mov_b64 s[88:89], -1
	s_and_b32 s3, s67, 15
	s_cbranch_scc1 Lkvretry_80
	v_lshlrev_b32 v96, 5, v5
	buffer_load_dword v14, v96, s[28:31], s70 offen offset:4 sc1
	s_waitcnt vmcnt(0)
	v_cmp_ne_u32 s[88:89], s65, v14
Lkvretry_80:
	s_add_u32 s48, s69, 4096
	buffer_load_dwordx4 v[192:195], v4, s[28:31], s69 offen offset:0 sc1
	buffer_load_dwordx4 v[196:199], v4, s[28:31], s69 offen offset:1024 sc1
	buffer_load_dwordx4 v[200:203], v4, s[28:31], s69 offen offset:2048 sc1
	buffer_load_dwordx4 v[204:207], v4, s[28:31], s69 offen offset:3072 sc1
	buffer_load_dwordx4 v[208:211], v4, s[28:31], s48 offen offset:0 sc1
	buffer_load_dwordx4 v[212:215], v4, s[28:31], s48 offen offset:1024 sc1
	buffer_load_dwordx4 v[216:219], v4, s[28:31], s48 offen offset:2048 sc1
	buffer_load_dwordx4 v[220:223], v4, s[28:31], s48 offen offset:3072 sc1
	v_mov_b32 v96, 0
	s_waitcnt vmcnt(7)
	v_max3_u32 v96, v96, v192, v193
	v_max3_u32 v96, v96, v194, v195
	s_waitcnt vmcnt(6)
	v_max3_u32 v96, v96, v196, v197
	v_max3_u32 v96, v96, v198, v199
	s_waitcnt vmcnt(5)
	v_max3_u32 v96, v96, v200, v201
	v_max3_u32 v96, v96, v202, v203
	s_waitcnt vmcnt(4)
	v_max3_u32 v96, v96, v204, v205
	v_max3_u32 v96, v96, v206, v207
	s_waitcnt vmcnt(3)
	v_max3_u32 v96, v96, v208, v209
	v_max3_u32 v96, v96, v210, v211
	s_waitcnt vmcnt(2)
	v_max3_u32 v96, v96, v212, v213
	v_max3_u32 v96, v96, v214, v215
	s_waitcnt vmcnt(1)
	v_max3_u32 v96, v96, v216, v217
	v_max3_u32 v96, v96, v218, v219
	s_waitcnt vmcnt(0)
	v_max3_u32 v96, v96, v220, v221
	v_max3_u32 v96, v96, v222, v223
	v_cmp_eq_u32 vcc, -1, v96
	s_nop 0
	s_cbranch_vccz Lkvretry_81
	s_cmp_eq_u64 s[88:89], 0
	s_cbranch_scc1 Lkvretry_81
	s_sub_u32 s67, s67, 1
	s_cbranch_scc0 Lkvretry_79
	s_mov_b32 s67, 0
Lkvretry_81:
	v_mfma_f32_32x32x16_bf16 v[112:127], v[176:179], v[192:195], 0
	v_mfma_f32_32x32x16_bf16 v[112:127], v[176:179], v[196:199], v[112:127]
	v_mfma_f32_32x32x16_bf16 v[112:127], v[176:179], v[200:203], v[112:127]
	v_mfma_f32_32x32x16_bf16 v[112:127], v[176:179], v[204:207], v[112:127]
	v_mfma_f32_32x32x16_bf16 v[112:127], v[176:179], v[208:211], v[112:127]
	v_mfma_f32_32x32x16_bf16 v[112:127], v[176:179], v[212:215], v[112:127]
	v_mfma_f32_32x32x16_bf16 v[112:127], v[176:179], v[216:219], v[112:127]
	v_mfma_f32_32x32x16_bf16 v[112:127], v[176:179], v[220:223], v[112:127]
	s_nop 11
	v_cmp_u_f32 vcc, v112, v112
	s_branch Lkvok_78
Lh1slow_89:
Lpoll_91:
	buffer_load_dword v14, v15, s[28:31], s73 offen offset:384 sc1
	s_waitcnt vmcnt(0)
	v_cmp_ne_u32 vcc, s65, v14
	s_nop 0
	s_cbranch_vccz Lpdone_92
	s_sub_u32 s67, s67, 1
	s_cbranch_scc0 Lpoll_91
	s_mov_b32 s67, 0
Lpdone_92:
	s_branch Lh1ok_90
Lpslow_93:
	s_mov_b64 s[88:89], -1
Lpslow_95:
	buffer_load_dword v14, v104, s[28:31], s49 offen offset:512 sc1
	buffer_load_dwordx4 v[232:235], v4, s[28:31], s48 offen offset:0 sc1
	buffer_load_dwordx4 v[236:239], v4, s[28:31], s48 offen offset:1024 sc1
	s_waitcnt vmcnt(1)
	v_max3_u32 v105, v232, v233, v234
	s_waitcnt vmcnt(0)
	v_max3_u32 v108, v235, v236, v237
	v_max3_u32 v105, v105, v238, v239
	v_max_u32 v105, v105, v108
	v_cmp_eq_u32 vcc, -1, v105
	s_nop 0
	s_cbranch_vccz Lpok_94
	s_cmp_eq_u64 s[88:89], 0
	s_cbranch_scc1 Lpok_94
	v_cmp_ne_u32 s[88:89], s65, v14
	s_sub_u32 s67, s67, 1
	s_cbranch_scc0 Lpslow_95
	s_mov_b32 s67, 0
	s_branch Lpok_94
Lkvretry_98:
	s_mov_b64 exec, 1
	buffer_store_dword v11, off, s[28:31], s49 offset:8 sc1
	s_mov_b64 exec, -1
Lkvretry_100:
	s_mov_b64 s[88:89], -1
	s_and_b32 s3, s67, 15
	s_cbranch_scc1 Lkvretry_101
	v_lshlrev_b32 v96, 5, v5
	buffer_load_dword v14, v96, s[28:31], s70 offen offset:8 sc1
	s_waitcnt vmcnt(0)
	v_cmp_ne_u32 s[88:89], s65, v14
Lkvretry_101:
	s_add_u32 s48, s69, 4096
	buffer_load_dwordx4 v[192:195], v4, s[28:31], s69 offen offset:0 sc1
	buffer_load_dwordx4 v[196:199], v4, s[28:31], s69 offen offset:1024 sc1
	buffer_load_dwordx4 v[200:203], v4, s[28:31], s69 offen offset:2048 sc1
	buffer_load_dwordx4 v[204:207], v4, s[28:31], s69 offen offset:3072 sc1
	buffer_load_dwordx4 v[208:211], v4, s[28:31], s48 offen offset:0 sc1
	buffer_load_dwordx4 v[212:215], v4, s[28:31], s48 offen offset:1024 sc1
	buffer_load_dwordx4 v[216:219], v4, s[28:31], s48 offen offset:2048 sc1
	buffer_load_dwordx4 v[220:223], v4, s[28:31], s48 offen offset:3072 sc1
	v_mov_b32 v96, 0
	s_waitcnt vmcnt(7)
	v_max3_u32 v96, v96, v192, v193
	v_max3_u32 v96, v96, v194, v195
	s_waitcnt vmcnt(6)
	v_max3_u32 v96, v96, v196, v197
	v_max3_u32 v96, v96, v198, v199
	s_waitcnt vmcnt(5)
	v_max3_u32 v96, v96, v200, v201
	v_max3_u32 v96, v96, v202, v203
	s_waitcnt vmcnt(4)
	v_max3_u32 v96, v96, v204, v205
	v_max3_u32 v96, v96, v206, v207
	s_waitcnt vmcnt(3)
	v_max3_u32 v96, v96, v208, v209
	v_max3_u32 v96, v96, v210, v211
	s_waitcnt vmcnt(2)
	v_max3_u32 v96, v96, v212, v213
	v_max3_u32 v96, v96, v214, v215
	s_waitcnt vmcnt(1)
	v_max3_u32 v96, v96, v216, v217
	v_max3_u32 v96, v96, v218, v219
	s_waitcnt vmcnt(0)
	v_max3_u32 v96, v96, v220, v221
	v_max3_u32 v96, v96, v222, v223
	v_cmp_eq_u32 vcc, -1, v96
	s_nop 0
	s_cbranch_vccz Lkvretry_102
	s_cmp_eq_u64 s[88:89], 0
	s_cbranch_scc1 Lkvretry_102
	s_sub_u32 s67, s67, 1
	s_cbranch_scc0 Lkvretry_100
	s_mov_b32 s67, 0
Lkvretry_102:
	v_mfma_f32_32x32x16_bf16 v[112:127], v[176:179], v[192:195], 0
	v_mfma_f32_32x32x16_bf16 v[112:127], v[176:179], v[196:199], v[112:127]
	v_mfma_f32_32x32x16_bf16 v[112:127], v[176:179], v[200:203], v[112:127]
	v_mfma_f32_32x32x16_bf16 v[112:127], v[176:179], v[204:207], v[112:127]
	v_mfma_f32_32x32x16_bf16 v[112:127], v[176:179], v[208:211], v[112:127]
	v_mfma_f32_32x32x16_bf16 v[112:127], v[176:179], v[212:215], v[112:127]
	v_mfma_f32_32x32x16_bf16 v[112:127], v[176:179], v[216:219], v[112:127]
	v_mfma_f32_32x32x16_bf16 v[112:127], v[176:179], v[220:223], v[112:127]
	s_nop 11
	v_cmp_u_f32 vcc, v112, v112
	s_branch Lkvok_99
Lpslow_106:
	s_mov_b64 s[88:89], -1
Lpslow_108:
	buffer_load_dword v14, v104, s[28:31], s49 offen offset:512 sc1
	buffer_load_dwordx4 v[232:235], v4, s[28:31], s48 offen offset:0 sc1
	buffer_load_dwordx4 v[236:239], v4, s[28:31], s48 offen offset:1024 sc1
	s_waitcnt vmcnt(1)
	v_max3_u32 v105, v232, v233, v234
	s_waitcnt vmcnt(0)
	v_max3_u32 v108, v235, v236, v237
	v_max3_u32 v105, v105, v238, v239
	v_max_u32 v105, v105, v108
	v_cmp_eq_u32 vcc, -1, v105
	s_nop 0
	s_cbranch_vccz Lpok_107
	s_cmp_eq_u64 s[88:89], 0
	s_cbranch_scc1 Lpok_107
	v_cmp_ne_u32 s[88:89], s65, v14
	s_sub_u32 s67, s67, 1
	s_cbranch_scc0 Lpslow_108
	s_mov_b32 s67, 0
	s_branch Lpok_107
.section .rodata,"a"
.p2align 6
.amdhsa_kernel interleave_layers__linear_attn_block__mixer_channel_mlp__prompt_kernel
  .amdhsa_next_free_vgpr 512
  .amdhsa_next_free_sgpr 102
  .amdhsa_accum_offset 256
  .amdhsa_group_segment_fixed_size 0
  .amdhsa_kernarg_size 88
  .amdhsa_user_sgpr_count 2
  .amdhsa_user_sgpr_kernarg_segment_ptr 1
  .amdhsa_system_sgpr_workgroup_id_x 1
.end_amdhsa_kernel
```
